```python
import torch

def _softmax(x, axis=-1):
    return torch.softmax(x, dim=axis)
def _gelu(x):
    return torch.nn.functional.gelu(x, approximate="tanh")
def _silu(x):
    return torch.nn.functional.silu(x)
def _sigmoid(x):
    return torch.sigmoid(x)
def _layernorm(x, axis=-1, eps=1e-5):
    m = x.mean(dim=axis, keepdim=True)
    v = x.var(dim=axis, keepdim=True, unbiased=False)
    return (x - m) / torch.sqrt(v + eps)
def _scatter_add(tgt, idx, src, axis=0):
    return tgt.clone().index_add_(axis, idx, src)
def _segment_sum(src, seg, n):
    out = torch.zeros((n,) + src.shape[1:], dtype=src.dtype)
    return out.index_add_(0, seg, src)
def _pad(x, pw):
    flat = tuple(v for pair in reversed(pw) for v in pair)
    return torch.nn.functional.pad(x, flat)

kernel_name = 'gated_mix__linear_attn_block__ssm_conv_s4d__prompt'

def setup_inputs():

    _w = (lambda a: (lambda t: t.to(torch.bfloat16) if t.is_floating_point() else t)(torch.as_tensor(a)))
    def _A_setup():
        B, S, D = 1, 2048, 576
        return {
            "x": _w((lambda *s: torch.randn(*s, dtype=torch.bfloat16) * 0.05)(B, S, D)),
            "wqkv": _w((lambda *s: torch.randn(*s, dtype=torch.bfloat16) * 0.8)(D, 3 * D)),
            "wo": _w((lambda *s: torch.randn(*s, dtype=torch.bfloat16) * 0.05)(D, D)),
        }
    _A_in = _A_setup()

    def _B_setup():
        Bsz, L, D, N = 1, 2048, 576, 128
        return {
            "u": _w((lambda *s: torch.randn(*s, dtype=torch.bfloat16) * 0.05)(Bsz, L, D)),
            "log_A_real": _w((lambda *s: torch.randn(*s, dtype=torch.bfloat16) * 6.4)(D, N) * 0.5),
            "A_imag": _w((lambda *s: torch.randn(*s, dtype=torch.bfloat16) * 0.05)(D, N) * 3.14),
            "C_real": _w((lambda *s: torch.randn(*s, dtype=torch.bfloat16) * 0.2)(D, N) / N ** 0.5),
            "C_imag": _w((lambda *s: torch.randn(*s, dtype=torch.bfloat16) * 0.2)(D, N) / N ** 0.5),
            "log_dt": _w((lambda *s: torch.randn(*s, dtype=torch.bfloat16) * 0.05)(D) * 0.5 - 4.0),
            "D_skip": _w((lambda *s: torch.randn(*s, dtype=torch.bfloat16) * 0.05)(D)),
        }
    _B_in = _B_setup()

    return {
        "A_x": _A_in["x"],
        "A_wqkv": _A_in["wqkv"],
        "A_wo": _A_in["wo"],
        "B_u": _B_in["u"],
        "B_log_A_real": _B_in["log_A_real"],
        "B_A_imag": _B_in["A_imag"],
        "B_C_real": _B_in["C_real"],
        "B_C_imag": _B_in["C_imag"],
        "B_log_dt": _B_in["log_dt"],
        "B_D_skip": _B_in["D_skip"],
        "gate_w": _w((lambda *s: torch.randn(*s, dtype=torch.bfloat16) * 0.05)(576) * 16.0),
    }

def reference(A_x, A_wqkv, A_wo, B_u, B_log_A_real, B_A_imag, B_C_real, B_C_imag, B_log_dt, B_D_skip, gate_w):
    def _A_ref(x, wqkv, wo):
        B, S, D = x.shape
        H = 32; Dh = D // H
        qkv = (lambda x, *d: x.permute(*d))((x @ wqkv).reshape(B, S, 3, H, Dh), 2, 0, 3, 1, 4)
        q, k, v = qkv[0], qkv[1], qkv[2]
        phi = lambda t: torch.where(t > 0, t + 1, torch.exp(t)) + 1e-6
        pq, pk = phi(q), phi(k)
        kv = torch.einsum("bhsd,bhse->bhde", pk, v)
        z = torch.einsum("bhsd->bhd", pk)
        num = torch.einsum("bhqd,bhde->bhqe", pq, kv)
        den = torch.einsum("bhqd,bhd->bhq", pq, z)[..., None] + 1e-6
        o = num / den
        return (lambda x, *d: x.permute(*d))(o, 0, 2, 1, 3).reshape(B, S, D) @ wo

    def _B_ref(u, log_A_real, A_imag, C_real, C_imag, log_dt, D_skip):
        L = u.shape[1]
        dt = torch.exp(log_dt)
        A = -torch.exp(log_A_real) + 1j * A_imag
        C = (C_real + 1j * C_imag) * dt[:, None]
        pos = (lambda x, dt: x.to(dt))(torch.arange(L), log_dt.dtype)
        P = torch.exp((A * dt[:, None])[:, :, None] * pos[None, None, :])
        K = 2.0 * torch.einsum("dn,dnl->dl", C, P).real
        L2 = 2 * L
        u_t = (lambda x, *d: x.permute(*d))(u, 0, 2, 1)
        Kf = (lambda x, *a, **k: torch.fft.rfft(x.float(), *a, **k))(K, L2)
        Uf = (lambda x, *a, **k: torch.fft.rfft(x.float(), *a, **k))(u_t, L2)
        y = (lambda x, *a, **k: torch.fft.irfft(x, *a, **k).to(torch.bfloat16))(Uf * Kf[None, :, :], L2)[:, :, :L]
        y = (lambda x, *d: x.permute(*d))(y, 0, 2, 1)
        return y + u * D_skip[None, None, :]

    x = A_x
    g = _sigmoid((x * gate_w).sum(-1, keepdims=True))
    a = _A_ref(x, A_wqkv, A_wo)
    b = _B_ref(x, B_log_A_real, B_A_imag, B_C_real, B_C_imag, B_log_dt, B_D_skip)
    return g * a + (1 - g) * b
```

```asm
; @launch grid=(256,1,1) block=(512,1,1) lds=163840
.amdgcn_target "amdgcn-amd-amdhsa--gfx950"
.text
.globl gated_mix__linear_attn_block__ssm_conv_s4d__prompt_kernel
.p2align 8
.type gated_mix__linear_attn_block__ssm_conv_s4d__prompt_kernel,@function
gated_mix__linear_attn_block__ssm_conv_s4d__prompt_kernel:
  s_load_dwordx16 s[16:31], s[0:1], 0
  s_load_dwordx8 s[32:39], s[0:1], 64
  s_load_dwordx4 s[40:43], s[0:1], 96
  s_getpc_b64 s[4:5]
L_pc0:
  v_lshrrev_b32 v2, 4, v0
  s_bfe_u32 s6, s2, 0x40003
  s_lshl_b32 s6, s6, 12
  v_lshl_add_u32 v2, v2, 7, s6
  v_min_u32 v2, L_code_end-L_pc0-8, v2
  v_lshrrev_b32 v1, 6, v0
  global_load_dword v253, v2, s[4:5]
  s_cmp_lt_u32 s2, 72
  s_cbranch_scc1 L_nsq
  s_lshl_b32 s7, s2, 3
  s_and_b32 s7, s7, 0x7f8
  s_add_u32 s7, s7, L_seqtab-L_pc0
  s_load_dwordx2 s[96:97], s[4:5], s7
  s_cmp_ge_u32 s2, 256
  s_cbranch_scc1 L1_exit
  L_nsq:
  v_readfirstlane_b32 s64, v1
  v_and_b32 v0, 63, v0
  s_and_b32 s3, s2, 7
  s_lshr_b32 s4, s2, 3
  s_mov_b32 s73, 0x3fb8aa3b
  s_cmp_lt_u32 s4, 9
  s_cbranch_scc0 L_nossm
  s_mul_i32 s65, s3, 9
  s_add_u32 s65, s65, s4
  s_lshl_b32 s66, s65, 3
  s_add_u32 s66, s66, s64
  s_lshl_b32 s67, s66, 8
  s_lshl_b32 s68, s66, 1
  s_lshr_b32 s83, s64, 2
  s_xor_b32 s83, s83, 1
  s_cmp_eq_u32 s83, 0
  s_setprio 2
  s_cbranch_scc0 L_np_21
  s_setprio 3
L_np_21:
  v_lshl_add_u32 v16, v0, 2, s67
  v_mov_b32 v17, s68
  s_waitcnt lgkmcnt(0)
  global_load_dword v244, v16, s[24:25] nt
  global_load_ushort v248, v17, s[32:33] nt
  global_load_dword v245, v16, s[26:27] nt
  global_load_ushort v249, v17, s[34:35] nt
  global_load_dword v246, v16, s[28:29] nt
  global_load_dword v247, v16, s[30:31] nt
  s_branch L1_ssm
L_nossm:
  s_cmp_eq_u32 s4, 31
  s_cbranch_scc1 L1_aux
  s_and_b32 s5, s3, 3
  s_lshl_b32 s5, s5, 2
  s_lshr_b32 s6, s3, 2
  s_mov_b32 s10, s4
  s_cmp_lt_u32 s4, 15
  s_cselect_b32 s11, 1, 0
  s_cselect_b32 s7, 6, 16
  s_cselect_b32 s8, 9, 15
  s_mul_i32 s6, s6, s7
  s_sub_u32 s4, s4, s8
  s_add_u32 s4, s4, s6
  s_and_b32 s7, s4, 3
  s_add_u32 s65, s5, s7
  s_lshr_b32 s66, s4, 2
  s_lshr_b32 s7, s64, 2
  s_or_b32 s8, s7, s11
  s_cbranch_scc0 L1_kv_c
  s_cmp_eq_u32 s7, 0
  s_cbranch_scc1 L1_q_c
  s_setprio 3
  s_sub_u32 s86, s64, 4
  s_mul_i32 s69, s65, 147456
  s_lshl_b32 s67, s86, 2
  v_lshrrev_b32 v4, 4, v0
  v_and_b32 v5, 7, v0
  v_xor_b32 v5, v5, v4
  s_and_b32 s70, s67, 1
  s_lshl_b32 s70, s70, 2
  v_xor_b32 v5, s70, v5
  v_lshrrev_b32 v4, 3, v0
  v_mul_u32_u24 v4, 1152, v4
  v_lshl_add_u32 v5, v5, 4, v4
  s_mul_i32 s70, s67, 9216
  s_add_u32 s70, s70, s69
  v_add_u32 v5, s70, v5
  v_xor_b32 v4, 64, v5
  v_add_u32 v10, 0, v5
  v_add_u32 v11, 8192, v4
  v_add_u32 v12, 16384, v5
  v_add_u32 v13, 24576, v4
  s_lshl_b32 s87, s86, 12
  s_cmp_eq_u32 s11, 1
  s_cselect_b32 s5, 24, 18
  s_cselect_b32 s83, 0, 4
  s_cselect_b32 s82, 6, 0
  s_cselect_b32 s6, -910, 0
  s_cselect_b32 s68, 0, 1008
  s_cselect_b32 s14, -1, 0
  s_cselect_b32 s69, 0, 1152
  s_cselect_b32 s67, 240, 0
  s_add_u32 s6, s6, 3641
  s_add_u32 s67, s67, 144
  s_mul_i32 s67, s67, s66
  s_add_u32 s69, s69, s67
  s_mul_i32 s67, s86, 55296
  s_add_u32 s69, s69, s67
  v_mov_b32 v9, s68
  s_lshl_b32 s90, s5, 8
  s_mul_i32 s88, s90, s86
  s_add_u32 s88, s88, 16384
  s_lshl_b32 s90, s5, 10
  s_add_u32 s90, s90, 16384
  s_lshl_b32 s12, s90, 2
  s_mov_b32 s76, 0
  v_and_b32 v1, 30, v0
  v_lshl_add_u32 v1, s86, 5, v1
  s_lshr_b32 s67, s86, 1
  s_mul_i32 s89, s67, 9216
  s_and_b32 s67, s86, 1
  s_lshl_b32 s67, s67, 7
  s_add_u32 s89, s89, s67
  s_add_u32 s89, s89, 139264
  s_lshl_b32 s9, s10, 2
  s_add_u32 s9, s9, s64
  s_sub_u32 s9, s9, 40
  s_mul_i32 s9, s9, 7
  v_lshrrev_b32 v6, 2, v0
  v_add_u32 v6, s9, v6
  v_min_u32 v6, 575, v6
  v_mul_u32_u24 v6, 1152, v6
  s_lshr_b32 s9, s3, 2
  s_mul_i32 s9, s9, 576
  s_and_b32 s8, s3, 1
  s_mul_i32 s13, s8, 320
  s_lshl_b32 s8, s8, 5
  s_add_u32 s8, s8, 256
  s_and_b32 s15, s3, 2
  s_lshl_b32 s15, s15, 6
  s_add_u32 s13, s13, s15
  v_and_b32 v4, 1, v0
  v_mul_u32_u24 v4, 124, v4
  v_add_u32 v4, s13, v4
  v_mov_b32 v5, s8
  v_and_b32 v7, 2, v0
  v_cmp_eq_u32 vcc, 0, v7
  s_nop 1
  v_cndmask_b32 v4, v5, v4, vcc
  v_add3_u32 v250, v4, v6, s9
  s_lshl_b32 s9, s10, 2
  s_add_u32 s9, s9, s64
  s_sub_u32 s9, s9, 40
  s_cmp_lt_u32 s9, 24
  s_cselect_b32 s15, 16, 16
  s_cselect_b32 s8, 0, 0
  s_mul_i32 s9, s9, s15
  s_mul_i32 s9, s9, 1152
  s_add_u32 s9, s9, s8
  s_add_u32 s9, s9, 746496
  s_max_u32 s15, s15, 1
  s_sub_u32 s15, s15, 1
  s_mul_i32 s8, s3, 144
  s_add_u32 s9, s9, s8
  v_lshrrev_b32 v251, 1, v0
  v_min_u32 v251, s15, v251
  v_mul_u32_u24 v251, 1152, v251
  v_and_b32 v252, 1, v0
  v_mul_u32_u24 v252, 140, v252
  v_add_u32 v251, v251, v252
  s_mov_b32 s10, s9
  s_waitcnt lgkmcnt(0)
  s_mov_b64 exec, 0xfffffff
  global_load_dword v250, v250, s[20:21]
  s_mov_b64 exec, -1
  s_waitcnt lgkmcnt(0)
  s_mov_b32 s44, s16
  s_and_b32 s45, s17, 0xffff
  s_mov_b32 s46, 2359296
  s_mov_b32 s47, 0x20000
  s_mov_b32 s75, s96
  s_mov_b32 s71, s97
  buffer_load_dword v253, v251, s[44:47], s10 offen
  s_cmp_eq_u32 s11, 0
  s_cbranch_scc1 L_qd_1
  s_sleep 10
L_qd_1:
  s_lshl_b32 s78, s75, 7
  s_add_u32 m0, s76, s87
  s_mul_i32 s79, s75, 221184
  buffer_load_dwordx4 v10, s[44:47], s78 offen offset:0 lds
  buffer_load_dwordx4 v11, s[44:47], s78 offen offset:1024 lds
  buffer_load_dwordx4 v12, s[44:47], s78 offen offset:2048 lds
  buffer_load_dwordx4 v13, s[44:47], s78 offen offset:3072 lds
  s_add_u32 m0, s76, s88
  s_add_u32 s76, s76, s90
  s_mov_b32 s48, s18
  s_and_b32 s49, s19, 0xffff
  s_mov_b32 s50, 1990656
  s_mov_b32 s51, 0x20000
  v_mul_u32_u24 v5, s6, v0
  v_lshrrev_b32 v5, 16, v5
  v_mul_u32_u24 v6, s5, v5
  v_sub_u32 v6, v0, v6
  v_lshrrev_b32 v7, 1, v5
  v_and_b32 v7, 4, v7
  v_cmp_lt_u32 vcc, 8, v6
  v_and_or_b32 v8, v5, 2, v7
  v_and_b32 v7, s83, v7
  v_and_b32 v8, s82, v8
  v_xor_b32 v5, v5, v7
  v_xor_b32 v6, v6, v8
  v_cndmask_b32 v7, 0, v9, vcc
  v_mul_u32_u24 v8, 3456, v5
  v_lshl_add_u32 v8, v6, 4, v8
  v_add3_u32 v20, v8, v7, s69
  s_sub_u32 s69, s69, 1024
  buffer_load_dwordx4 v20, s[48:51], s79 offen offset:0 lds
  v_add_u32 v4, 64, v0
  v_mul_u32_u24 v5, s6, v4
  v_lshrrev_b32 v5, 16, v5
  v_mul_u32_u24 v6, s5, v5
  v_sub_u32 v6, v4, v6
  v_lshrrev_b32 v7, 1, v5
  v_and_b32 v7, 4, v7
  v_cmp_lt_u32 vcc, 8, v6
  v_and_or_b32 v8, v5, 2, v7
  v_and_b32 v7, s83, v7
  v_and_b32 v8, s82, v8
  v_xor_b32 v5, v5, v7
  v_xor_b32 v6, v6, v8
  v_cndmask_b32 v7, 0, v9, vcc
  v_mul_u32_u24 v8, 3456, v5
  v_lshl_add_u32 v8, v6, 4, v8
  v_add3_u32 v21, v8, v7, s69
  s_sub_u32 s69, s69, 1024
  buffer_load_dwordx4 v21, s[48:51], s79 offen offset:1024 lds
  v_add_u32 v4, 128, v0
  v_mul_u32_u24 v5, s6, v4
  v_lshrrev_b32 v5, 16, v5
  v_mul_u32_u24 v6, s5, v5
  v_sub_u32 v6, v4, v6
  v_lshrrev_b32 v7, 1, v5
  v_and_b32 v7, 4, v7
  v_cmp_lt_u32 vcc, 8, v6
  v_and_or_b32 v8, v5, 2, v7
  v_and_b32 v7, s83, v7
  v_and_b32 v8, s82, v8
  v_xor_b32 v5, v5, v7
  v_xor_b32 v6, v6, v8
  v_cndmask_b32 v7, 0, v9, vcc
  v_mul_u32_u24 v8, 3456, v5
  v_lshl_add_u32 v8, v6, 4, v8
  v_add3_u32 v22, v8, v7, s69
  v_xor_b32 v6, 4, v6
  v_mul_u32_u24 v8, 3456, v5
  v_lshl_add_u32 v8, v6, 4, v8
  v_add_u32 v8, 28672, v8
  v_add_u32 v25, s69, v8
  s_sub_u32 s69, s69, 1024
  buffer_load_dwordx4 v22, s[48:51], s79 offen offset:2048 lds
  v_add_u32 v4, 192, v0
  v_mul_u32_u24 v5, s6, v4
  v_lshrrev_b32 v5, 16, v5
  v_mul_u32_u24 v6, s5, v5
  v_sub_u32 v6, v4, v6
  v_lshrrev_b32 v7, 1, v5
  v_and_b32 v7, 4, v7
  v_cmp_lt_u32 vcc, 8, v6
  v_and_or_b32 v8, v5, 2, v7
  v_and_b32 v7, s83, v7
  v_and_b32 v8, s82, v8
  v_xor_b32 v5, v5, v7
  v_xor_b32 v6, v6, v8
  v_cndmask_b32 v7, 0, v9, vcc
  v_mul_u32_u24 v8, 3456, v5
  v_lshl_add_u32 v8, v6, 4, v8
  v_add3_u32 v23, v8, v7, s69
  s_add_u32 s69, s69, 3072
  buffer_load_dwordx4 v23, s[48:51], s79 offen offset:3072 lds
  v_add_u32 v4, 256, v0
  v_mul_u32_u24 v5, s6, v4
  v_lshrrev_b32 v5, 16, v5
  v_mul_u32_u24 v6, s5, v5
  v_sub_u32 v6, v4, v6
  v_lshrrev_b32 v7, 1, v5
  v_and_b32 v7, 4, v7
  v_cmp_lt_u32 vcc, 8, v6
  v_and_or_b32 v8, v5, 2, v7
  v_and_b32 v7, s83, v7
  v_and_b32 v8, s82, v8
  v_xor_b32 v5, v5, v7
  v_xor_b32 v6, v6, v8
  v_cndmask_b32 v7, 0, v9, vcc
  v_mul_u32_u24 v8, 3456, v5
  v_lshl_add_u32 v8, v6, 4, v8
  v_add3_u32 v24, v8, v7, s69
  s_sub_u32 s69, s69, 1024
  s_add_u32 m0, m0, 4096
  s_mov_b32 exec_hi, s14
  s_cmp_eq_u32 s76, s12
  buffer_load_dwordx4 v24, s[48:51], s79 offen lds
  s_cselect_b32 s76, 0, s76
  s_lshl_b32 s67, s75, 8
  s_and_b32 s75, s71, 15
  s_lshr_b32 s71, s71, 4
  s_mov_b32 s60, s36
  s_and_b32 s61, s37, 0xffff
  s_mov_b32 s62, 1152
  s_mov_b32 s63, 0x20000
  s_mov_b32 exec_hi, -1
  s_cmp_eq_u32 s11, 1
  s_cbranch_scc0 L_iq_2
  buffer_load_dwordx4 v25, s[48:51], s79 offen offset:1024 lds
  s_branch L_ie_3
L_iq_2:
  v_and_b32 v1, 62, v0
  s_and_b32 s67, s86, 1
  s_lshr_b32 s68, s86, 1
  s_mul_i32 s9, s67, 9216
  s_lshl_b32 s67, s67, 6
  s_lshl_b32 s69, s68, 10
  s_add_u32 s9, s9, s69
  s_add_u32 s9, s9, 139264
  s_lshl_b32 s68, s68, 9
  s_add_u32 s68, s68, s67
  s_add_u32 m0, s9, 0
  s_nop 0
  buffer_load_ushort v1, s[60:63], s68 offen offset:0 lds
  s_add_u32 m0, s9, 128
  s_nop 0
  buffer_load_ushort v1, s[60:63], s68 offen offset:128 lds
  s_add_u32 m0, s9, 256
  s_nop 0
  buffer_load_ushort v1, s[60:63], s68 offen offset:256 lds
  s_add_u32 m0, s9, 384
  s_nop 0
  buffer_load_ushort v1, s[60:63], s68 offen offset:384 lds
  s_add_u32 m0, s9, 512
  s_nop 0
  buffer_load_ushort v1, s[60:63], s68 offen offset:512 lds
L_ie_3:
  s_mov_b32 s56, s40
  s_and_b32 s57, s41, 0xffff
  s_mov_b32 s58, 256
  s_mov_b32 s59, 0x20000
  v_mov_b32 v8, 0
  v_mov_b32 v9, 0
  s_mov_b32 s77, 0
L_ld_4:
  s_lshl_b32 s78, s75, 7
  s_add_u32 m0, s76, s87
  s_mul_i32 s79, s75, 221184
  buffer_load_dwordx4 v10, s[44:47], s78 offen offset:0 lds
  buffer_load_dwordx4 v11, s[44:47], s78 offen offset:1024 lds
  buffer_load_dwordx4 v12, s[44:47], s78 offen offset:2048 lds
  buffer_load_dwordx4 v13, s[44:47], s78 offen offset:3072 lds
  s_add_u32 m0, s76, s88
  s_add_u32 s76, s76, s90
  buffer_load_dwordx4 v20, s[48:51], s79 offen offset:0 lds
  buffer_load_dwordx4 v21, s[48:51], s79 offen offset:1024 lds
  buffer_load_dwordx4 v22, s[48:51], s79 offen offset:2048 lds
  buffer_load_dwordx4 v23, s[48:51], s79 offen offset:3072 lds
  s_add_u32 m0, m0, 4096
  s_mov_b32 exec_hi, s14
  s_cmp_eq_u32 s76, s12
  buffer_load_dwordx4 v24, s[48:51], s79 offen lds
  s_cselect_b32 s76, 0, s76
  s_lshl_b32 s67, s75, 8
  s_and_b32 s75, s71, 15
  s_lshr_b32 s71, s71, 4
  s_mov_b32 exec_hi, -1
  s_cmp_eq_u32 s11, 1
  s_cbranch_scc0 L_ie_6
  buffer_load_dwordx4 v25, s[48:51], s79 offen offset:1024 lds
  s_waitcnt vmcnt(10)
  s_branch L_iq_5
L_ie_6:
  s_waitcnt vmcnt(9)
L_iq_5:
  s_add_u32 s77, s77, 1
  s_cmp_lt_u32 s77, 8
  s_waitcnt vmcnt(10)
  s_cbranch_scc1 1
  s_waitcnt vmcnt(10)
  s_barrier
  s_cbranch_scc1 L_ld_4
L_ldx:
  s_mov_b32 s97, 1
  s_mov_b32 s96, 41024
  s_mov_b32 s101, 1
  s_mov_b32 s91, 0x100
  s_mov_b32 s98, 0
  s_mov_b32 s99, 0
  s_mov_b32 s100, 0
  v_readfirstlane_b32 s67, v9
  v_mov_b32 v4, 40960
  v_mov_b32 v6, 0
  v_mov_b32 v7, 0
  v_mov_b32 v5, 0xff
  ds_write_b64 v4, v[6:7]
  ds_write_b64 v4, v[6:7] offset:8
  ds_write_b64 v4, v[6:7] offset:24
  ds_write_b64 v4, v[6:7] offset:32
  s_cmp_ge_u32 s67, 8
  s_cbranch_scc1 L_p2
  buffer_load_dword v9, v8, s[56:59], 0 offen sc1
  s_mov_b32 s101, 0
  s_waitcnt vmcnt(1) lgkmcnt(0)
  s_barrier
  s_mov_b32 s77, 0
  s_waitcnt vmcnt(0)
L_zp_7:
  v_readfirstlane_b32 s67, v9
  s_cmp_ge_u32 s67, 8
  s_cbranch_scc1 L_ze_8
  s_add_u32 s77, s77, 1
  s_cmp_gt_u32 s77, 8192
  s_cbranch_scc1 L_ze_8

  buffer_load_dword v9, v8, s[56:59], 0 offen offset:0 sc0 sc1
  s_waitcnt vmcnt(0)
  s_branch L_zp_7
L_ze_8:
  s_branch L_p2
L1_aux:
  s_lshr_b32 s5, s64, 2
  s_and_b32 s6, s3, 1
  s_and_b32 s8, s64, 1
  s_and_b32 s67, s3, 2
  s_add_u32 s8, s8, s67
  s_lshr_b32 s67, s3, 2
  s_lshl_b32 s67, s67, 1
  s_add_u32 s66, s67, s6
  s_mul_i32 s67, s66, 288
  s_mul_i32 s68, s5, 331776
  s_add_u32 s67, s67, s68
  s_lshl_b32 s68, s8, 6
  s_lshl_b32 s69, s6, 5
  s_add_u32 s79, s67, s68
  s_add_u32 s79, s79, s69
  s_mul_i32 s12, s8, 82944
  s_add_u32 s12, s12, s67
  s_lshl_b32 s69, s6, 8
  s_sub_u32 s12, s12, s69
  s_add_u32 s12, s12, 256
  s_mul_i32 s11, s64, 11264
  s_add_u32 s11, s11, 71680
  v_lshrrev_b32 v2, 2, v0
  v_and_b32 v3, 3, v0
  v_lshlrev_b32 v3, 4, v3
  v_mul_u32_u24 v2, 1152, v2
  v_add_u32 v20, v2, v3
  v_mov_b32 v4, 40960
  v_mov_b32 v8, 0
  v_mov_b32 v9, 0
  v_mov_b32 v10, 0
  v_mov_b32 v11, 0
  ds_write_b128 v4, v[8:11]
  ds_write_b128 v4, v[8:11] offset:16
  ds_write_b128 v4, v[8:11] offset:32
  v_mov_b32 v5, 4
  ds_write_b32 v4, v5
  s_waitcnt lgkmcnt(0)
  s_barrier
  s_mov_b32 s48, s20
  s_and_b32 s49, s21, 0xffff
  s_mov_b32 s50, 663552
  s_mov_b32 s51, 0x20000
  s_cmp_lt_u32 s64, 4
  s_cbranch_scc1 L_p0_11
  s_sleep 16
L_p0_11:
  s_bitcmp1_b32 s64, 1
  s_cbranch_scc1 L_ph_9
  s_xor_b32 s13, s8, 0
  s_mul_i32 s13, s13, 82944
  s_add_u32 s13, s13, s79
  s_add_u32 m0, s11, 0
  s_add_u32 s68, s13, 0
  buffer_load_dwordx4 v20, s[48:51], s68 offen lds
  s_add_u32 m0, s11, 1024
  s_add_u32 s68, s13, 23040
  buffer_load_dwordx4 v20, s[48:51], s68 offen lds
  s_add_u32 m0, s11, 2048
  s_add_u32 s68, s13, 41472
  buffer_load_dwordx4 v20, s[48:51], s68 offen lds
  s_add_u32 m0, s11, 3072
  s_add_u32 s68, s13, 64512
  buffer_load_dwordx4 v20, s[48:51], s68 offen lds
  s_xor_b32 s13, s8, 1
  s_mul_i32 s13, s13, 82944
  s_add_u32 s13, s13, s79
  s_add_u32 m0, s11, 4096
  s_add_u32 s68, s13, 0
  buffer_load_dwordx4 v20, s[48:51], s68 offen lds
  s_add_u32 m0, s11, 5120
  s_add_u32 s68, s13, 23040
  buffer_load_dwordx4 v20, s[48:51], s68 offen lds
  s_add_u32 m0, s11, 6144
  s_add_u32 s68, s13, 41472
  buffer_load_dwordx4 v20, s[48:51], s68 offen lds
  s_add_u32 m0, s11, 7168
  s_add_u32 s68, s13, 64512
  buffer_load_dwordx4 v20, s[48:51], s68 offen lds
  s_xor_b32 s13, s8, 2
  s_mul_i32 s13, s13, 82944
  s_add_u32 s13, s13, s79
  s_add_u32 m0, s11, 8192
  s_add_u32 s68, s13, 0
  buffer_load_dwordx4 v20, s[48:51], s68 offen lds
  s_add_u32 m0, s11, 9216
  s_add_u32 s68, s13, 23040
  buffer_load_dwordx4 v20, s[48:51], s68 offen lds
  v_bfe_u32 v4, v0, 3, 1
  v_mul_u32_u24 v4, 36, v4
  v_lshrrev_b32 v2, 4, v0
  v_mul_u32_u24 v2, 72, v2
  v_bfe_u32 v5, v0, 2, 1
  v_lshl_add_u32 v4, v5, 1, v4
  v_add3_u32 v4, v4, v2, 16
  v_mul_u32_u24 v4, 1152, v4
  v_add_u32 v21, v4, v3
  v_lshrrev_b32 v2, 1, v0
  v_lshrrev_b32 v4, 5, v0
  v_lshl_add_u32 v2, v4, 2, v2
  v_and_b32 v3, 1, v0
  v_lshlrev_b32 v3, 4, v3
  v_mul_u32_u24 v2, 1152, v2
  v_add_u32 v22, v2, v3
  v_mul_u32_u24 v5, 36, v5
  v_and_b32 v2, 2, v0
  v_bfe_u32 v4, v0, 3, 1
  v_add3_u32 v2, v2, v4, v5
  v_add_u32 v2, 16, v2
  v_mul_u32_u24 v2, 1152, v2
  v_add_u32 v23, v2, v3
  v_lshlrev_b32 v1, 4, v0
  v_lshlrev_b32 v7, 3, v0
  v_add_u32 v12, s11, v1
  v_add_u32 v13, s11, v7
  s_mov_b32 s97, 1
  s_mov_b32 s96, 41024
  s_mov_b32 s101, 0
  s_mov_b32 s91, 0x100
  s_mov_b32 s98, 0
  s_mov_b32 s99, 0
  s_mov_b32 s100, 0
  s_lshl_b32 s67, s66, 3
  s_lshl_b32 s68, s5, 2
  s_add_u32 s67, s67, s68
  s_add_u32 s67, s67, s8
  s_mul_i32 s78, s67, 20736
  s_add_u32 s78, s78, 6291456
  s_waitcnt lgkmcnt(0)
  s_mov_b32 s52, s42
  s_and_b32 s53, s43, 0xffff
  s_mov_b32 s54, 9764864
  s_mov_b32 s55, 0x20000
  s_mov_b32 s56, s40
  s_and_b32 s57, s41, 0xffff
  s_mov_b32 s58, 256
  s_mov_b32 s59, 0x20000
  s_cmp_ge_u32 s64, 4
  s_cbranch_scc1 L_nz_12
  s_and_b32 s69, s64, 1
  s_mul_i32 s68, s3, 6144
  s_mul_i32 s69, s69, 3072
  s_add_u32 s68, s68, s69
  s_add_u32 s68, s68, 2359296
  buffer_store_dwordx4 v[8:11], v1, s[52:55], s68 offen offset:0 sc0 sc1
  buffer_store_dwordx4 v[8:11], v1, s[52:55], s68 offen offset:1024 sc0 sc1
  buffer_store_dwordx4 v[8:11], v1, s[52:55], s68 offen offset:2048 sc0 sc1
L_nz_12:
  s_waitcnt vmcnt(8)
  ds_read_b64_tr_b16 v[40:41], v12 offset:0
  ds_read_b64_tr_b16 v[42:43], v12 offset:1024
  ds_read_b64_tr_b16 v[44:45], v12 offset:8
  ds_read_b64_tr_b16 v[46:47], v12 offset:1032
  s_add_u32 s68, s78, 0
  s_waitcnt lgkmcnt(2)
  buffer_store_dwordx4 v[40:43], v1, s[52:55], s68 offen offset:0 sc0 sc1
  s_waitcnt lgkmcnt(0)
  buffer_store_dwordx4 v[44:47], v1, s[52:55], s68 offen offset:1024 sc0 sc1
  s_waitcnt vmcnt(8)
  ds_read_b64_tr_b16 v[48:49], v12 offset:2048
  ds_read_b64_tr_b16 v[50:51], v12 offset:3072
  ds_read_b64_tr_b16 v[52:53], v12 offset:2056
  ds_read_b64_tr_b16 v[54:55], v12 offset:3080
  s_add_u32 s68, s78, 2048
  s_waitcnt lgkmcnt(2)
  buffer_store_dwordx4 v[48:51], v1, s[52:55], s68 offen offset:0 sc0 sc1
  s_waitcnt lgkmcnt(0)
  buffer_store_dwordx4 v[52:55], v1, s[52:55], s68 offen offset:1024 sc0 sc1
  s_waitcnt vmcnt(8)
  ds_read_b64_tr_b16 v[56:57], v12 offset:4096
  ds_read_b64_tr_b16 v[58:59], v12 offset:5120
  ds_read_b64_tr_b16 v[60:61], v12 offset:4104
  ds_read_b64_tr_b16 v[62:63], v12 offset:5128
  s_add_u32 s68, s78, 4096
  s_waitcnt lgkmcnt(2)
  buffer_store_dwordx4 v[56:59], v1, s[52:55], s68 offen offset:0 sc0 sc1
  s_waitcnt lgkmcnt(0)
  buffer_store_dwordx4 v[60:63], v1, s[52:55], s68 offen offset:1024 sc0 sc1
  s_waitcnt vmcnt(8)
  ds_read_b64_tr_b16 v[64:65], v12 offset:6144
  ds_read_b64_tr_b16 v[66:67], v12 offset:7168
  ds_read_b64_tr_b16 v[68:69], v12 offset:6152
  ds_read_b64_tr_b16 v[70:71], v12 offset:7176
  s_add_u32 s68, s78, 6144
  s_waitcnt lgkmcnt(2)
  buffer_store_dwordx4 v[64:67], v1, s[52:55], s68 offen offset:0 sc0 sc1
  s_waitcnt lgkmcnt(0)
  buffer_store_dwordx4 v[68:71], v1, s[52:55], s68 offen offset:1024 sc0 sc1
  s_waitcnt vmcnt(8)
  ds_read_b64_tr_b16 v[72:73], v12 offset:8192
  ds_read_b64_tr_b16 v[74:75], v12 offset:9216
  ds_read_b64_tr_b16 v[76:77], v12 offset:8200
  ds_read_b64_tr_b16 v[78:79], v12 offset:9224
  s_add_u32 s68, s78, 8192
  s_waitcnt lgkmcnt(2)
  buffer_store_dwordx4 v[72:75], v1, s[52:55], s68 offen offset:0 sc0 sc1
  s_waitcnt lgkmcnt(0)
  buffer_store_dwordx4 v[76:79], v1, s[52:55], s68 offen offset:1024 sc0 sc1
  s_branch L_pd_10
L_ph_9:
  s_xor_b32 s13, s8, 2
  s_mul_i32 s13, s13, 82944
  s_add_u32 s13, s13, s79
  s_add_u32 m0, s11, 0
  s_add_u32 s68, s13, 41472
  buffer_load_dwordx4 v20, s[48:51], s68 offen lds
  s_add_u32 m0, s11, 1024
  s_add_u32 s68, s13, 64512
  buffer_load_dwordx4 v20, s[48:51], s68 offen lds
  s_xor_b32 s13, s8, 3
  s_mul_i32 s13, s13, 82944
  s_add_u32 s13, s13, s79
  s_add_u32 m0, s11, 2048
  s_add_u32 s68, s13, 0
  buffer_load_dwordx4 v20, s[48:51], s68 offen lds
  s_add_u32 m0, s11, 3072
  s_add_u32 s68, s13, 23040
  buffer_load_dwordx4 v20, s[48:51], s68 offen lds
  s_add_u32 m0, s11, 4096
  s_add_u32 s68, s13, 41472
  buffer_load_dwordx4 v20, s[48:51], s68 offen lds
  s_add_u32 m0, s11, 5120
  s_add_u32 s68, s13, 64512
  buffer_load_dwordx4 v20, s[48:51], s68 offen lds
  v_bfe_u32 v4, v0, 3, 1
  v_mul_u32_u24 v4, 36, v4
  v_lshrrev_b32 v2, 4, v0
  v_mul_u32_u24 v2, 72, v2
  v_bfe_u32 v5, v0, 2, 1
  v_lshl_add_u32 v4, v5, 1, v4
  v_add3_u32 v4, v4, v2, 16
  v_mul_u32_u24 v4, 1152, v4
  v_add_u32 v21, v4, v3
  v_lshrrev_b32 v2, 1, v0
  v_lshrrev_b32 v4, 5, v0
  v_lshl_add_u32 v2, v4, 2, v2
  v_and_b32 v3, 1, v0
  v_lshlrev_b32 v3, 4, v3
  v_mul_u32_u24 v2, 1152, v2
  v_add_u32 v22, v2, v3
  v_mul_u32_u24 v5, 36, v5
  v_and_b32 v2, 2, v0
  v_bfe_u32 v4, v0, 3, 1
  v_add3_u32 v2, v2, v4, v5
  v_add_u32 v2, 16, v2
  v_mul_u32_u24 v2, 1152, v2
  v_add_u32 v23, v2, v3
  v_lshlrev_b32 v1, 4, v0
  v_lshlrev_b32 v7, 3, v0
  v_add_u32 v12, s11, v1
  v_add_u32 v13, s11, v7
  s_mov_b32 s97, 1
  s_mov_b32 s96, 41024
  s_mov_b32 s101, 0
  s_mov_b32 s91, 0x100
  s_mov_b32 s98, 0
  s_mov_b32 s99, 0
  s_mov_b32 s100, 0
  s_lshl_b32 s67, s66, 3
  s_lshl_b32 s68, s5, 2
  s_add_u32 s67, s67, s68
  s_add_u32 s67, s67, s8
  s_mul_i32 s78, s67, 20736
  s_add_u32 s78, s78, 6291456
  s_add_u32 m0, s11, 6144
  s_add_u32 s68, s79, 0
  buffer_load_dwordx4 v21, s[48:51], s68 offen lds
  s_add_u32 m0, s11, 7168
  s_add_u32 s68, s79, 1152
  buffer_load_dwordx4 v21, s[48:51], s68 offen lds
  s_add_u32 m0, s11, 8192
  s_add_u32 s68, s12, 0
  buffer_load_dwordx4 v22, s[48:51], s68 offen lds
  s_add_u32 m0, s11, 9216
  s_add_u32 s68, s12, 41472
  buffer_load_dwordx4 v22, s[48:51], s68 offen lds
  s_add_u32 m0, s11, 10240
  s_add_u32 s68, s12, 0
  buffer_load_dwordx4 v23, s[48:51], s68 offen lds
  s_waitcnt lgkmcnt(0)
  s_mov_b32 s52, s42
  s_and_b32 s53, s43, 0xffff
  s_mov_b32 s54, 9764864
  s_mov_b32 s55, 0x20000
  s_mov_b32 s56, s40
  s_and_b32 s57, s41, 0xffff
  s_mov_b32 s58, 256
  s_mov_b32 s59, 0x20000
  s_cmp_ge_u32 s64, 4
  s_cbranch_scc1 L_nz_13
  s_and_b32 s69, s64, 1
  s_mul_i32 s68, s3, 12544
  s_add_u32 s68, s68, 4849664
  v_lshl_add_u32 v2, s69, 6, v0
  v_add_u32 v3, 0, v2
  v_cmp_gt_u32 vcc, 49, v3
  v_lshlrev_b32 v3, 8, v3
  s_and_b64 exec, vcc, -1
  s_cbranch_execz 2
  buffer_store_dword v8, v3, s[52:55], s68 offen sc0 sc1
  s_mov_b64 exec, -1
L_nz_13:
  s_waitcnt vmcnt(9)
  ds_read_b64_tr_b16 v[80:81], v12 offset:0
  ds_read_b64_tr_b16 v[82:83], v12 offset:1024
  ds_read_b64_tr_b16 v[84:85], v12 offset:8
  ds_read_b64_tr_b16 v[86:87], v12 offset:1032
  s_add_u32 s68, s78, 10240
  s_waitcnt lgkmcnt(2)
  buffer_store_dwordx4 v[80:83], v1, s[52:55], s68 offen offset:0 sc0 sc1
  s_waitcnt lgkmcnt(0)
  buffer_store_dwordx4 v[84:87], v1, s[52:55], s68 offen offset:1024 sc0 sc1
  s_waitcnt vmcnt(9)
  ds_read_b64_tr_b16 v[88:89], v12 offset:2048
  ds_read_b64_tr_b16 v[90:91], v12 offset:3072
  ds_read_b64_tr_b16 v[92:93], v12 offset:2056
  ds_read_b64_tr_b16 v[94:95], v12 offset:3080
  s_add_u32 s68, s78, 12288
  s_waitcnt lgkmcnt(2)
  buffer_store_dwordx4 v[88:91], v1, s[52:55], s68 offen offset:0 sc0 sc1
  s_waitcnt lgkmcnt(0)
  buffer_store_dwordx4 v[92:95], v1, s[52:55], s68 offen offset:1024 sc0 sc1
  s_waitcnt vmcnt(9)
  ds_read_b64_tr_b16 v[96:97], v12 offset:4096
  ds_read_b64_tr_b16 v[98:99], v12 offset:5120
  ds_read_b64_tr_b16 v[100:101], v12 offset:4104
  ds_read_b64_tr_b16 v[102:103], v12 offset:5128
  s_add_u32 s68, s78, 14336
  s_waitcnt lgkmcnt(2)
  buffer_store_dwordx4 v[96:99], v1, s[52:55], s68 offen offset:0 sc0 sc1
  s_waitcnt lgkmcnt(0)
  buffer_store_dwordx4 v[100:103], v1, s[52:55], s68 offen offset:1024 sc0 sc1
  s_waitcnt vmcnt(9)
  ds_read_b64_tr_b16 v[104:105], v12 offset:6144
  ds_read_b64_tr_b16 v[106:107], v12 offset:7168
  ds_read_b64_tr_b16 v[108:109], v12 offset:6152
  ds_read_b64_tr_b16 v[110:111], v12 offset:7176
  s_add_u32 s68, s78, 16384
  s_waitcnt lgkmcnt(2)
  buffer_store_dwordx4 v[104:107], v1, s[52:55], s68 offen offset:0 sc0 sc1
  s_waitcnt lgkmcnt(0)
  buffer_store_dwordx4 v[108:111], v1, s[52:55], s68 offen offset:1024 sc0 sc1
  s_waitcnt vmcnt(9)
  ds_read_b64_tr_b16 v[112:113], v13 offset:8192
  ds_read_b64_tr_b16 v[114:115], v13 offset:8704
  ds_read_b64_tr_b16 v[116:117], v13 offset:9216
  ds_read_b64_tr_b16 v[118:119], v13 offset:9728
  s_add_u32 s68, s78, 18432
  s_waitcnt lgkmcnt(2)
  buffer_store_dwordx4 v[112:115], v1, s[52:55], s68 offen offset:0 sc0 sc1
  s_waitcnt lgkmcnt(0)
  buffer_store_dwordx4 v[116:119], v1, s[52:55], s68 offen offset:1024 sc0 sc1
  s_waitcnt vmcnt(10)
  ds_read_b64_tr_b16 v[120:121], v13 offset:10240
  s_add_u32 s68, s78, 20480
  s_mov_b32 exec_hi, 0
  s_waitcnt lgkmcnt(0)
  buffer_store_dwordx2 v[120:121], v7, s[52:55], s68 offen sc0 sc1
  s_mov_b64 exec, -1
L_pd_10:
  s_lshr_b32 s68, s64, 2
  s_lshl_b32 s68, s68, 2
  v_mov_b32 v5, s68
  v_add_u32 v4, 40968, v5
  v_mov_b32 v2, 1
  v_mov_b32 v3, 1
  s_mov_b64 exec, 1
  s_waitcnt vmcnt(0)
  ds_add_rtn_u32 v6, v4, v3
  s_waitcnt lgkmcnt(0)
  v_readfirstlane_b32 s67, v6
  s_cmp_lg_u32 s67, 3
  s_cbranch_scc1 L_nf_14

  v_lshlrev_b32 v5, 5, v5
  buffer_atomic_add v2, v5, s[56:59], 0 offen sc1
L_nf_14:
  s_mov_b64 exec, -1
  s_barrier
  s_sleep 8
  s_mov_b32 s77, 0
  s_waitcnt vmcnt(0)
L_zp_15:
  v_readfirstlane_b32 s70, v10
  s_cmp_ge_u32 s70, 8
  s_cbranch_scc1 L_ze_16
  s_add_u32 s77, s77, 1
  s_cmp_gt_u32 s77, 8192
  s_cbranch_scc1 L_ze_16

  buffer_load_dword v10, v8, s[56:59], 0 offen offset:0 sc0 sc1
  s_waitcnt vmcnt(0)
  s_branch L_zp_15
L_ze_16:
  s_mov_b32 s77, 0
  s_waitcnt vmcnt(0)
L_zp_17:
  v_readfirstlane_b32 s70, v11
  s_cmp_ge_u32 s70, 8
  s_cbranch_scc1 L_ze_18
  s_add_u32 s77, s77, 1
  s_cmp_gt_u32 s77, 8192
  s_cbranch_scc1 L_ze_18

  buffer_load_dword v11, v8, s[56:59], 0 offen offset:128 sc0 sc1
  s_waitcnt vmcnt(0)
  s_branch L_zp_17
L_ze_18:
  s_and_b32 s8, s64, 3
  s_cmp_ge_u32 s64, 4
  s_cbranch_scc1 L_nw_19
  s_lshr_b32 s67, s3, 2
  s_lshl_b32 s67, s67, 4
  s_add_u32 s67, s67, s64
  s_mul_i32 s67, s67, 20736
  s_add_u32 s67, s67, 6374400
  s_mov_b32 s77, 0
L_pf_20:
  buffer_load_dwordx4 v[12:15], v1, s[52:55], s67 offen sc1
  s_add_u32 s67, s67, 1024
  s_add_u32 s77, s77, 1
  s_cmp_lt_u32 s77, 21
  s_cbranch_scc1 L_pf_20
  s_waitcnt vmcnt(0)
L_nw_19:
  s_branch L_p2
.p2align 3
L1_ssm:
  s_mul_i32 s9, s64, 9
  s_add_u32 s9, s9, s4
  s_mul_i32 s9, s9, 10368
  s_mov_b32 s14, 8
  s_mul_i32 s8, s3, 144
  s_add_u32 s9, s9, s8
  v_lshrrev_b32 v251, 1, v0
  v_min_u32 v251, s14, v251
  v_mul_u32_u24 v251, 1152, v251
  v_and_b32 v252, 1, v0
  v_mul_u32_u24 v252, 140, v252
  v_add_u32 v251, v251, v252
  s_waitcnt lgkmcnt(0)
  s_mov_b32 s44, s16
  s_and_b32 s45, s17, 0xffff
  s_mov_b32 s46, 2359296
  s_mov_b32 s47, 0x20000
  s_mov_b32 s52, s42
  s_and_b32 s53, s43, 0xffff
  s_mov_b32 s54, 9764864
  s_mov_b32 s55, 0x20000
  s_mov_b32 s56, s40
  s_and_b32 s57, s41, 0xffff
  s_mov_b32 s58, 256
  s_mov_b32 s59, 0x20000
  s_mov_b32 s90, s9
  v_mov_b32 v116, 0
  v_mov_b32 v117, 0
  v_mov_b32 v118, 0
  v_mov_b32 v119, 0
  v_mov_b32 v12, 34688
  ds_write_b128 v12, v[116:119]
  ds_write_b128 v12, v[116:119] offset:16
  ds_write_b128 v12, v[116:119] offset:32
  s_lshl_b32 s67, s65, 4
  v_mul_u32_u24 v18, 9216, v0
  v_add_u32 v13, s67, v18
  s_add_u32 s82, s4, s64
  s_and_b32 s82, s82, 3
  s_waitcnt lgkmcnt(0)
  s_barrier
  buffer_load_dword v253, v251, s[44:47], s90 offen
  v_lshlrev_b32 v10, 4, v0
  s_mul_i32 s86, s82, 589824
  s_add_u32 s87, s86, 4608
  v_lshlrev_b32 v10, 4, v0
  s_and_b32 s67, s64, 3
  s_cmp_eq_u32 s83, 0
  s_cselect_b32 s68, 12064, 0
  s_cselect_b32 s75, 41920, 0
  s_cselect_b32 s69, 16064, 0
  s_cselect_b32 s76, -93728, 0
  s_add_u32 s68, s68, 8672
  s_add_u32 s69, s69, 4672
  s_add_u32 s76, s76, 144320
  s_mul_i32 s68, s68, s67
  s_mul_i32 s69, s69, s67
  s_add_u32 s75, s75, s68
  s_add_u32 s76, s76, s69
  s_mov_b32 m0, s75
  s_mov_b32 s97, 0
  s_mov_b32 s96, 34752
  s_mov_b32 s101, 0
  s_mov_b32 s91, 0x101
  s_mov_b32 s98, 8
  s_mov_b32 s99, 0
  s_lshl_b32 s100, s65, 8
  s_add_u32 s100, s100, 4931584
  v_and_b32 v16, 15, v0
  v_lshrrev_b32 v17, 4, v0
  v_mul_u32_u24 v1, 544, v16
  v_lshl_add_u32 v1, v17, 4, v1
  v_add_u32 v1, s75, v1
  v_add_u32 v11, s75, v10
  v_lshl_add_u32 v15, v0, 3, s75
  v_add_u32 v18, s76, v10
  s_mov_b32 exec_hi, 0xf
  ds_write_b128 v18, v[116:119]
  s_mov_b64 exec, -1
  s_cmp_eq_u32 s83, 1
  s_cbranch_scc0 L_pw_22
  s_waitcnt vmcnt(1)
  s_branch L_pw_23
L_pw_22:
  s_waitcnt vmcnt(1)
L_pw_23:
  v_lshlrev_b32 v120, 16, v244
  v_and_b32 v121, 0xffff0000, v244
  v_lshlrev_b32 v122, 16, v248
  v_mul_f32 v120, s73, v120
  v_mul_f32 v121, s73, v121
  v_mul_f32 v122, s73, v122
  v_exp_f32 v120, v120
  v_exp_f32 v121, v121
  v_exp_f32 v122, v122
  v_lshlrev_b32 v124, 16, v245
  v_and_b32 v125, 0xffff0000, v245
  v_cvt_pk_bf16_f32 v121, v120, v121
  v_cvt_pk_bf16_f32 v122, v122, v122
  v_lshlrev_b32 v120, 16, v121
  v_and_b32 v121, 0xffff0000, v121
  v_and_b32 v122, 0xffff0000, v122
  v_mul_f32 v120, v120, v122
  v_mul_f32 v121, v121, v122
  v_mul_f32 v124, v124, v122
  v_mul_f32 v125, v125, v122
  v_mul_f32 v120, s73, v120
  v_mul_f32 v121, s73, v121
  v_mul_f32 v124, 0.15915494, v124
  v_mul_f32 v125, 0.15915494, v125
  v_add_f32 v122, v122, v122
  v_mul_f32 v140, 0x41000000, v120
  v_mul_f32 v142, 0x41000000, v124
  v_mul_f32 v141, 0x41000000, v121
  v_mul_f32 v143, 0x41000000, v125
  v_exp_f32 v140, -v140
  v_fract_f32 v142, v142
  v_exp_f32 v141, -v141
  v_fract_f32 v143, v143
  v_cos_f32 v136, v142
  v_sin_f32 v137, v142
  v_cos_f32 v138, v143
  v_sin_f32 v139, v143
  v_mul_f32 v136, v140, v136
  v_mul_f32 v137, v140, v137
  v_mul_f32 v138, v141, v138
  v_mul_f32 v139, v141, v139
  v_lshlrev_b32 v144, 16, v246
  v_lshlrev_b32 v145, 16, v247
  v_and_b32 v146, 0xffff0000, v246
  v_and_b32 v147, 0xffff0000, v247
  v_mul_f32 v144, v122, v144
  v_mul_f32 v145, v122, v145
  v_mul_f32 v146, v122, v146
  v_mul_f32 v147, v122, v147
  v_pk_mul_f32 v[148:149], v[144:145], v[136:137] op_sel:[1,1] op_sel_hi:[1,0]
  v_pk_mul_f32 v[150:151], v[146:147], v[138:139] op_sel:[1,1] op_sel_hi:[1,0]
  v_cvt_pk_bf16_f32 v128, v144, -v145
  v_cvt_pk_bf16_f32 v129, v146, -v147
  v_pk_fma_f32 v[148:149], v[144:145], v[136:137], v[148:149] op_sel:[0,0,0] op_sel_hi:[0,1,1] neg_lo:[0,0,1]
  v_pk_fma_f32 v[150:151], v[146:147], v[138:139], v[150:151] op_sel:[0,0,0] op_sel_hi:[0,1,1] neg_lo:[0,0,1]
  ds_write_addtid_b32 v128 offset:0
  ds_write_addtid_b32 v129 offset:256
  v_pk_mul_f32 v[152:153], v[148:149], v[136:137] op_sel:[1,1] op_sel_hi:[1,0]
  v_pk_mul_f32 v[154:155], v[150:151], v[138:139] op_sel:[1,1] op_sel_hi:[1,0]
  v_cvt_pk_bf16_f32 v130, v148, -v149
  v_cvt_pk_bf16_f32 v131, v150, -v151
  v_pk_fma_f32 v[152:153], v[148:149], v[136:137], v[152:153] op_sel:[0,0,0] op_sel_hi:[0,1,1] neg_lo:[0,0,1]
  v_pk_fma_f32 v[154:155], v[150:151], v[138:139], v[154:155] op_sel:[0,0,0] op_sel_hi:[0,1,1] neg_lo:[0,0,1]
  ds_write_addtid_b32 v130 offset:4352
  ds_write_addtid_b32 v131 offset:4608
  v_pk_mul_f32 v[156:157], v[152:153], v[136:137] op_sel:[1,1] op_sel_hi:[1,0]
  v_pk_mul_f32 v[158:159], v[154:155], v[138:139] op_sel:[1,1] op_sel_hi:[1,0]
  v_cvt_pk_bf16_f32 v132, v152, -v153
  v_cvt_pk_bf16_f32 v133, v154, -v155
  v_pk_fma_f32 v[156:157], v[152:153], v[136:137], v[156:157] op_sel:[0,0,0] op_sel_hi:[0,1,1] neg_lo:[0,0,1]
  v_pk_fma_f32 v[158:159], v[154:155], v[138:139], v[158:159] op_sel:[0,0,0] op_sel_hi:[0,1,1] neg_lo:[0,0,1]
  ds_write_addtid_b32 v132 offset:544
  ds_write_addtid_b32 v133 offset:800
  v_pk_mul_f32 v[160:161], v[156:157], v[136:137] op_sel:[1,1] op_sel_hi:[1,0]
  v_pk_mul_f32 v[162:163], v[158:159], v[138:139] op_sel:[1,1] op_sel_hi:[1,0]
  v_cvt_pk_bf16_f32 v134, v156, -v157
  v_cvt_pk_bf16_f32 v135, v158, -v159
  v_pk_fma_f32 v[160:161], v[156:157], v[136:137], v[160:161] op_sel:[0,0,0] op_sel_hi:[0,1,1] neg_lo:[0,0,1]
  v_pk_fma_f32 v[162:163], v[158:159], v[138:139], v[162:163] op_sel:[0,0,0] op_sel_hi:[0,1,1] neg_lo:[0,0,1]
  ds_write_addtid_b32 v134 offset:4896
  ds_write_addtid_b32 v135 offset:5152
  v_pk_mul_f32 v[164:165], v[160:161], v[136:137] op_sel:[1,1] op_sel_hi:[1,0]
  v_pk_mul_f32 v[166:167], v[162:163], v[138:139] op_sel:[1,1] op_sel_hi:[1,0]
  v_cvt_pk_bf16_f32 v128, v160, -v161
  v_cvt_pk_bf16_f32 v129, v162, -v163
  v_pk_fma_f32 v[164:165], v[160:161], v[136:137], v[164:165] op_sel:[0,0,0] op_sel_hi:[0,1,1] neg_lo:[0,0,1]
  v_pk_fma_f32 v[166:167], v[162:163], v[138:139], v[166:167] op_sel:[0,0,0] op_sel_hi:[0,1,1] neg_lo:[0,0,1]
  ds_write_addtid_b32 v128 offset:1088
  ds_write_addtid_b32 v129 offset:1344
  v_pk_mul_f32 v[168:169], v[164:165], v[136:137] op_sel:[1,1] op_sel_hi:[1,0]
  v_pk_mul_f32 v[170:171], v[166:167], v[138:139] op_sel:[1,1] op_sel_hi:[1,0]
  v_cvt_pk_bf16_f32 v130, v164, -v165
  v_cvt_pk_bf16_f32 v131, v166, -v167
  v_pk_fma_f32 v[168:169], v[164:165], v[136:137], v[168:169] op_sel:[0,0,0] op_sel_hi:[0,1,1] neg_lo:[0,0,1]
  v_pk_fma_f32 v[170:171], v[166:167], v[138:139], v[170:171] op_sel:[0,0,0] op_sel_hi:[0,1,1] neg_lo:[0,0,1]
  ds_write_addtid_b32 v130 offset:5440
  ds_write_addtid_b32 v131 offset:5696
  v_pk_mul_f32 v[172:173], v[168:169], v[136:137] op_sel:[1,1] op_sel_hi:[1,0]
  v_pk_mul_f32 v[174:175], v[170:171], v[138:139] op_sel:[1,1] op_sel_hi:[1,0]
  v_cvt_pk_bf16_f32 v132, v168, -v169
  v_cvt_pk_bf16_f32 v133, v170, -v171
  v_pk_fma_f32 v[172:173], v[168:169], v[136:137], v[172:173] op_sel:[0,0,0] op_sel_hi:[0,1,1] neg_lo:[0,0,1]
  v_pk_fma_f32 v[174:175], v[170:171], v[138:139], v[174:175] op_sel:[0,0,0] op_sel_hi:[0,1,1] neg_lo:[0,0,1]
  ds_write_addtid_b32 v132 offset:1632
  ds_write_addtid_b32 v133 offset:1888
  v_pk_mul_f32 v[176:177], v[172:173], v[136:137] op_sel:[1,1] op_sel_hi:[1,0]
  v_pk_mul_f32 v[178:179], v[174:175], v[138:139] op_sel:[1,1] op_sel_hi:[1,0]
  v_cvt_pk_bf16_f32 v134, v172, -v173
  v_cvt_pk_bf16_f32 v135, v174, -v175
  v_pk_fma_f32 v[176:177], v[172:173], v[136:137], v[176:177] op_sel:[0,0,0] op_sel_hi:[0,1,1] neg_lo:[0,0,1]
  v_pk_fma_f32 v[178:179], v[174:175], v[138:139], v[178:179] op_sel:[0,0,0] op_sel_hi:[0,1,1] neg_lo:[0,0,1]
  ds_write_addtid_b32 v134 offset:5984
  ds_write_addtid_b32 v135 offset:6240
  v_pk_mul_f32 v[180:181], v[176:177], v[136:137] op_sel:[1,1] op_sel_hi:[1,0]
  v_pk_mul_f32 v[182:183], v[178:179], v[138:139] op_sel:[1,1] op_sel_hi:[1,0]
  v_cvt_pk_bf16_f32 v128, v176, -v177
  v_cvt_pk_bf16_f32 v129, v178, -v179
  v_pk_fma_f32 v[180:181], v[176:177], v[136:137], v[180:181] op_sel:[0,0,0] op_sel_hi:[0,1,1] neg_lo:[0,0,1]
  v_pk_fma_f32 v[182:183], v[178:179], v[138:139], v[182:183] op_sel:[0,0,0] op_sel_hi:[0,1,1] neg_lo:[0,0,1]
  ds_write_addtid_b32 v128 offset:2176
  ds_write_addtid_b32 v129 offset:2432
  v_pk_mul_f32 v[184:185], v[180:181], v[136:137] op_sel:[1,1] op_sel_hi:[1,0]
  v_pk_mul_f32 v[186:187], v[182:183], v[138:139] op_sel:[1,1] op_sel_hi:[1,0]
  v_cvt_pk_bf16_f32 v130, v180, -v181
  v_cvt_pk_bf16_f32 v131, v182, -v183
  v_pk_fma_f32 v[184:185], v[180:181], v[136:137], v[184:185] op_sel:[0,0,0] op_sel_hi:[0,1,1] neg_lo:[0,0,1]
  v_pk_fma_f32 v[186:187], v[182:183], v[138:139], v[186:187] op_sel:[0,0,0] op_sel_hi:[0,1,1] neg_lo:[0,0,1]
  ds_write_addtid_b32 v130 offset:6528
  ds_write_addtid_b32 v131 offset:6784
  s_cmp_eq_u32 s83, 0
  s_cbranch_scc0 L_na_24
  buffer_load_dwordx4 v[196:199], v13, s[44:47], s86 offen offset:0
  buffer_load_dwordx4 v[200:203], v13, s[44:47], s86 offen offset:1152
L_na_24:
  v_pk_mul_f32 v[188:189], v[184:185], v[136:137] op_sel:[1,1] op_sel_hi:[1,0]
  v_pk_mul_f32 v[190:191], v[186:187], v[138:139] op_sel:[1,1] op_sel_hi:[1,0]
  v_cvt_pk_bf16_f32 v132, v184, -v185
  v_cvt_pk_bf16_f32 v133, v186, -v187
  v_pk_fma_f32 v[188:189], v[184:185], v[136:137], v[188:189] op_sel:[0,0,0] op_sel_hi:[0,1,1] neg_lo:[0,0,1]
  v_pk_fma_f32 v[190:191], v[186:187], v[138:139], v[190:191] op_sel:[0,0,0] op_sel_hi:[0,1,1] neg_lo:[0,0,1]
  ds_write_addtid_b32 v132 offset:2720
  ds_write_addtid_b32 v133 offset:2976
  v_pk_mul_f32 v[192:193], v[188:189], v[136:137] op_sel:[1,1] op_sel_hi:[1,0]
  v_pk_mul_f32 v[194:195], v[190:191], v[138:139] op_sel:[1,1] op_sel_hi:[1,0]
  v_cvt_pk_bf16_f32 v134, v188, -v189
  v_cvt_pk_bf16_f32 v135, v190, -v191
  v_pk_fma_f32 v[192:193], v[188:189], v[136:137], v[192:193] op_sel:[0,0,0] op_sel_hi:[0,1,1] neg_lo:[0,0,1]
  v_pk_fma_f32 v[194:195], v[190:191], v[138:139], v[194:195] op_sel:[0,0,0] op_sel_hi:[0,1,1] neg_lo:[0,0,1]
  ds_write_addtid_b32 v134 offset:7072
  ds_write_addtid_b32 v135 offset:7328
  v_pk_mul_f32 v[228:229], v[192:193], v[136:137] op_sel:[1,1] op_sel_hi:[1,0]
  v_pk_mul_f32 v[230:231], v[194:195], v[138:139] op_sel:[1,1] op_sel_hi:[1,0]
  v_cvt_pk_bf16_f32 v128, v192, -v193
  v_cvt_pk_bf16_f32 v129, v194, -v195
  v_pk_fma_f32 v[228:229], v[192:193], v[136:137], v[228:229] op_sel:[0,0,0] op_sel_hi:[0,1,1] neg_lo:[0,0,1]
  v_pk_fma_f32 v[230:231], v[194:195], v[138:139], v[230:231] op_sel:[0,0,0] op_sel_hi:[0,1,1] neg_lo:[0,0,1]
  ds_write_addtid_b32 v128 offset:3264
  ds_write_addtid_b32 v129 offset:3520
  v_pk_mul_f32 v[232:233], v[228:229], v[136:137] op_sel:[1,1] op_sel_hi:[1,0]
  v_pk_mul_f32 v[234:235], v[230:231], v[138:139] op_sel:[1,1] op_sel_hi:[1,0]
  v_cvt_pk_bf16_f32 v130, v228, -v229
  v_cvt_pk_bf16_f32 v131, v230, -v231
  v_pk_fma_f32 v[232:233], v[228:229], v[136:137], v[232:233] op_sel:[0,0,0] op_sel_hi:[0,1,1] neg_lo:[0,0,1]
  v_pk_fma_f32 v[234:235], v[230:231], v[138:139], v[234:235] op_sel:[0,0,0] op_sel_hi:[0,1,1] neg_lo:[0,0,1]
  ds_write_addtid_b32 v130 offset:7616
  ds_write_addtid_b32 v131 offset:7872
  v_pk_mul_f32 v[236:237], v[232:233], v[136:137] op_sel:[1,1] op_sel_hi:[1,0]
  v_pk_mul_f32 v[238:239], v[234:235], v[138:139] op_sel:[1,1] op_sel_hi:[1,0]
  v_cvt_pk_bf16_f32 v132, v232, -v233
  v_cvt_pk_bf16_f32 v133, v234, -v235
  v_pk_fma_f32 v[236:237], v[232:233], v[136:137], v[236:237] op_sel:[0,0,0] op_sel_hi:[0,1,1] neg_lo:[0,0,1]
  v_pk_fma_f32 v[238:239], v[234:235], v[138:139], v[238:239] op_sel:[0,0,0] op_sel_hi:[0,1,1] neg_lo:[0,0,1]
  ds_write_addtid_b32 v132 offset:3808
  ds_write_addtid_b32 v133 offset:4064
  v_cvt_pk_bf16_f32 v134, v236, -v237
  v_cvt_pk_bf16_f32 v135, v238, -v239
  ds_write_addtid_b32 v134 offset:8160
  ds_write_addtid_b32 v135 offset:8416
  ds_read_b128 v[44:47], v1 offset:0
  ds_read_b128 v[48:51], v1 offset:64
  ds_read_b128 v[52:55], v1 offset:128
  ds_read_b128 v[56:59], v1 offset:192
  ds_read_b128 v[60:63], v1 offset:256
  ds_read_b128 v[64:67], v1 offset:320
  ds_read_b128 v[68:71], v1 offset:384
  ds_read_b128 v[72:75], v1 offset:448
  s_cmp_eq_u32 s83, 0
  s_cbranch_scc0 L_tb_25
  s_cmp_eq_u32 s83, 0
  s_cbranch_scc0 L_na_27
  buffer_load_dwordx4 v[204:207], v13, s[44:47], s86 offen offset:2304
  buffer_load_dwordx4 v[208:211], v13, s[44:47], s86 offen offset:3456
L_na_27:
  v_mul_f32 v144, 0x3f800000, v120
  v_mul_f32 v146, 0x3f800000, v124
  v_mul_f32 v145, 0x3f800000, v121
  v_mul_f32 v147, 0x3f800000, v125
  v_exp_f32 v144, -v144
  v_fract_f32 v146, v146
  v_exp_f32 v145, -v145
  v_fract_f32 v147, v147
  v_cos_f32 v140, v146
  v_sin_f32 v141, v146
  v_cos_f32 v142, v147
  v_sin_f32 v143, v147
  v_mul_f32 v140, v144, v140
  v_mul_f32 v141, v144, v141
  v_mul_f32 v142, v145, v142
  v_mul_f32 v143, v145, v143
  v_mul_f32 v152, 0x43000000, v120
  v_mul_f32 v154, 0x43000000, v124
  v_mul_f32 v153, 0x43000000, v121
  v_mul_f32 v155, 0x43000000, v125
  v_exp_f32 v152, -v152
  v_fract_f32 v154, v154
  v_exp_f32 v153, -v153
  v_fract_f32 v155, v155
  v_cos_f32 v148, v154
  v_sin_f32 v149, v154
  v_cos_f32 v150, v155
  v_sin_f32 v151, v155
  v_mul_f32 v148, v152, v148
  v_mul_f32 v149, v152, v149
  v_mul_f32 v150, v153, v150
  v_mul_f32 v151, v153, v151
  v_mov_b32 v18, 0x3f80
  ds_write_addtid_b32 v18
  ds_write_addtid_b32 v18 offset:256
  v_pk_mul_f32 v[156:157], v[140:141], v[148:149] op_sel:[1,1] op_sel_hi:[1,0]
  v_pk_mul_f32 v[158:159], v[142:143], v[150:151] op_sel:[1,1] op_sel_hi:[1,0]
  v_cvt_pk_bf16_f32 v128, v148, v149
  v_cvt_pk_bf16_f32 v129, v150, v151
  v_pk_fma_f32 v[156:157], v[140:141], v[148:149], v[156:157] op_sel:[0,0,0] op_sel_hi:[0,1,1] neg_lo:[0,0,1]
  v_pk_fma_f32 v[158:159], v[142:143], v[150:151], v[158:159] op_sel:[0,0,0] op_sel_hi:[0,1,1] neg_lo:[0,0,1]
  ds_write_addtid_b32 v128 offset:4352
  ds_write_addtid_b32 v129 offset:4608
  s_cmp_eq_u32 s83, 0
  s_cbranch_scc0 L_na_28
  buffer_load_dwordx4 v[212:215], v13, s[44:47], s87 offen offset:0
  buffer_load_dwordx4 v[216:219], v13, s[44:47], s87 offen offset:1152
L_na_28:
  v_pk_mul_f32 v[160:161], v[140:141], v[140:141] op_sel:[1,1] op_sel_hi:[1,0]
  v_pk_mul_f32 v[162:163], v[142:143], v[142:143] op_sel:[1,1] op_sel_hi:[1,0]
  v_cvt_pk_bf16_f32 v130, v140, v141
  v_cvt_pk_bf16_f32 v131, v142, v143
  v_pk_fma_f32 v[160:161], v[140:141], v[140:141], v[160:161] op_sel:[0,0,0] op_sel_hi:[0,1,1] neg_lo:[0,0,1]
  v_pk_fma_f32 v[162:163], v[142:143], v[142:143], v[162:163] op_sel:[0,0,0] op_sel_hi:[0,1,1] neg_lo:[0,0,1]
  ds_write_addtid_b32 v130 offset:544
  ds_write_addtid_b32 v131 offset:800
  v_pk_mul_f32 v[164:165], v[160:161], v[148:149] op_sel:[1,1] op_sel_hi:[1,0]
  v_pk_mul_f32 v[166:167], v[162:163], v[150:151] op_sel:[1,1] op_sel_hi:[1,0]
  v_cvt_pk_bf16_f32 v132, v156, v157
  v_cvt_pk_bf16_f32 v133, v158, v159
  v_pk_fma_f32 v[164:165], v[160:161], v[148:149], v[164:165] op_sel:[0,0,0] op_sel_hi:[0,1,1] neg_lo:[0,0,1]
  v_pk_fma_f32 v[166:167], v[162:163], v[150:151], v[166:167] op_sel:[0,0,0] op_sel_hi:[0,1,1] neg_lo:[0,0,1]
  ds_write_addtid_b32 v132 offset:4896
  ds_write_addtid_b32 v133 offset:5152
  v_pk_mul_f32 v[168:169], v[160:161], v[140:141] op_sel:[1,1] op_sel_hi:[1,0]
  v_pk_mul_f32 v[170:171], v[162:163], v[142:143] op_sel:[1,1] op_sel_hi:[1,0]
  v_cvt_pk_bf16_f32 v134, v160, v161
  v_cvt_pk_bf16_f32 v135, v162, v163
  v_pk_fma_f32 v[168:169], v[160:161], v[140:141], v[168:169] op_sel:[0,0,0] op_sel_hi:[0,1,1] neg_lo:[0,0,1]
  v_pk_fma_f32 v[170:171], v[162:163], v[142:143], v[170:171] op_sel:[0,0,0] op_sel_hi:[0,1,1] neg_lo:[0,0,1]
  ds_write_addtid_b32 v134 offset:1088
  ds_write_addtid_b32 v135 offset:1344
  v_pk_mul_f32 v[172:173], v[168:169], v[148:149] op_sel:[1,1] op_sel_hi:[1,0]
  v_pk_mul_f32 v[174:175], v[170:171], v[150:151] op_sel:[1,1] op_sel_hi:[1,0]
  v_cvt_pk_bf16_f32 v128, v164, v165
  v_cvt_pk_bf16_f32 v129, v166, v167
  v_pk_fma_f32 v[172:173], v[168:169], v[148:149], v[172:173] op_sel:[0,0,0] op_sel_hi:[0,1,1] neg_lo:[0,0,1]
  v_pk_fma_f32 v[174:175], v[170:171], v[150:151], v[174:175] op_sel:[0,0,0] op_sel_hi:[0,1,1] neg_lo:[0,0,1]
  ds_write_addtid_b32 v128 offset:5440
  ds_write_addtid_b32 v129 offset:5696
  v_pk_mul_f32 v[176:177], v[168:169], v[140:141] op_sel:[1,1] op_sel_hi:[1,0]
  v_pk_mul_f32 v[178:179], v[170:171], v[142:143] op_sel:[1,1] op_sel_hi:[1,0]
  v_cvt_pk_bf16_f32 v130, v168, v169
  v_cvt_pk_bf16_f32 v131, v170, v171
  v_pk_fma_f32 v[176:177], v[168:169], v[140:141], v[176:177] op_sel:[0,0,0] op_sel_hi:[0,1,1] neg_lo:[0,0,1]
  v_pk_fma_f32 v[178:179], v[170:171], v[142:143], v[178:179] op_sel:[0,0,0] op_sel_hi:[0,1,1] neg_lo:[0,0,1]
  ds_write_addtid_b32 v130 offset:1632
  ds_write_addtid_b32 v131 offset:1888
  v_pk_mul_f32 v[180:181], v[176:177], v[148:149] op_sel:[1,1] op_sel_hi:[1,0]
  v_pk_mul_f32 v[182:183], v[178:179], v[150:151] op_sel:[1,1] op_sel_hi:[1,0]
  v_cvt_pk_bf16_f32 v132, v172, v173
  v_cvt_pk_bf16_f32 v133, v174, v175
  v_pk_fma_f32 v[180:181], v[176:177], v[148:149], v[180:181] op_sel:[0,0,0] op_sel_hi:[0,1,1] neg_lo:[0,0,1]
  v_pk_fma_f32 v[182:183], v[178:179], v[150:151], v[182:183] op_sel:[0,0,0] op_sel_hi:[0,1,1] neg_lo:[0,0,1]
  ds_write_addtid_b32 v132 offset:5984
  ds_write_addtid_b32 v133 offset:6240
  v_pk_mul_f32 v[184:185], v[176:177], v[140:141] op_sel:[1,1] op_sel_hi:[1,0]
  v_pk_mul_f32 v[186:187], v[178:179], v[142:143] op_sel:[1,1] op_sel_hi:[1,0]
  v_cvt_pk_bf16_f32 v134, v176, v177
  v_cvt_pk_bf16_f32 v135, v178, v179
  v_pk_fma_f32 v[184:185], v[176:177], v[140:141], v[184:185] op_sel:[0,0,0] op_sel_hi:[0,1,1] neg_lo:[0,0,1]
  v_pk_fma_f32 v[186:187], v[178:179], v[142:143], v[186:187] op_sel:[0,0,0] op_sel_hi:[0,1,1] neg_lo:[0,0,1]
  ds_write_addtid_b32 v134 offset:2176
  ds_write_addtid_b32 v135 offset:2432
  v_pk_mul_f32 v[188:189], v[184:185], v[148:149] op_sel:[1,1] op_sel_hi:[1,0]
  v_pk_mul_f32 v[190:191], v[186:187], v[150:151] op_sel:[1,1] op_sel_hi:[1,0]
  v_cvt_pk_bf16_f32 v128, v180, v181
  v_cvt_pk_bf16_f32 v129, v182, v183
  v_pk_fma_f32 v[188:189], v[184:185], v[148:149], v[188:189] op_sel:[0,0,0] op_sel_hi:[0,1,1] neg_lo:[0,0,1]
  v_pk_fma_f32 v[190:191], v[186:187], v[150:151], v[190:191] op_sel:[0,0,0] op_sel_hi:[0,1,1] neg_lo:[0,0,1]
  ds_write_addtid_b32 v128 offset:6528
  ds_write_addtid_b32 v129 offset:6784
  v_pk_mul_f32 v[192:193], v[184:185], v[140:141] op_sel:[1,1] op_sel_hi:[1,0]
  v_pk_mul_f32 v[194:195], v[186:187], v[142:143] op_sel:[1,1] op_sel_hi:[1,0]
  v_cvt_pk_bf16_f32 v130, v184, v185
  v_cvt_pk_bf16_f32 v131, v186, v187
  v_pk_fma_f32 v[192:193], v[184:185], v[140:141], v[192:193] op_sel:[0,0,0] op_sel_hi:[0,1,1] neg_lo:[0,0,1]
  v_pk_fma_f32 v[194:195], v[186:187], v[142:143], v[194:195] op_sel:[0,0,0] op_sel_hi:[0,1,1] neg_lo:[0,0,1]
  ds_write_addtid_b32 v130 offset:2720
  ds_write_addtid_b32 v131 offset:2976
  v_pk_mul_f32 v[228:229], v[192:193], v[148:149] op_sel:[1,1] op_sel_hi:[1,0]
  v_pk_mul_f32 v[230:231], v[194:195], v[150:151] op_sel:[1,1] op_sel_hi:[1,0]
  v_cvt_pk_bf16_f32 v132, v188, v189
  v_cvt_pk_bf16_f32 v133, v190, v191
  v_pk_fma_f32 v[228:229], v[192:193], v[148:149], v[228:229] op_sel:[0,0,0] op_sel_hi:[0,1,1] neg_lo:[0,0,1]
  v_pk_fma_f32 v[230:231], v[194:195], v[150:151], v[230:231] op_sel:[0,0,0] op_sel_hi:[0,1,1] neg_lo:[0,0,1]
  ds_write_addtid_b32 v132 offset:7072
  ds_write_addtid_b32 v133 offset:7328
  v_pk_mul_f32 v[232:233], v[192:193], v[140:141] op_sel:[1,1] op_sel_hi:[1,0]
  v_pk_mul_f32 v[234:235], v[194:195], v[142:143] op_sel:[1,1] op_sel_hi:[1,0]
  v_cvt_pk_bf16_f32 v134, v192, v193
  v_cvt_pk_bf16_f32 v135, v194, v195
  v_pk_fma_f32 v[232:233], v[192:193], v[140:141], v[232:233] op_sel:[0,0,0] op_sel_hi:[0,1,1] neg_lo:[0,0,1]
  v_pk_fma_f32 v[234:235], v[194:195], v[142:143], v[234:235] op_sel:[0,0,0] op_sel_hi:[0,1,1] neg_lo:[0,0,1]
  ds_write_addtid_b32 v134 offset:3264
  ds_write_addtid_b32 v135 offset:3520
  v_pk_mul_f32 v[236:237], v[232:233], v[148:149] op_sel:[1,1] op_sel_hi:[1,0]
  v_pk_mul_f32 v[238:239], v[234:235], v[150:151] op_sel:[1,1] op_sel_hi:[1,0]
  v_cvt_pk_bf16_f32 v128, v228, v229
  v_cvt_pk_bf16_f32 v129, v230, v231
  v_pk_fma_f32 v[236:237], v[232:233], v[148:149], v[236:237] op_sel:[0,0,0] op_sel_hi:[0,1,1] neg_lo:[0,0,1]
  v_pk_fma_f32 v[238:239], v[234:235], v[150:151], v[238:239] op_sel:[0,0,0] op_sel_hi:[0,1,1] neg_lo:[0,0,1]
  ds_write_addtid_b32 v128 offset:7616
  ds_write_addtid_b32 v129 offset:7872
  v_cvt_pk_bf16_f32 v130, v232, v233
  v_cvt_pk_bf16_f32 v131, v234, v235
  ds_write_addtid_b32 v130 offset:3808
  ds_write_addtid_b32 v131 offset:4064
  v_cvt_pk_bf16_f32 v132, v236, v237
  v_cvt_pk_bf16_f32 v133, v238, v239
  ds_write_addtid_b32 v132 offset:8160
  ds_write_addtid_b32 v133 offset:8416
  ds_read_b128 v[76:79], v1 offset:0
  ds_read_b128 v[80:83], v1 offset:64
  ds_read_b128 v[84:87], v1 offset:128
  ds_read_b128 v[88:91], v1 offset:192
  ds_read_b128 v[92:95], v1 offset:256
  ds_read_b128 v[96:99], v1 offset:320
  ds_read_b128 v[100:103], v1 offset:384
  ds_read_b128 v[104:107], v1 offset:448
  s_cmp_eq_u32 s83, 0
  s_cbranch_scc0 L_na_29
  buffer_load_dwordx4 v[220:223], v13, s[44:47], s87 offen offset:2304
  buffer_load_dwordx4 v[224:227], v13, s[44:47], s87 offen offset:3456
L_na_29:
  v_pk_mul_f32 v[144:145], v[148:149], v[148:149] op_sel:[1,1] op_sel_hi:[1,0]
  v_pk_mul_f32 v[146:147], v[150:151], v[150:151] op_sel:[1,1] op_sel_hi:[1,0]
  v_pk_fma_f32 v[144:145], v[148:149], v[148:149], v[144:145] op_sel:[0,0,0] op_sel_hi:[0,1,1] neg_lo:[0,0,1]
  v_pk_fma_f32 v[146:147], v[150:151], v[150:151], v[146:147] op_sel:[0,0,0] op_sel_hi:[0,1,1] neg_lo:[0,0,1]
  v_pk_mul_f32 v[152:153], v[144:145], v[148:149] op_sel:[1,1] op_sel_hi:[1,0]
  v_pk_mul_f32 v[154:155], v[146:147], v[150:151] op_sel:[1,1] op_sel_hi:[1,0]
  v_pk_fma_f32 v[152:153], v[144:145], v[148:149], v[152:153] op_sel:[0,0,0] op_sel_hi:[0,1,1] neg_lo:[0,0,1]
  v_pk_fma_f32 v[154:155], v[146:147], v[150:151], v[154:155] op_sel:[0,0,0] op_sel_hi:[0,1,1] neg_lo:[0,0,1]
  v_pk_mul_f32 v[156:157], v[152:153], v[148:149] op_sel:[1,1] op_sel_hi:[1,0]
  v_pk_mul_f32 v[158:159], v[154:155], v[150:151] op_sel:[1,1] op_sel_hi:[1,0]
  v_pk_fma_f32 v[156:157], v[152:153], v[148:149], v[156:157] op_sel:[0,0,0] op_sel_hi:[0,1,1] neg_lo:[0,0,1]
  v_pk_fma_f32 v[158:159], v[154:155], v[150:151], v[158:159] op_sel:[0,0,0] op_sel_hi:[0,1,1] neg_lo:[0,0,1]
  v_pk_mul_f32 v[164:165], v[160:161], v[144:145] op_sel:[1,1] op_sel_hi:[1,0]
  v_pk_mul_f32 v[166:167], v[162:163], v[146:147] op_sel:[1,1] op_sel_hi:[1,0]
  v_cvt_pk_bf16_f32 v134, v144, v145
  v_cvt_pk_bf16_f32 v135, v146, v147
  v_pk_fma_f32 v[164:165], v[160:161], v[144:145], v[164:165] op_sel:[0,0,0] op_sel_hi:[0,1,1] neg_lo:[0,0,1]
  v_pk_fma_f32 v[166:167], v[162:163], v[146:147], v[166:167] op_sel:[0,0,0] op_sel_hi:[0,1,1] neg_lo:[0,0,1]
  ds_write_addtid_b32 v134 offset:4352
  ds_write_addtid_b32 v135 offset:4608
  v_pk_mul_f32 v[172:173], v[176:177], v[144:145] op_sel:[1,1] op_sel_hi:[1,0]
  v_pk_mul_f32 v[174:175], v[178:179], v[146:147] op_sel:[1,1] op_sel_hi:[1,0]
  v_cvt_pk_bf16_f32 v128, v164, v165
  v_cvt_pk_bf16_f32 v129, v166, v167
  v_pk_fma_f32 v[172:173], v[176:177], v[144:145], v[172:173] op_sel:[0,0,0] op_sel_hi:[0,1,1] neg_lo:[0,0,1]
  v_pk_fma_f32 v[174:175], v[178:179], v[146:147], v[174:175] op_sel:[0,0,0] op_sel_hi:[0,1,1] neg_lo:[0,0,1]
  ds_write_addtid_b32 v128 offset:0
  ds_write_addtid_b32 v129 offset:256
  v_pk_mul_f32 v[180:181], v[192:193], v[144:145] op_sel:[1,1] op_sel_hi:[1,0]
  v_pk_mul_f32 v[182:183], v[194:195], v[146:147] op_sel:[1,1] op_sel_hi:[1,0]
  v_cvt_pk_bf16_f32 v130, v172, v173
  v_cvt_pk_bf16_f32 v131, v174, v175
  v_pk_fma_f32 v[180:181], v[192:193], v[144:145], v[180:181] op_sel:[0,0,0] op_sel_hi:[0,1,1] neg_lo:[0,0,1]
  v_pk_fma_f32 v[182:183], v[194:195], v[146:147], v[182:183] op_sel:[0,0,0] op_sel_hi:[0,1,1] neg_lo:[0,0,1]
  ds_write_addtid_b32 v130 offset:544
  ds_write_addtid_b32 v131 offset:800
  v_pk_mul_f32 v[168:169], v[136:137], v[144:145] op_sel:[1,1] op_sel_hi:[1,0]
  v_pk_mul_f32 v[170:171], v[138:139], v[146:147] op_sel:[1,1] op_sel_hi:[1,0]
  v_cvt_pk_bf16_f32 v132, v180, v181
  v_cvt_pk_bf16_f32 v133, v182, v183
  v_pk_fma_f32 v[168:169], v[136:137], v[144:145], v[168:169] op_sel:[0,0,0] op_sel_hi:[0,1,1] neg_lo:[0,0,1]
  v_pk_fma_f32 v[170:171], v[138:139], v[146:147], v[170:171] op_sel:[0,0,0] op_sel_hi:[0,1,1] neg_lo:[0,0,1]
  ds_write_addtid_b32 v132 offset:1088
  ds_write_addtid_b32 v133 offset:1344
  s_waitcnt lgkmcnt(15)
  v_mfma_f32_16x16x32_bf16 v[108:111], v[76:79], v[44:47], 0
  s_waitcnt lgkmcnt(14)
  v_mfma_f32_16x16x32_bf16 v[108:111], v[80:83], v[48:51], v[108:111]
  s_waitcnt lgkmcnt(13)
  v_mfma_f32_16x16x32_bf16 v[108:111], v[84:87], v[52:55], v[108:111]
  s_waitcnt lgkmcnt(12)
  v_mfma_f32_16x16x32_bf16 v[108:111], v[88:91], v[56:59], v[108:111]
  s_waitcnt lgkmcnt(11)
  v_mfma_f32_16x16x32_bf16 v[108:111], v[92:95], v[60:63], v[108:111]
  s_waitcnt lgkmcnt(10)
  v_mfma_f32_16x16x32_bf16 v[108:111], v[96:99], v[64:67], v[108:111]
  s_waitcnt lgkmcnt(9)
  v_mfma_f32_16x16x32_bf16 v[108:111], v[100:103], v[68:71], v[108:111]
  s_waitcnt lgkmcnt(8)
  v_mfma_f32_16x16x32_bf16 v[108:111], v[104:107], v[72:75], v[108:111]
  v_pk_mul_f32 v[188:189], v[160:161], v[152:153] op_sel:[1,1] op_sel_hi:[1,0]
  v_pk_mul_f32 v[190:191], v[162:163], v[154:155] op_sel:[1,1] op_sel_hi:[1,0]
  v_cvt_pk_bf16_f32 v134, v168, v169
  v_cvt_pk_bf16_f32 v135, v170, v171
  v_pk_fma_f32 v[188:189], v[160:161], v[152:153], v[188:189] op_sel:[0,0,0] op_sel_hi:[0,1,1] neg_lo:[0,0,1]
  v_pk_fma_f32 v[190:191], v[162:163], v[154:155], v[190:191] op_sel:[0,0,0] op_sel_hi:[0,1,1] neg_lo:[0,0,1]
  ds_write_addtid_b32 v134 offset:1632
  ds_write_addtid_b32 v135 offset:1888
  v_pk_mul_f32 v[228:229], v[176:177], v[152:153] op_sel:[1,1] op_sel_hi:[1,0]
  v_pk_mul_f32 v[230:231], v[178:179], v[154:155] op_sel:[1,1] op_sel_hi:[1,0]
  v_cvt_pk_bf16_f32 v128, v188, v189
  v_cvt_pk_bf16_f32 v129, v190, v191
  v_pk_fma_f32 v[228:229], v[176:177], v[152:153], v[228:229] op_sel:[0,0,0] op_sel_hi:[0,1,1] neg_lo:[0,0,1]
  v_pk_fma_f32 v[230:231], v[178:179], v[154:155], v[230:231] op_sel:[0,0,0] op_sel_hi:[0,1,1] neg_lo:[0,0,1]
  ds_write_addtid_b32 v128 offset:2176
  ds_write_addtid_b32 v129 offset:2432
  v_pk_mul_f32 v[184:185], v[192:193], v[152:153] op_sel:[1,1] op_sel_hi:[1,0]
  v_pk_mul_f32 v[186:187], v[194:195], v[154:155] op_sel:[1,1] op_sel_hi:[1,0]
  v_cvt_pk_bf16_f32 v130, v228, v229
  v_cvt_pk_bf16_f32 v131, v230, v231
  v_pk_fma_f32 v[184:185], v[192:193], v[152:153], v[184:185] op_sel:[0,0,0] op_sel_hi:[0,1,1] neg_lo:[0,0,1]
  v_pk_fma_f32 v[186:187], v[194:195], v[154:155], v[186:187] op_sel:[0,0,0] op_sel_hi:[0,1,1] neg_lo:[0,0,1]
  ds_write_addtid_b32 v130 offset:2720
  ds_write_addtid_b32 v131 offset:2976
  v_pk_mul_f32 v[236:237], v[136:137], v[152:153] op_sel:[1,1] op_sel_hi:[1,0]
  v_pk_mul_f32 v[238:239], v[138:139], v[154:155] op_sel:[1,1] op_sel_hi:[1,0]
  v_cvt_pk_bf16_f32 v132, v184, v185
  v_cvt_pk_bf16_f32 v133, v186, v187
  v_pk_fma_f32 v[236:237], v[136:137], v[152:153], v[236:237] op_sel:[0,0,0] op_sel_hi:[0,1,1] neg_lo:[0,0,1]
  v_pk_fma_f32 v[238:239], v[138:139], v[154:155], v[238:239] op_sel:[0,0,0] op_sel_hi:[0,1,1] neg_lo:[0,0,1]
  ds_write_addtid_b32 v132 offset:3264
  ds_write_addtid_b32 v133 offset:3520
  v_cvt_pk_bf16_f32 v134, v236, v237
  v_cvt_pk_bf16_f32 v135, v238, v239
  ds_write_addtid_b32 v134 offset:3808
  ds_write_addtid_b32 v135 offset:4064
  ds_read_b128 v[76:79], v1 offset:0
  ds_read_b128 v[80:83], v1 offset:64
  ds_read_b128 v[84:87], v1 offset:128
  ds_read_b128 v[88:91], v1 offset:192
  ds_read_b128 v[92:95], v1 offset:256
  ds_read_b128 v[96:99], v1 offset:320
  ds_read_b128 v[100:103], v1 offset:384
  ds_read_b128 v[104:107], v1 offset:448
  v_pk_mul_f32 v[232:233], v[156:157], v[176:177] op_sel:[1,1] op_sel_hi:[1,0]
  v_pk_mul_f32 v[234:235], v[158:159], v[178:179] op_sel:[1,1] op_sel_hi:[1,0]
  v_pk_fma_f32 v[232:233], v[156:157], v[176:177], v[232:233] op_sel:[0,0,0] op_sel_hi:[0,1,1] neg_lo:[0,0,1]
  v_pk_fma_f32 v[234:235], v[158:159], v[178:179], v[234:235] op_sel:[0,0,0] op_sel_hi:[0,1,1] neg_lo:[0,0,1]
  v_pk_mul_f32 v[164:165], v[156:157], v[136:137] op_sel:[1,1] op_sel_hi:[1,0]
  v_pk_mul_f32 v[166:167], v[158:159], v[138:139] op_sel:[1,1] op_sel_hi:[1,0]
  v_pk_fma_f32 v[164:165], v[156:157], v[136:137], v[164:165] op_sel:[0,0,0] op_sel_hi:[0,1,1] neg_lo:[0,0,1]
  v_pk_fma_f32 v[166:167], v[158:159], v[138:139], v[166:167] op_sel:[0,0,0] op_sel_hi:[0,1,1] neg_lo:[0,0,1]
  v_pk_mul_f32 v[172:173], v[232:233], v[148:149] op_sel:[1,1] op_sel_hi:[1,0]
  v_pk_mul_f32 v[174:175], v[234:235], v[150:151] op_sel:[1,1] op_sel_hi:[1,0]
  v_cvt_pk_bf16_f32 v128, v232, v233
  v_cvt_pk_bf16_f32 v129, v234, v235
  v_pk_fma_f32 v[172:173], v[232:233], v[148:149], v[172:173] op_sel:[0,0,0] op_sel_hi:[0,1,1] neg_lo:[0,0,1]
  v_pk_fma_f32 v[174:175], v[234:235], v[150:151], v[174:175] op_sel:[0,0,0] op_sel_hi:[0,1,1] neg_lo:[0,0,1]
  ds_write_addtid_b32 v128 offset:0
  ds_write_addtid_b32 v129 offset:256
  v_pk_mul_f32 v[180:181], v[164:165], v[148:149] op_sel:[1,1] op_sel_hi:[1,0]
  v_pk_mul_f32 v[182:183], v[166:167], v[150:151] op_sel:[1,1] op_sel_hi:[1,0]
  v_cvt_pk_bf16_f32 v130, v164, v165
  v_cvt_pk_bf16_f32 v131, v166, v167
  v_pk_fma_f32 v[180:181], v[164:165], v[148:149], v[180:181] op_sel:[0,0,0] op_sel_hi:[0,1,1] neg_lo:[0,0,1]
  v_pk_fma_f32 v[182:183], v[166:167], v[150:151], v[182:183] op_sel:[0,0,0] op_sel_hi:[0,1,1] neg_lo:[0,0,1]
  ds_write_addtid_b32 v130 offset:2176
  ds_write_addtid_b32 v131 offset:2432
  v_pk_mul_f32 v[168:169], v[172:173], v[148:149] op_sel:[1,1] op_sel_hi:[1,0]
  v_pk_mul_f32 v[170:171], v[174:175], v[150:151] op_sel:[1,1] op_sel_hi:[1,0]
  v_cvt_pk_bf16_f32 v132, v172, v173
  v_cvt_pk_bf16_f32 v133, v174, v175
  v_pk_fma_f32 v[168:169], v[172:173], v[148:149], v[168:169] op_sel:[0,0,0] op_sel_hi:[0,1,1] neg_lo:[0,0,1]
  v_pk_fma_f32 v[170:171], v[174:175], v[150:151], v[170:171] op_sel:[0,0,0] op_sel_hi:[0,1,1] neg_lo:[0,0,1]
  ds_write_addtid_b32 v132 offset:544
  ds_write_addtid_b32 v133 offset:800
  v_pk_mul_f32 v[188:189], v[180:181], v[148:149] op_sel:[1,1] op_sel_hi:[1,0]
  v_pk_mul_f32 v[190:191], v[182:183], v[150:151] op_sel:[1,1] op_sel_hi:[1,0]
  v_cvt_pk_bf16_f32 v134, v180, v181
  v_cvt_pk_bf16_f32 v135, v182, v183
  v_pk_fma_f32 v[188:189], v[180:181], v[148:149], v[188:189] op_sel:[0,0,0] op_sel_hi:[0,1,1] neg_lo:[0,0,1]
  v_pk_fma_f32 v[190:191], v[182:183], v[150:151], v[190:191] op_sel:[0,0,0] op_sel_hi:[0,1,1] neg_lo:[0,0,1]
  ds_write_addtid_b32 v134 offset:2720
  ds_write_addtid_b32 v135 offset:2976
  v_pk_mul_f32 v[228:229], v[168:169], v[148:149] op_sel:[1,1] op_sel_hi:[1,0]
  v_pk_mul_f32 v[230:231], v[170:171], v[150:151] op_sel:[1,1] op_sel_hi:[1,0]
  v_cvt_pk_bf16_f32 v128, v168, v169
  v_cvt_pk_bf16_f32 v129, v170, v171
  v_pk_fma_f32 v[228:229], v[168:169], v[148:149], v[228:229] op_sel:[0,0,0] op_sel_hi:[0,1,1] neg_lo:[0,0,1]
  v_pk_fma_f32 v[230:231], v[170:171], v[150:151], v[230:231] op_sel:[0,0,0] op_sel_hi:[0,1,1] neg_lo:[0,0,1]
  ds_write_addtid_b32 v128 offset:1088
  ds_write_addtid_b32 v129 offset:1344
  v_pk_mul_f32 v[184:185], v[188:189], v[148:149] op_sel:[1,1] op_sel_hi:[1,0]
  v_pk_mul_f32 v[186:187], v[190:191], v[150:151] op_sel:[1,1] op_sel_hi:[1,0]
  v_cvt_pk_bf16_f32 v130, v188, v189
  v_cvt_pk_bf16_f32 v131, v190, v191
  v_pk_fma_f32 v[184:185], v[188:189], v[148:149], v[184:185] op_sel:[0,0,0] op_sel_hi:[0,1,1] neg_lo:[0,0,1]
  v_pk_fma_f32 v[186:187], v[190:191], v[150:151], v[186:187] op_sel:[0,0,0] op_sel_hi:[0,1,1] neg_lo:[0,0,1]
  ds_write_addtid_b32 v130 offset:3264
  ds_write_addtid_b32 v131 offset:3520
  s_waitcnt lgkmcnt(15)
  v_mfma_f32_16x16x32_bf16 v[112:115], v[76:79], v[44:47], 0
  v_mfma_f32_16x16x32_bf16 v[112:115], v[80:83], v[48:51], v[112:115]
  v_mfma_f32_16x16x32_bf16 v[112:115], v[84:87], v[52:55], v[112:115]
  v_mfma_f32_16x16x32_bf16 v[112:115], v[88:91], v[56:59], v[112:115]
  v_mfma_f32_16x16x32_bf16 v[112:115], v[92:95], v[60:63], v[112:115]
  s_waitcnt lgkmcnt(14)
  v_mfma_f32_16x16x32_bf16 v[112:115], v[96:99], v[64:67], v[112:115]
  s_waitcnt lgkmcnt(13)
  v_mfma_f32_16x16x32_bf16 v[112:115], v[100:103], v[68:71], v[112:115]
  s_waitcnt lgkmcnt(12)
  v_mfma_f32_16x16x32_bf16 v[112:115], v[104:107], v[72:75], v[112:115]
  v_pk_mul_f32 v[236:237], v[184:185], v[148:149] op_sel:[1,1] op_sel_hi:[1,0]
  v_pk_mul_f32 v[238:239], v[186:187], v[150:151] op_sel:[1,1] op_sel_hi:[1,0]
  v_cvt_pk_bf16_f32 v132, v228, v229
  v_cvt_pk_bf16_f32 v133, v230, v231
  v_pk_fma_f32 v[236:237], v[184:185], v[148:149], v[236:237] op_sel:[0,0,0] op_sel_hi:[0,1,1] neg_lo:[0,0,1]
  v_pk_fma_f32 v[238:239], v[186:187], v[150:151], v[238:239] op_sel:[0,0,0] op_sel_hi:[0,1,1] neg_lo:[0,0,1]
  ds_write_addtid_b32 v132 offset:1632
  ds_write_addtid_b32 v133 offset:1888
  v_pk_mul_f32 v[144:145], v[236:237], v[148:149] op_sel:[1,1] op_sel_hi:[1,0]
  v_pk_mul_f32 v[146:147], v[238:239], v[150:151] op_sel:[1,1] op_sel_hi:[1,0]
  v_cvt_pk_bf16_f32 v134, v184, v185
  v_cvt_pk_bf16_f32 v135, v186, v187
  v_pk_fma_f32 v[144:145], v[236:237], v[148:149], v[144:145] op_sel:[0,0,0] op_sel_hi:[0,1,1] neg_lo:[0,0,1]
  v_pk_fma_f32 v[146:147], v[238:239], v[150:151], v[146:147] op_sel:[0,0,0] op_sel_hi:[0,1,1] neg_lo:[0,0,1]
  ds_write_addtid_b32 v134 offset:3808
  ds_write_addtid_b32 v135 offset:4064
  v_pk_mul_f32 v[152:153], v[144:145], v[148:149] op_sel:[1,1] op_sel_hi:[1,0]
  v_pk_mul_f32 v[154:155], v[146:147], v[150:151] op_sel:[1,1] op_sel_hi:[1,0]
  v_cvt_pk_bf16_f32 v128, v236, v237
  v_cvt_pk_bf16_f32 v129, v238, v239
  v_pk_fma_f32 v[152:153], v[144:145], v[148:149], v[152:153] op_sel:[0,0,0] op_sel_hi:[0,1,1] neg_lo:[0,0,1]
  v_pk_fma_f32 v[154:155], v[146:147], v[150:151], v[154:155] op_sel:[0,0,0] op_sel_hi:[0,1,1] neg_lo:[0,0,1]
  ds_write_addtid_b32 v128 offset:4352
  ds_write_addtid_b32 v129 offset:4608
  v_pk_mul_f32 v[160:161], v[152:153], v[148:149] op_sel:[1,1] op_sel_hi:[1,0]
  v_pk_mul_f32 v[162:163], v[154:155], v[150:151] op_sel:[1,1] op_sel_hi:[1,0]
  v_cvt_pk_bf16_f32 v130, v144, v145
  v_cvt_pk_bf16_f32 v131, v146, v147
  v_pk_fma_f32 v[160:161], v[152:153], v[148:149], v[160:161] op_sel:[0,0,0] op_sel_hi:[0,1,1] neg_lo:[0,0,1]
  v_pk_fma_f32 v[162:163], v[154:155], v[150:151], v[162:163] op_sel:[0,0,0] op_sel_hi:[0,1,1] neg_lo:[0,0,1]
  ds_write_addtid_b32 v130 offset:4896
  ds_write_addtid_b32 v131 offset:5152
  v_pk_mul_f32 v[192:193], v[160:161], v[148:149] op_sel:[1,1] op_sel_hi:[1,0]
  v_pk_mul_f32 v[194:195], v[162:163], v[150:151] op_sel:[1,1] op_sel_hi:[1,0]
  v_cvt_pk_bf16_f32 v132, v152, v153
  v_cvt_pk_bf16_f32 v133, v154, v155
  v_pk_fma_f32 v[192:193], v[160:161], v[148:149], v[192:193] op_sel:[0,0,0] op_sel_hi:[0,1,1] neg_lo:[0,0,1]
  v_pk_fma_f32 v[194:195], v[162:163], v[150:151], v[194:195] op_sel:[0,0,0] op_sel_hi:[0,1,1] neg_lo:[0,0,1]
  ds_write_addtid_b32 v132 offset:5440
  ds_write_addtid_b32 v133 offset:5696
  v_pk_mul_f32 v[140:141], v[192:193], v[148:149] op_sel:[1,1] op_sel_hi:[1,0]
  v_pk_mul_f32 v[142:143], v[194:195], v[150:151] op_sel:[1,1] op_sel_hi:[1,0]
  v_cvt_pk_bf16_f32 v134, v160, v161
  v_cvt_pk_bf16_f32 v135, v162, v163
  v_pk_fma_f32 v[140:141], v[192:193], v[148:149], v[140:141] op_sel:[0,0,0] op_sel_hi:[0,1,1] neg_lo:[0,0,1]
  v_pk_fma_f32 v[142:143], v[194:195], v[150:151], v[142:143] op_sel:[0,0,0] op_sel_hi:[0,1,1] neg_lo:[0,0,1]
  ds_write_addtid_b32 v134 offset:5984
  ds_write_addtid_b32 v135 offset:6240
  v_pk_mul_f32 v[156:157], v[140:141], v[148:149] op_sel:[1,1] op_sel_hi:[1,0]
  v_pk_mul_f32 v[158:159], v[142:143], v[150:151] op_sel:[1,1] op_sel_hi:[1,0]
  v_cvt_pk_bf16_f32 v128, v192, v193
  v_cvt_pk_bf16_f32 v129, v194, v195
  v_pk_fma_f32 v[156:157], v[140:141], v[148:149], v[156:157] op_sel:[0,0,0] op_sel_hi:[0,1,1] neg_lo:[0,0,1]
  v_pk_fma_f32 v[158:159], v[142:143], v[150:151], v[158:159] op_sel:[0,0,0] op_sel_hi:[0,1,1] neg_lo:[0,0,1]
  ds_write_addtid_b32 v128 offset:6528
  ds_write_addtid_b32 v129 offset:6784
  v_pk_mul_f32 v[176:177], v[156:157], v[148:149] op_sel:[1,1] op_sel_hi:[1,0]
  v_pk_mul_f32 v[178:179], v[158:159], v[150:151] op_sel:[1,1] op_sel_hi:[1,0]
  v_cvt_pk_bf16_f32 v130, v140, v141
  v_cvt_pk_bf16_f32 v131, v142, v143
  v_pk_fma_f32 v[176:177], v[156:157], v[148:149], v[176:177] op_sel:[0,0,0] op_sel_hi:[0,1,1] neg_lo:[0,0,1]
  v_pk_fma_f32 v[178:179], v[158:159], v[150:151], v[178:179] op_sel:[0,0,0] op_sel_hi:[0,1,1] neg_lo:[0,0,1]
  ds_write_addtid_b32 v130 offset:7072
  ds_write_addtid_b32 v131 offset:7328
  v_cvt_pk_bf16_f32 v132, v156, v157
  v_cvt_pk_bf16_f32 v133, v158, v159
  ds_write_addtid_b32 v132 offset:7616
  ds_write_addtid_b32 v133 offset:7872
  v_cvt_pk_bf16_f32 v134, v176, v177
  v_cvt_pk_bf16_f32 v135, v178, v179
  ds_write_addtid_b32 v134 offset:8160
  ds_write_addtid_b32 v135 offset:8416
  ds_read_b128 v[76:79], v1 offset:0
  ds_read_b128 v[80:83], v1 offset:64
  ds_read_b128 v[84:87], v1 offset:128
  ds_read_b128 v[88:91], v1 offset:192
  ds_read_b128 v[92:95], v1 offset:256
  ds_read_b128 v[96:99], v1 offset:320
  ds_read_b128 v[100:103], v1 offset:384
  ds_read_b128 v[104:107], v1 offset:448
  s_branch L_tj_26
L_tb_25:
  v_mul_f32 v144, 0x3f800000, v120
  v_mul_f32 v146, 0x3f800000, v124
  v_mul_f32 v145, 0x3f800000, v121
  v_mul_f32 v147, 0x3f800000, v125
  v_exp_f32 v144, -v144
  v_fract_f32 v146, v146
  v_exp_f32 v145, -v145
  v_fract_f32 v147, v147
  v_cos_f32 v140, v146
  v_sin_f32 v141, v146
  v_cos_f32 v142, v147
  v_sin_f32 v143, v147
  v_mul_f32 v140, v144, v140
  v_mul_f32 v141, v144, v141
  v_mul_f32 v142, v145, v142
  v_mul_f32 v143, v145, v143
  v_mul_f32 v152, 0x43000000, v120
  v_mul_f32 v154, 0x43000000, v124
  v_mul_f32 v153, 0x43000000, v121
  v_mul_f32 v155, 0x43000000, v125
  v_exp_f32 v152, -v152
  v_fract_f32 v154, v154
  v_exp_f32 v153, -v153
  v_fract_f32 v155, v155
  v_cos_f32 v148, v154
  v_sin_f32 v149, v154
  v_cos_f32 v150, v155
  v_sin_f32 v151, v155
  v_mul_f32 v148, v152, v148
  v_mul_f32 v149, v152, v149
  v_mul_f32 v150, v153, v150
  v_mul_f32 v151, v153, v151
  v_mov_b32 v18, 0x3f80
  ds_write_addtid_b32 v18
  ds_write_addtid_b32 v18 offset:256
  v_mul_f32 v156, v140, v148
  v_mul_f32 v158, v142, v150
  v_mul_f32 v157, v141, v148
  v_mul_f32 v159, v143, v150
  v_cvt_pk_bf16_f32 v128, v148, v149
  v_cvt_pk_bf16_f32 v129, v150, v151
  v_fma_f32 v156, -v141, v149, v156
  v_fma_f32 v158, -v143, v151, v158
  v_fmac_f32 v157, v140, v149
  v_fmac_f32 v159, v142, v151
  ds_write_addtid_b32 v128 offset:4352
  ds_write_addtid_b32 v129 offset:4608
  v_mul_f32 v160, v140, v140
  v_mul_f32 v162, v142, v142
  v_mul_f32 v161, v141, v140
  v_mul_f32 v163, v143, v142
  v_cvt_pk_bf16_f32 v130, v140, v141
  v_cvt_pk_bf16_f32 v131, v142, v143
  v_fma_f32 v160, -v141, v141, v160
  v_fma_f32 v162, -v143, v143, v162
  v_fmac_f32 v161, v140, v141
  v_fmac_f32 v163, v142, v143
  ds_write_addtid_b32 v130 offset:544
  ds_write_addtid_b32 v131 offset:800
  v_mul_f32 v164, v160, v148
  v_mul_f32 v166, v162, v150
  v_mul_f32 v165, v161, v148
  v_mul_f32 v167, v163, v150
  v_cvt_pk_bf16_f32 v132, v156, v157
  v_cvt_pk_bf16_f32 v133, v158, v159
  v_fma_f32 v164, -v161, v149, v164
  v_fma_f32 v166, -v163, v151, v166
  v_fmac_f32 v165, v160, v149
  v_fmac_f32 v167, v162, v151
  ds_write_addtid_b32 v132 offset:4896
  ds_write_addtid_b32 v133 offset:5152
  v_mul_f32 v168, v160, v140
  v_mul_f32 v170, v162, v142
  v_mul_f32 v169, v161, v140
  v_mul_f32 v171, v163, v142
  v_cvt_pk_bf16_f32 v134, v160, v161
  v_cvt_pk_bf16_f32 v135, v162, v163
  v_fma_f32 v168, -v161, v141, v168
  v_fma_f32 v170, -v163, v143, v170
  v_fmac_f32 v169, v160, v141
  v_fmac_f32 v171, v162, v143
  ds_write_addtid_b32 v134 offset:1088
  ds_write_addtid_b32 v135 offset:1344
  v_mul_f32 v172, v168, v148
  v_mul_f32 v174, v170, v150
  v_mul_f32 v173, v169, v148
  v_mul_f32 v175, v171, v150
  v_cvt_pk_bf16_f32 v128, v164, v165
  v_cvt_pk_bf16_f32 v129, v166, v167
  v_fma_f32 v172, -v169, v149, v172
  v_fma_f32 v174, -v171, v151, v174
  v_fmac_f32 v173, v168, v149
  v_fmac_f32 v175, v170, v151
  ds_write_addtid_b32 v128 offset:5440
  ds_write_addtid_b32 v129 offset:5696
  v_mul_f32 v176, v168, v140
  v_mul_f32 v178, v170, v142
  v_mul_f32 v177, v169, v140
  v_mul_f32 v179, v171, v142
  v_cvt_pk_bf16_f32 v130, v168, v169
  v_cvt_pk_bf16_f32 v131, v170, v171
  v_fma_f32 v176, -v169, v141, v176
  v_fma_f32 v178, -v171, v143, v178
  v_fmac_f32 v177, v168, v141
  v_fmac_f32 v179, v170, v143
  ds_write_addtid_b32 v130 offset:1632
  ds_write_addtid_b32 v131 offset:1888
  v_mul_f32 v180, v176, v148
  v_mul_f32 v182, v178, v150
  v_mul_f32 v181, v177, v148
  v_mul_f32 v183, v179, v150
  v_cvt_pk_bf16_f32 v132, v172, v173
  v_cvt_pk_bf16_f32 v133, v174, v175
  v_fma_f32 v180, -v177, v149, v180
  v_fma_f32 v182, -v179, v151, v182
  v_fmac_f32 v181, v176, v149
  v_fmac_f32 v183, v178, v151
  ds_write_addtid_b32 v132 offset:5984
  ds_write_addtid_b32 v133 offset:6240
  v_mul_f32 v184, v176, v140
  v_mul_f32 v186, v178, v142
  v_mul_f32 v185, v177, v140
  v_mul_f32 v187, v179, v142
  v_cvt_pk_bf16_f32 v134, v176, v177
  v_cvt_pk_bf16_f32 v135, v178, v179
  v_fma_f32 v184, -v177, v141, v184
  v_fma_f32 v186, -v179, v143, v186
  v_fmac_f32 v185, v176, v141
  v_fmac_f32 v187, v178, v143
  ds_write_addtid_b32 v134 offset:2176
  ds_write_addtid_b32 v135 offset:2432
  v_mul_f32 v188, v184, v148
  v_mul_f32 v190, v186, v150
  v_mul_f32 v189, v185, v148
  v_mul_f32 v191, v187, v150
  v_cvt_pk_bf16_f32 v128, v180, v181
  v_cvt_pk_bf16_f32 v129, v182, v183
  v_fma_f32 v188, -v185, v149, v188
  v_fma_f32 v190, -v187, v151, v190
  v_fmac_f32 v189, v184, v149
  v_fmac_f32 v191, v186, v151
  ds_write_addtid_b32 v128 offset:6528
  ds_write_addtid_b32 v129 offset:6784
  v_mul_f32 v192, v184, v140
  v_mul_f32 v194, v186, v142
  v_mul_f32 v193, v185, v140
  v_mul_f32 v195, v187, v142
  v_cvt_pk_bf16_f32 v130, v184, v185
  v_cvt_pk_bf16_f32 v131, v186, v187
  v_fma_f32 v192, -v185, v141, v192
  v_fma_f32 v194, -v187, v143, v194
  v_fmac_f32 v193, v184, v141
  v_fmac_f32 v195, v186, v143
  ds_write_addtid_b32 v130 offset:2720
  ds_write_addtid_b32 v131 offset:2976
  v_mul_f32 v228, v192, v148
  v_mul_f32 v230, v194, v150
  v_mul_f32 v229, v193, v148
  v_mul_f32 v231, v195, v150
  v_cvt_pk_bf16_f32 v132, v188, v189
  v_cvt_pk_bf16_f32 v133, v190, v191
  v_fma_f32 v228, -v193, v149, v228
  v_fma_f32 v230, -v195, v151, v230
  v_fmac_f32 v229, v192, v149
  v_fmac_f32 v231, v194, v151
  ds_write_addtid_b32 v132 offset:7072
  ds_write_addtid_b32 v133 offset:7328
  v_mul_f32 v232, v192, v140
  v_mul_f32 v234, v194, v142
  v_mul_f32 v233, v193, v140
  v_mul_f32 v235, v195, v142
  v_cvt_pk_bf16_f32 v134, v192, v193
  v_cvt_pk_bf16_f32 v135, v194, v195
  v_fma_f32 v232, -v193, v141, v232
  v_fma_f32 v234, -v195, v143, v234
  v_fmac_f32 v233, v192, v141
  v_fmac_f32 v235, v194, v143
  ds_write_addtid_b32 v134 offset:3264
  ds_write_addtid_b32 v135 offset:3520
  v_mul_f32 v236, v232, v148
  v_mul_f32 v238, v234, v150
  v_mul_f32 v237, v233, v148
  v_mul_f32 v239, v235, v150
  v_cvt_pk_bf16_f32 v128, v228, v229
  v_cvt_pk_bf16_f32 v129, v230, v231
  v_fma_f32 v236, -v233, v149, v236
  v_fma_f32 v238, -v235, v151, v238
  v_fmac_f32 v237, v232, v149
  v_fmac_f32 v239, v234, v151
  ds_write_addtid_b32 v128 offset:7616
  ds_write_addtid_b32 v129 offset:7872
  v_cvt_pk_bf16_f32 v130, v232, v233
  v_cvt_pk_bf16_f32 v131, v234, v235
  ds_write_addtid_b32 v130 offset:3808
  ds_write_addtid_b32 v131 offset:4064
  v_cvt_pk_bf16_f32 v132, v236, v237
  v_cvt_pk_bf16_f32 v133, v238, v239
  ds_write_addtid_b32 v132 offset:8160
  ds_write_addtid_b32 v133 offset:8416
  ds_read_b128 v[76:79], v1 offset:0
  ds_read_b128 v[80:83], v1 offset:64
  ds_read_b128 v[84:87], v1 offset:128
  ds_read_b128 v[88:91], v1 offset:192
  ds_read_b128 v[92:95], v1 offset:256
  ds_read_b128 v[96:99], v1 offset:320
  ds_read_b128 v[100:103], v1 offset:384
  ds_read_b128 v[104:107], v1 offset:448
  v_mul_f32 v144, v148, v148
  v_mul_f32 v146, v150, v150
  v_mul_f32 v145, v149, v148
  v_mul_f32 v147, v151, v150
  v_fma_f32 v144, -v149, v149, v144
  v_fma_f32 v146, -v151, v151, v146
  v_fmac_f32 v145, v148, v149
  v_fmac_f32 v147, v150, v151
  v_mul_f32 v152, v144, v148
  v_mul_f32 v154, v146, v150
  v_mul_f32 v153, v145, v148
  v_mul_f32 v155, v147, v150
  v_fma_f32 v152, -v145, v149, v152
  v_fma_f32 v154, -v147, v151, v154
  v_fmac_f32 v153, v144, v149
  v_fmac_f32 v155, v146, v151
  v_mul_f32 v156, v152, v148
  v_mul_f32 v158, v154, v150
  v_mul_f32 v157, v153, v148
  v_mul_f32 v159, v155, v150
  v_fma_f32 v156, -v153, v149, v156
  v_fma_f32 v158, -v155, v151, v158
  v_fmac_f32 v157, v152, v149
  v_fmac_f32 v159, v154, v151
  v_mul_f32 v164, v160, v144
  v_mul_f32 v166, v162, v146
  v_mul_f32 v165, v161, v144
  v_mul_f32 v167, v163, v146
  v_cvt_pk_bf16_f32 v134, v144, v145
  v_cvt_pk_bf16_f32 v135, v146, v147
  v_fma_f32 v164, -v161, v145, v164
  v_fma_f32 v166, -v163, v147, v166
  v_fmac_f32 v165, v160, v145
  v_fmac_f32 v167, v162, v147
  ds_write_addtid_b32 v134 offset:4352
  ds_write_addtid_b32 v135 offset:4608
  v_mul_f32 v172, v176, v144
  v_mul_f32 v174, v178, v146
  v_mul_f32 v173, v177, v144
  v_mul_f32 v175, v179, v146
  v_cvt_pk_bf16_f32 v128, v164, v165
  v_cvt_pk_bf16_f32 v129, v166, v167
  v_fma_f32 v172, -v177, v145, v172
  v_fma_f32 v174, -v179, v147, v174
  v_fmac_f32 v173, v176, v145
  v_fmac_f32 v175, v178, v147
  ds_write_addtid_b32 v128 offset:0
  ds_write_addtid_b32 v129 offset:256
  v_mul_f32 v180, v192, v144
  v_mul_f32 v182, v194, v146
  v_mul_f32 v181, v193, v144
  v_mul_f32 v183, v195, v146
  v_cvt_pk_bf16_f32 v130, v172, v173
  v_cvt_pk_bf16_f32 v131, v174, v175
  v_fma_f32 v180, -v193, v145, v180
  v_fma_f32 v182, -v195, v147, v182
  v_fmac_f32 v181, v192, v145
  v_fmac_f32 v183, v194, v147
  ds_write_addtid_b32 v130 offset:544
  ds_write_addtid_b32 v131 offset:800
  v_mul_f32 v168, v136, v144
  v_mul_f32 v170, v138, v146
  v_mul_f32 v169, v137, v144
  v_mul_f32 v171, v139, v146
  v_cvt_pk_bf16_f32 v132, v180, v181
  v_cvt_pk_bf16_f32 v133, v182, v183
  v_fma_f32 v168, -v137, v145, v168
  v_fma_f32 v170, -v139, v147, v170
  v_fmac_f32 v169, v136, v145
  v_fmac_f32 v171, v138, v147
  ds_write_addtid_b32 v132 offset:1088
  ds_write_addtid_b32 v133 offset:1344
  s_waitcnt lgkmcnt(15)
  v_mfma_f32_16x16x32_bf16 v[108:111], v[76:79], v[44:47], 0
  s_waitcnt lgkmcnt(14)
  v_mfma_f32_16x16x32_bf16 v[108:111], v[80:83], v[48:51], v[108:111]
  s_waitcnt lgkmcnt(13)
  v_mfma_f32_16x16x32_bf16 v[108:111], v[84:87], v[52:55], v[108:111]
  s_waitcnt lgkmcnt(12)
  v_mfma_f32_16x16x32_bf16 v[108:111], v[88:91], v[56:59], v[108:111]
  s_waitcnt lgkmcnt(11)
  v_mfma_f32_16x16x32_bf16 v[108:111], v[92:95], v[60:63], v[108:111]
  s_waitcnt lgkmcnt(10)
  v_mfma_f32_16x16x32_bf16 v[108:111], v[96:99], v[64:67], v[108:111]
  s_waitcnt lgkmcnt(9)
  v_mfma_f32_16x16x32_bf16 v[108:111], v[100:103], v[68:71], v[108:111]
  s_waitcnt lgkmcnt(8)
  v_mfma_f32_16x16x32_bf16 v[108:111], v[104:107], v[72:75], v[108:111]
  v_mul_f32 v188, v160, v152
  v_mul_f32 v190, v162, v154
  v_mul_f32 v189, v161, v152
  v_mul_f32 v191, v163, v154
  v_cvt_pk_bf16_f32 v134, v168, v169
  v_cvt_pk_bf16_f32 v135, v170, v171
  v_fma_f32 v188, -v161, v153, v188
  v_fma_f32 v190, -v163, v155, v190
  v_fmac_f32 v189, v160, v153
  v_fmac_f32 v191, v162, v155
  ds_write_addtid_b32 v134 offset:1632
  ds_write_addtid_b32 v135 offset:1888
  v_mul_f32 v228, v176, v152
  v_mul_f32 v230, v178, v154
  v_mul_f32 v229, v177, v152
  v_mul_f32 v231, v179, v154
  v_cvt_pk_bf16_f32 v128, v188, v189
  v_cvt_pk_bf16_f32 v129, v190, v191
  v_fma_f32 v228, -v177, v153, v228
  v_fma_f32 v230, -v179, v155, v230
  v_fmac_f32 v229, v176, v153
  v_fmac_f32 v231, v178, v155
  ds_write_addtid_b32 v128 offset:2176
  ds_write_addtid_b32 v129 offset:2432
  v_mul_f32 v184, v192, v152
  v_mul_f32 v186, v194, v154
  v_mul_f32 v185, v193, v152
  v_mul_f32 v187, v195, v154
  v_cvt_pk_bf16_f32 v130, v228, v229
  v_cvt_pk_bf16_f32 v131, v230, v231
  v_fma_f32 v184, -v193, v153, v184
  v_fma_f32 v186, -v195, v155, v186
  v_fmac_f32 v185, v192, v153
  v_fmac_f32 v187, v194, v155
  ds_write_addtid_b32 v130 offset:2720
  ds_write_addtid_b32 v131 offset:2976
  v_mul_f32 v236, v136, v152
  v_mul_f32 v238, v138, v154
  v_mul_f32 v237, v137, v152
  v_mul_f32 v239, v139, v154
  v_cvt_pk_bf16_f32 v132, v184, v185
  v_cvt_pk_bf16_f32 v133, v186, v187
  v_fma_f32 v236, -v137, v153, v236
  v_fma_f32 v238, -v139, v155, v238
  v_fmac_f32 v237, v136, v153
  v_fmac_f32 v239, v138, v155
  ds_write_addtid_b32 v132 offset:3264
  ds_write_addtid_b32 v133 offset:3520
  v_cvt_pk_bf16_f32 v134, v236, v237
  v_cvt_pk_bf16_f32 v135, v238, v239
  ds_write_addtid_b32 v134 offset:3808
  ds_write_addtid_b32 v135 offset:4064
  ds_read_b128 v[76:79], v1 offset:0
  ds_read_b128 v[80:83], v1 offset:64
  ds_read_b128 v[84:87], v1 offset:128
  ds_read_b128 v[88:91], v1 offset:192
  ds_read_b128 v[92:95], v1 offset:256
  ds_read_b128 v[96:99], v1 offset:320
  ds_read_b128 v[100:103], v1 offset:384
  ds_read_b128 v[104:107], v1 offset:448
  v_mul_f32 v232, v156, v176
  v_mul_f32 v234, v158, v178
  v_mul_f32 v233, v157, v176
  v_mul_f32 v235, v159, v178
  v_fma_f32 v232, -v157, v177, v232
  v_fma_f32 v234, -v159, v179, v234
  v_fmac_f32 v233, v156, v177
  v_fmac_f32 v235, v158, v179
  v_mul_f32 v164, v156, v136
  v_mul_f32 v166, v158, v138
  v_mul_f32 v165, v157, v136
  v_mul_f32 v167, v159, v138
  v_fma_f32 v164, -v157, v137, v164
  v_fma_f32 v166, -v159, v139, v166
  v_fmac_f32 v165, v156, v137
  v_fmac_f32 v167, v158, v139
  v_mul_f32 v172, v232, v148
  v_mul_f32 v174, v234, v150
  v_mul_f32 v173, v233, v148
  v_mul_f32 v175, v235, v150
  v_cvt_pk_bf16_f32 v128, v232, v233
  v_cvt_pk_bf16_f32 v129, v234, v235
  v_fma_f32 v172, -v233, v149, v172
  v_fma_f32 v174, -v235, v151, v174
  v_fmac_f32 v173, v232, v149
  v_fmac_f32 v175, v234, v151
  ds_write_addtid_b32 v128 offset:0
  ds_write_addtid_b32 v129 offset:256
  v_mul_f32 v180, v164, v148
  v_mul_f32 v182, v166, v150
  v_mul_f32 v181, v165, v148
  v_mul_f32 v183, v167, v150
  v_cvt_pk_bf16_f32 v130, v164, v165
  v_cvt_pk_bf16_f32 v131, v166, v167
  v_fma_f32 v180, -v165, v149, v180
  v_fma_f32 v182, -v167, v151, v182
  v_fmac_f32 v181, v164, v149
  v_fmac_f32 v183, v166, v151
  ds_write_addtid_b32 v130 offset:2176
  ds_write_addtid_b32 v131 offset:2432
  v_mul_f32 v168, v172, v148
  v_mul_f32 v170, v174, v150
  v_mul_f32 v169, v173, v148
  v_mul_f32 v171, v175, v150
  v_cvt_pk_bf16_f32 v132, v172, v173
  v_cvt_pk_bf16_f32 v133, v174, v175
  v_fma_f32 v168, -v173, v149, v168
  v_fma_f32 v170, -v175, v151, v170
  v_fmac_f32 v169, v172, v149
  v_fmac_f32 v171, v174, v151
  ds_write_addtid_b32 v132 offset:544
  ds_write_addtid_b32 v133 offset:800
  v_mul_f32 v188, v180, v148
  v_mul_f32 v190, v182, v150
  v_mul_f32 v189, v181, v148
  v_mul_f32 v191, v183, v150
  v_cvt_pk_bf16_f32 v134, v180, v181
  v_cvt_pk_bf16_f32 v135, v182, v183
  v_fma_f32 v188, -v181, v149, v188
  v_fma_f32 v190, -v183, v151, v190
  v_fmac_f32 v189, v180, v149
  v_fmac_f32 v191, v182, v151
  ds_write_addtid_b32 v134 offset:2720
  ds_write_addtid_b32 v135 offset:2976
  v_mul_f32 v228, v168, v148
  v_mul_f32 v230, v170, v150
  v_mul_f32 v229, v169, v148
  v_mul_f32 v231, v171, v150
  v_cvt_pk_bf16_f32 v128, v168, v169
  v_cvt_pk_bf16_f32 v129, v170, v171
  v_fma_f32 v228, -v169, v149, v228
  v_fma_f32 v230, -v171, v151, v230
  v_fmac_f32 v229, v168, v149
  v_fmac_f32 v231, v170, v151
  ds_write_addtid_b32 v128 offset:1088
  ds_write_addtid_b32 v129 offset:1344
  v_mul_f32 v184, v188, v148
  v_mul_f32 v186, v190, v150
  v_mul_f32 v185, v189, v148
  v_mul_f32 v187, v191, v150
  v_cvt_pk_bf16_f32 v130, v188, v189
  v_cvt_pk_bf16_f32 v131, v190, v191
  v_fma_f32 v184, -v189, v149, v184
  v_fma_f32 v186, -v191, v151, v186
  v_fmac_f32 v185, v188, v149
  v_fmac_f32 v187, v190, v151
  ds_write_addtid_b32 v130 offset:3264
  ds_write_addtid_b32 v131 offset:3520
  s_waitcnt lgkmcnt(15)
  v_mfma_f32_16x16x32_bf16 v[112:115], v[76:79], v[44:47], 0
  v_mfma_f32_16x16x32_bf16 v[112:115], v[80:83], v[48:51], v[112:115]
  v_mfma_f32_16x16x32_bf16 v[112:115], v[84:87], v[52:55], v[112:115]
  v_mfma_f32_16x16x32_bf16 v[112:115], v[88:91], v[56:59], v[112:115]
  v_mfma_f32_16x16x32_bf16 v[112:115], v[92:95], v[60:63], v[112:115]
  s_waitcnt lgkmcnt(14)
  v_mfma_f32_16x16x32_bf16 v[112:115], v[96:99], v[64:67], v[112:115]
  s_waitcnt lgkmcnt(13)
  v_mfma_f32_16x16x32_bf16 v[112:115], v[100:103], v[68:71], v[112:115]
  s_waitcnt lgkmcnt(12)
  v_mfma_f32_16x16x32_bf16 v[112:115], v[104:107], v[72:75], v[112:115]
  v_mul_f32 v236, v184, v148
  v_mul_f32 v238, v186, v150
  v_mul_f32 v237, v185, v148
  v_mul_f32 v239, v187, v150
  v_cvt_pk_bf16_f32 v132, v228, v229
  v_cvt_pk_bf16_f32 v133, v230, v231
  v_fma_f32 v236, -v185, v149, v236
  v_fma_f32 v238, -v187, v151, v238
  v_fmac_f32 v237, v184, v149
  v_fmac_f32 v239, v186, v151
  ds_write_addtid_b32 v132 offset:1632
  ds_write_addtid_b32 v133 offset:1888
  v_mul_f32 v144, v236, v148
  v_mul_f32 v146, v238, v150
  v_mul_f32 v145, v237, v148
  v_mul_f32 v147, v239, v150
  v_cvt_pk_bf16_f32 v134, v184, v185
  v_cvt_pk_bf16_f32 v135, v186, v187
  v_fma_f32 v144, -v237, v149, v144
  v_fma_f32 v146, -v239, v151, v146
  v_fmac_f32 v145, v236, v149
  v_fmac_f32 v147, v238, v151
  ds_write_addtid_b32 v134 offset:3808
  ds_write_addtid_b32 v135 offset:4064
  v_mul_f32 v152, v144, v148
  v_mul_f32 v154, v146, v150
  v_mul_f32 v153, v145, v148
  v_mul_f32 v155, v147, v150
  v_cvt_pk_bf16_f32 v128, v236, v237
  v_cvt_pk_bf16_f32 v129, v238, v239
  v_fma_f32 v152, -v145, v149, v152
  v_fma_f32 v154, -v147, v151, v154
  v_fmac_f32 v153, v144, v149
  v_fmac_f32 v155, v146, v151
  ds_write_addtid_b32 v128 offset:4352
  ds_write_addtid_b32 v129 offset:4608
  v_mul_f32 v160, v152, v148
  v_mul_f32 v162, v154, v150
  v_mul_f32 v161, v153, v148
  v_mul_f32 v163, v155, v150
  v_cvt_pk_bf16_f32 v130, v144, v145
  v_cvt_pk_bf16_f32 v131, v146, v147
  v_fma_f32 v160, -v153, v149, v160
  v_fma_f32 v162, -v155, v151, v162
  v_fmac_f32 v161, v152, v149
  v_fmac_f32 v163, v154, v151
  ds_write_addtid_b32 v130 offset:4896
  ds_write_addtid_b32 v131 offset:5152
  v_mul_f32 v192, v160, v148
  v_mul_f32 v194, v162, v150
  v_mul_f32 v193, v161, v148
  v_mul_f32 v195, v163, v150
  v_cvt_pk_bf16_f32 v132, v152, v153
  v_cvt_pk_bf16_f32 v133, v154, v155
  v_fma_f32 v192, -v161, v149, v192
  v_fma_f32 v194, -v163, v151, v194
  v_fmac_f32 v193, v160, v149
  v_fmac_f32 v195, v162, v151
  ds_write_addtid_b32 v132 offset:5440
  ds_write_addtid_b32 v133 offset:5696
  v_mul_f32 v140, v192, v148
  v_mul_f32 v142, v194, v150
  v_mul_f32 v141, v193, v148
  v_mul_f32 v143, v195, v150
  v_cvt_pk_bf16_f32 v134, v160, v161
  v_cvt_pk_bf16_f32 v135, v162, v163
  v_fma_f32 v140, -v193, v149, v140
  v_fma_f32 v142, -v195, v151, v142
  v_fmac_f32 v141, v192, v149
  v_fmac_f32 v143, v194, v151
  ds_write_addtid_b32 v134 offset:5984
  ds_write_addtid_b32 v135 offset:6240
  v_mul_f32 v156, v140, v148
  v_mul_f32 v158, v142, v150
  v_mul_f32 v157, v141, v148
  v_mul_f32 v159, v143, v150
  v_cvt_pk_bf16_f32 v128, v192, v193
  v_cvt_pk_bf16_f32 v129, v194, v195
  v_fma_f32 v156, -v141, v149, v156
  v_fma_f32 v158, -v143, v151, v158
  v_fmac_f32 v157, v140, v149
  v_fmac_f32 v159, v142, v151
  ds_write_addtid_b32 v128 offset:6528
  ds_write_addtid_b32 v129 offset:6784
  v_mul_f32 v176, v156, v148
  v_mul_f32 v178, v158, v150
  v_mul_f32 v177, v157, v148
  v_mul_f32 v179, v159, v150
  v_cvt_pk_bf16_f32 v130, v140, v141
  v_cvt_pk_bf16_f32 v131, v142, v143
  v_fma_f32 v176, -v157, v149, v176
  v_fma_f32 v178, -v159, v151, v178
  v_fmac_f32 v177, v156, v149
  v_fmac_f32 v179, v158, v151
  ds_write_addtid_b32 v130 offset:7072
  ds_write_addtid_b32 v131 offset:7328
  v_cvt_pk_bf16_f32 v132, v156, v157
  v_cvt_pk_bf16_f32 v133, v158, v159
  ds_write_addtid_b32 v132 offset:7616
  ds_write_addtid_b32 v133 offset:7872
  v_cvt_pk_bf16_f32 v134, v176, v177
  v_cvt_pk_bf16_f32 v135, v178, v179
  ds_write_addtid_b32 v134 offset:8160
  ds_write_addtid_b32 v135 offset:8416
  ds_read_b128 v[76:79], v1 offset:0
  ds_read_b128 v[80:83], v1 offset:64
  ds_read_b128 v[84:87], v1 offset:128
  ds_read_b128 v[88:91], v1 offset:192
  ds_read_b128 v[92:95], v1 offset:256
  ds_read_b128 v[96:99], v1 offset:320
  ds_read_b128 v[100:103], v1 offset:384
  ds_read_b128 v[104:107], v1 offset:448
L_tj_26:
  s_nop 1
  v_and_b32 v16, 15, v0
  v_lshrrev_b32 v17, 4, v0
  v_lshlrev_b32 v3, 5, v16
  v_lshl_add_u32 v3, v17, 4, v3
  s_add_u32 s67, s76, 32
  v_add_u32 v3, s67, v3
  v_and_b32 v18, 3, v0
  v_bfe_u32 v19, v0, 2, 2
  v_lshl_add_u32 v4, v18, 2, v19
  v_lshlrev_b32 v4, 5, v4
  v_lshl_add_u32 v4, v17, 4, v4
  s_add_u32 s67, s76, 528
  v_add_u32 v4, s67, v4
  v_sub_u32 v5, v18, v19
  v_lshlrev_b32 v5, 3, v5
  v_sub_u32 v18, 4, v17
  v_and_b32 v18, 3, v18
  v_mul_u32_u24 v18, 2112, v18
  v_min_u32 v19, 1, v17
  v_lshlrev_b32 v19, 3, v19
  v_sub_u32 v18, v18, v19
  s_add_u32 s67, s75, 1024
  v_add3_u32 v5, v5, v18, s67
  v_lshrrev_b32 v18, 1, v17
  v_lshrrev_b32 v19, 2, v16
  v_lshl_add_u32 v19, v19, 1, v18
  v_mul_u32_u24 v19, 96, v19
  v_and_b32 v6, 3, v16
  v_lshl_add_u32 v19, v6, 4, v19
  v_mul_u32_u24 v6, 160, v18
  v_lshl_add_u32 v6, v16, 4, v6
  v_add_u32 v6, 256, v6
  v_cmp_gt_u32 vcc, 8, v16
  s_nop 1
  v_cndmask_b32 v6, v6, v19, vcc
  v_and_b32 v19, 1, v17
  v_lshl_add_u32 v6, v19, 3, v6
  s_add_u32 s67, s75, 1184
  v_add_u32 v6, s67, v6
  v_and_b32 v8, 7, v16
  v_lshlrev_b32 v8, 1, v8
  v_lshrrev_b32 v7, 3, v16
  v_add_u32 v8, v8, v7
  v_lshlrev_b32 v8, 4, v8
  v_lshl_add_u32 v7, v18, 8, v8
  v_lshl_add_u32 v7, v19, 3, v7
  s_add_u32 s67, s75, 1080
  v_sub_u32 v7, s67, v7
  v_lshl_add_u32 v8, v17, 8, v8
  s_add_u32 s67, s75, 556
  v_sub_u32 v8, s67, v8
  v_sub_u32 v18, 15, v16
  v_and_b32 v19, 3, v18
  v_mul_u32_u24 v9, 2112, v19
  v_lshrrev_b32 v18, 2, v18
  v_lshl_add_u32 v9, v18, 3, v9
  v_lshl_add_u32 v9, v17, 4, v9
  v_add_u32 v9, s75, v9
  ds_write_b128 v11, v[116:119]
  ds_write_b128 v11, v[116:119] offset:1024
  v_lshlrev_b32 v18, 16, v249
  s_mov_b64 exec, 1
  v_add_f32 v108, v108, v18
  s_mov_b64 exec, -1
  v_cvt_pk_bf16_f32 v228, v111, v110
  v_cvt_pk_bf16_f32 v229, v109, v108
  v_cvt_pk_bf16_f32 v232, v115, v115
  v_cvt_pk_bf16_f32 v233, v115, v114
  v_cvt_pk_bf16_f32 v234, v113, v113
  v_cvt_pk_bf16_f32 v235, v113, v112
  v_cvt_pk_bf16_f32 v230, v112, v112
  v_mov_b32 v19, s75
  s_waitcnt lgkmcnt(9)
  v_mfma_f32_16x16x32_bf16 v[240:243], v[44:47], v[76:79], 0
  s_waitcnt lgkmcnt(8)
  v_mfma_f32_16x16x32_bf16 v[240:243], v[48:51], v[80:83], v[240:243]
  s_waitcnt lgkmcnt(7)
  v_mfma_f32_16x16x32_bf16 v[240:243], v[52:55], v[84:87], v[240:243]
  s_waitcnt lgkmcnt(6)
  v_mfma_f32_16x16x32_bf16 v[240:243], v[56:59], v[88:91], v[240:243]
  s_waitcnt lgkmcnt(5)
  v_mfma_f32_16x16x32_bf16 v[240:243], v[60:63], v[92:95], v[240:243]
  s_waitcnt lgkmcnt(4)
  v_mfma_f32_16x16x32_bf16 v[240:243], v[64:67], v[96:99], v[240:243]
  s_waitcnt lgkmcnt(3)
  v_mfma_f32_16x16x32_bf16 v[240:243], v[68:71], v[100:103], v[240:243]
  s_waitcnt lgkmcnt(2)
  v_mfma_f32_16x16x32_bf16 v[240:243], v[72:75], v[104:107], v[240:243]
  ds_write_b64 v7, v[228:229]
  s_mov_b32 exec_hi, 0
  ds_write2_b32 v8, v232, v233 offset0:0 offset1:1
  ds_write2_b32 v8, v234, v235 offset0:2 offset1:3
  s_mov_b32 exec_lo, 0x80000000
  ds_write_b16 v19, v232 offset:58
  s_mov_b32 exec_lo, 0
  s_mov_b32 exec_hi, 1
  ds_write_b32 v19, v230 offset:572
  s_mov_b64 exec, -1
  s_getpc_b64 s[78:79]
L_ssm_pc_30:
  s_add_u32 s78, s78, L_wtab-L_ssm_pc_30
  s_addc_u32 s79, s79, 0
  global_load_dwordx4 v[20:23], v10, s[78:79] offset:0
  global_load_dwordx4 v[24:27], v10, s[78:79] offset:1024
  global_load_dwordx4 v[28:31], v10, s[78:79] offset:2048
  global_load_dwordx4 v[32:35], v10, s[78:79] offset:3072
  s_add_u32 s78, s78, 4096
  s_addc_u32 s79, s79, 0
  global_load_dwordx4 v[36:39], v10, s[78:79] offset:0
  global_load_dwordx4 v[40:43], v10, s[78:79] offset:1024
  v_readlane_b32 s77, v243, 55
  s_mov_b32 exec_lo, 0
  s_mov_b32 exec_hi, 0x800000
  v_mov_b32 v243, 0
  s_mov_b64 exec, -1
  v_cvt_pk_bf16_f32 v236, v240, v241
  v_cvt_pk_bf16_f32 v237, v242, v243
  v_mov_b32 v19, s77
  v_cvt_pk_bf16_f32 v19, v19, v19
  v_lshl_add_u32 v18, v0, 1, s75
  ds_write_b64 v6, v[236:237]
  s_mov_b64 exec, 0x7f
  ds_write_b16 v18, v19 offset:1126
  s_mov_b64 exec, -1
  ds_read_b128 v[44:47], v11 offset:0
  ds_read_b64 v[48:49], v11 offset:16
  ds_read_b128 v[52:55], v11 offset:1024
  ds_read_b64 v[56:57], v11 offset:1040
  s_waitcnt lgkmcnt(3)
  v_alignbit_b32 v60, v45, v44, 16
  v_alignbit_b32 v61, v46, v45, 16
  v_alignbit_b32 v62, v47, v46, 16
  s_waitcnt lgkmcnt(2)
  v_alignbit_b32 v63, v48, v47, 16
  ds_write_b128 v11, v[60:63] offset:2112
  v_mov_b32 v64, v45
  v_mov_b32 v65, v46
  v_mov_b32 v66, v47
  v_mov_b32 v67, v48
  ds_write_b128 v11, v[64:67] offset:4224
  v_alignbit_b32 v68, v46, v45, 16
  v_alignbit_b32 v69, v47, v46, 16
  v_alignbit_b32 v70, v48, v47, 16
  v_alignbit_b32 v71, v49, v48, 16
  ds_write_b128 v11, v[68:71] offset:6336
  s_waitcnt lgkmcnt(4)
  v_alignbit_b32 v72, v53, v52, 16
  v_alignbit_b32 v73, v54, v53, 16
  v_alignbit_b32 v74, v55, v54, 16
  s_waitcnt lgkmcnt(3)
  v_alignbit_b32 v75, v56, v55, 16
  ds_write_b128 v11, v[72:75] offset:3136
  v_mov_b32 v76, v53
  v_mov_b32 v77, v54
  v_mov_b32 v78, v55
  v_mov_b32 v79, v56
  ds_write_b128 v11, v[76:79] offset:5248
  v_alignbit_b32 v80, v54, v53, 16
  v_alignbit_b32 v81, v55, v54, 16
  v_alignbit_b32 v82, v56, v55, 16
  v_alignbit_b32 v83, v57, v56, 16
  ds_write_b128 v11, v[80:83] offset:7360
  s_cmp_eq_u32 s83, 0
  s_cbranch_scc0 L_na_31
  s_mov_b32 s84, 0x05040100
  s_mov_b32 s85, 0x07060302
  s_lshl_b32 s70, s82, 10
  s_add_u32 s70, s70, 51168
  v_add_u32 v2, s70, v10
  v_add_u32 v14, 93728, v2
  v_mov_b32 v18, 1
  s_waitcnt vmcnt(6)
  s_setprio 3
  v_perm_b32 v84, v202, v198, s84
  v_perm_b32 v85, v210, v206, s84
  v_perm_b32 v86, v218, v214, s84
  v_perm_b32 v87, v226, v222, s84
  ds_write_b128 v2, v[84:87] offset:0
  v_perm_b32 v88, v202, v198, s85
  v_perm_b32 v89, v210, v206, s85
  v_perm_b32 v90, v218, v214, s85
  v_perm_b32 v91, v226, v222, s85
  ds_write_b128 v2, v[88:91] offset:20736
  v_perm_b32 v92, v203, v199, s84
  v_perm_b32 v93, v211, v207, s84
  v_perm_b32 v94, v219, v215, s84
  v_perm_b32 v95, v227, v223, s84
  ds_write_b128 v2, v[92:95] offset:41472
  v_perm_b32 v96, v203, v199, s85
  v_perm_b32 v97, v211, v207, s85
  v_perm_b32 v98, v219, v215, s85
  v_perm_b32 v99, v227, v223, s85
  ds_write_b128 v2, v[96:99] offset:62208
  s_mov_b64 exec, 1
  ds_add_u32 v12, v18 offset:8
  s_mov_b64 exec, -1
  s_setprio 3

L_na_31:
  ds_read_b64 v[148:149], v9 offset:512
  ds_read_b64 v[150:151], v9 offset:520
  ds_read_b64 v[180:181], v9 offset:0
  ds_read_b64 v[182:183], v9 offset:8
  ds_read_b64 v[144:145], v9 offset:576
  ds_read_b64 v[146:147], v9 offset:584
  ds_read_b64 v[176:177], v9 offset:64
  ds_read_b64 v[178:179], v9 offset:72
  ds_read_b64 v[140:141], v9 offset:640
  ds_read_b64 v[142:143], v9 offset:648
  ds_read_b64 v[172:173], v9 offset:128
  ds_read_b64 v[174:175], v9 offset:136
  ds_read_b64 v[136:137], v9 offset:704
  ds_read_b64 v[138:139], v9 offset:712
  ds_read_b64 v[168:169], v9 offset:192
  ds_read_b64 v[170:171], v9 offset:200
  ds_read_b64 v[132:133], v9 offset:768
  ds_read_b64 v[134:135], v9 offset:776
  ds_read_b64 v[164:165], v9 offset:256
  ds_read_b64 v[166:167], v9 offset:264
  ds_read_b64 v[128:129], v9 offset:832
  ds_read_b64 v[130:131], v9 offset:840
  ds_read_b64 v[160:161], v9 offset:320
  ds_read_b64 v[162:163], v9 offset:328
  ds_read_b64 v[124:125], v9 offset:896
  ds_read_b64 v[126:127], v9 offset:904
  ds_read_b64 v[156:157], v9 offset:384
  ds_read_b64 v[158:159], v9 offset:392
  ds_read_b64 v[120:121], v9 offset:960
  ds_read_b64 v[122:123], v9 offset:968
  ds_read_b64 v[152:153], v9 offset:448
  ds_read_b64 v[154:155], v9 offset:456
  ds_read_b64 v[116:117], v9 offset:1024
  ds_read_b64 v[118:119], v9 offset:1032
  ds_read_b64 v[184:185], v9 offset:1088
  ds_read_b64 v[186:187], v9 offset:1096
  ds_read_b64_tr_b16 v[76:77], v5 offset:160
  ds_read_b64_tr_b16 v[78:79], v5 offset:256
  ds_read_b64_tr_b16 v[80:81], v5 offset:192
  ds_read_b64_tr_b16 v[82:83], v5 offset:288
  ds_read_b64_tr_b16 v[84:85], v5 offset:224
  ds_read_b64_tr_b16 v[86:87], v5 offset:320
  ds_read_b64_tr_b16 v[88:89], v5 offset:352
  ds_read_b64_tr_b16 v[90:91], v5 offset:448
  ds_read_b64_tr_b16 v[92:93], v5 offset:384
  ds_read_b64_tr_b16 v[94:95], v5 offset:480
  ds_read_b64_tr_b16 v[96:97], v5 offset:416
  ds_read_b64_tr_b16 v[98:99], v5 offset:512
  ds_read_b64_tr_b16 v[100:101], v5 offset:544
  ds_read_b64_tr_b16 v[102:103], v5 offset:704
  ds_read_b64_tr_b16 v[104:105], v5 offset:576
  ds_read_b64_tr_b16 v[106:107], v5 offset:736
  ds_read_b64_tr_b16 v[108:109], v5 offset:608
  ds_read_b64_tr_b16 v[110:111], v5 offset:768
  ds_read_b64_tr_b16 v[112:113], v5 offset:640
  ds_read_b64_tr_b16 v[114:115], v5 offset:800
  s_cmp_eq_u32 s83, 0
  s_cbranch_scc0 L_na_32
  v_mov_b32 v18, 0x100
  v_perm_b32 v44, v200, v196, s84
  v_perm_b32 v45, v208, v204, s84
  v_perm_b32 v46, v216, v212, s84
  v_perm_b32 v47, v224, v220, s84
  ds_write_b128 v14, v[44:47] offset:0
  v_perm_b32 v48, v200, v196, s85
  v_perm_b32 v49, v208, v204, s85
  v_perm_b32 v50, v216, v212, s85
  v_perm_b32 v51, v224, v220, s85
  ds_write_b128 v14, v[48:51] offset:4672
  v_perm_b32 v52, v201, v197, s84
  v_perm_b32 v53, v209, v205, s84
  v_perm_b32 v54, v217, v213, s84
  v_perm_b32 v55, v225, v221, s84
  ds_write_b128 v14, v[52:55] offset:9344
  v_perm_b32 v56, v201, v197, s85
  v_perm_b32 v57, v209, v205, s85
  v_perm_b32 v58, v217, v213, s85
  v_perm_b32 v59, v225, v221, s85
  ds_write_b128 v14, v[56:59] offset:14016
  s_mov_b64 exec, 1
  ds_add_u32 v12, v18 offset:8
  s_mov_b64 exec, -1
L_na_32:
  s_lshl_b32 s70, s83, 3
  s_mov_b32 s68, 0
  s_branch L_x0_35
L_xw_33:
  s_sleep 2
L_x0_35:
  ds_read_b32 v18, v12 offset:8
  s_add_u32 s68, s68, 1
  s_cmp_gt_u32 s68, 8192
  s_cbranch_scc1 L_xe_34
  s_waitcnt lgkmcnt(0)
  v_readfirstlane_b32 s67, v18
  s_lshr_b32 s67, s67, s70
  s_and_b32 s67, s67, 0xff
  s_cmp_lt_u32 s67, 4
  s_cbranch_scc1 L_xw_33
L_xe_34:
  s_setprio 1
  s_waitcnt vmcnt(0)
  s_cmp_eq_u32 s83, 1
  s_cbranch_scc0 L_na_36
  s_setprio 0
L_na_36:
  ds_read_b128 v[188:191], v3 offset:0
  ds_read_b128 v[192:195], v3 offset:64
  ds_read_b128 v[196:199], v3 offset:128
  ds_read_b128 v[200:203], v3 offset:192
  ds_read_b128 v[204:207], v3 offset:256
  ds_read_b128 v[212:215], v4 offset:16
  ds_read_b128 v[216:219], v4 offset:0
  s_waitcnt lgkmcnt(6)
  v_mfma_f32_16x16x32_bf16 v[44:47], v[148:151], v[188:191], 0
  ds_read_b128 v[208:211], v3 offset:320
  v_mfma_f32_16x16x32_bf16 v[48:51], v[180:183], v[188:191], 0
  s_waitcnt lgkmcnt(6)
  v_mfma_f32_16x16x32_bf16 v[44:47], v[144:147], v[192:195], v[44:47]
  ds_read_b128 v[188:191], v3 offset:384
  v_mfma_f32_16x16x32_bf16 v[48:51], v[176:179], v[192:195], v[48:51]
  s_waitcnt lgkmcnt(6)
  v_mfma_f32_16x16x32_bf16 v[44:47], v[140:143], v[196:199], v[44:47]
  ds_read_b128 v[192:195], v3 offset:448
  v_mfma_f32_16x16x32_bf16 v[48:51], v[172:175], v[196:199], v[48:51]
  s_waitcnt lgkmcnt(4)
  v_mfma_f32_16x16x32_bf16 v[220:223], v[212:215], v[20:23], 0
  v_mfma_f32_16x16x32_bf16 v[224:227], v[212:215], v[24:27], 0
  v_mfma_f32_16x16x32_bf16 v[228:231], v[212:215], v[28:31], 0
  s_waitcnt lgkmcnt(3)
  v_mfma_f32_16x16x32_bf16 v[232:235], v[216:219], v[32:35], 0
  v_mfma_f32_16x16x32_bf16 v[236:239], v[212:215], v[36:39], 0
  v_mfma_f32_16x16x32_bf16 v[240:243], v[216:219], v[40:43], 0
  v_mfma_f32_16x16x32_bf16 v[44:47], v[136:139], v[200:203], v[44:47]
  ds_read_b128 v[196:199], v3 offset:512
  v_mfma_f32_16x16x32_bf16 v[48:51], v[168:171], v[200:203], v[48:51]
  v_mfma_f32_16x16x32_bf16 v[44:47], v[132:135], v[204:207], v[44:47]
  ds_read_b128 v[200:203], v3 offset:576
  v_mfma_f32_16x16x32_bf16 v[48:51], v[164:167], v[204:207], v[48:51]
  s_waitcnt lgkmcnt(4)
  v_mfma_f32_16x16x32_bf16 v[44:47], v[128:131], v[208:211], v[44:47]
  ds_read_b128 v[204:207], v3 offset:640
  v_cvt_pk_bf16_f32 v244, v220, v221
  v_mfma_f32_16x16x32_bf16 v[48:51], v[160:163], v[208:211], v[48:51]
  v_cvt_pk_bf16_f32 v245, v222, v223
  v_cvt_pk_bf16_f32 v246, v224, v225
  s_waitcnt lgkmcnt(4)
  v_mfma_f32_16x16x32_bf16 v[44:47], v[124:127], v[188:191], v[44:47]
  ds_read_b128 v[208:211], v3 offset:704
  v_cvt_pk_bf16_f32 v247, v226, v227
  v_mfma_f32_16x16x32_bf16 v[48:51], v[156:159], v[188:191], v[48:51]
  v_cvt_pk_bf16_f32 v248, v228, v229
  v_cvt_pk_bf16_f32 v249, v230, v231
  s_waitcnt lgkmcnt(4)
  v_mfma_f32_16x16x32_bf16 v[44:47], v[120:123], v[192:195], v[44:47]
  ds_read_b128 v[188:191], v3 offset:768
  v_cvt_pk_bf16_f32 v250, v232, v233
  v_mfma_f32_16x16x32_bf16 v[48:51], v[152:155], v[192:195], v[48:51]
  v_cvt_pk_bf16_f32 v251, v234, v235
  v_cvt_pk_bf16_f32 v16, v236, v237
  s_waitcnt lgkmcnt(4)
  v_mfma_f32_16x16x32_bf16 v[44:47], v[116:119], v[196:199], v[44:47]
  ds_read_b128 v[192:195], v3 offset:832
  v_cvt_pk_bf16_f32 v17, v238, v239
  v_mfma_f32_16x16x32_bf16 v[48:51], v[148:151], v[196:199], v[48:51]
  v_cvt_pk_bf16_f32 v18, v240, v241
  v_cvt_pk_bf16_f32 v19, v242, v243
  v_mfma_f32_16x16x32_bf16 v[52:55], v[180:183], v[196:199], 0
  s_waitcnt lgkmcnt(4)
  v_mfma_f32_16x16x32_bf16 v[48:51], v[144:147], v[200:203], v[48:51]
  ds_read_b128 v[196:199], v3 offset:896
  v_mfma_f32_16x16x32_bf16 v[52:55], v[176:179], v[200:203], v[52:55]
  v_mfma_f32_16x16x32_bf16 v[52:55], v[244:247], v[76:79], v[52:55]
  v_mfma_f32_16x16x32_bf16 v[56:59], v[244:247], v[80:83], 0
  v_mfma_f32_16x16x32_bf16 v[60:63], v[244:247], v[84:87], 0
  v_mfma_f32_16x16x32_bf16 v[52:55], v[248:251], v[88:91], v[52:55]
  v_mfma_f32_16x16x32_bf16 v[56:59], v[248:251], v[92:95], v[56:59]
  v_mfma_f32_16x16x32_bf16 v[60:63], v[248:251], v[96:99], v[60:63]
  v_mfma_f32_16x16x32_bf16 v[60:63], v[16:19], v[100:103], v[60:63]
  v_mfma_f32_16x16x32_bf16 v[64:67], v[16:19], v[104:107], 0
  v_mfma_f32_16x16x32_bf16 v[68:71], v[16:19], v[108:111], 0
  v_mfma_f32_16x16x32_bf16 v[72:75], v[16:19], v[112:115], 0
  s_waitcnt lgkmcnt(4)
  v_mfma_f32_16x16x32_bf16 v[48:51], v[140:143], v[204:207], v[48:51]
  ds_read_b128 v[200:203], v3 offset:960
  v_mfma_f32_16x16x32_bf16 v[52:55], v[172:175], v[204:207], v[52:55]
  ds_read_b128 v[212:215], v4 offset:528
  ds_read_b128 v[216:219], v4 offset:512
  s_waitcnt lgkmcnt(6)
  v_mfma_f32_16x16x32_bf16 v[48:51], v[136:139], v[208:211], v[48:51]
  ds_read_b128 v[204:207], v3 offset:1024
  v_mfma_f32_16x16x32_bf16 v[52:55], v[168:171], v[208:211], v[52:55]
  s_waitcnt lgkmcnt(6)
  v_mfma_f32_16x16x32_bf16 v[48:51], v[132:135], v[188:191], v[48:51]
  ds_read_b128 v[208:211], v3 offset:1088
  v_mfma_f32_16x16x32_bf16 v[52:55], v[164:167], v[188:191], v[52:55]
  s_waitcnt lgkmcnt(6)
  v_mfma_f32_16x16x32_bf16 v[48:51], v[128:131], v[192:195], v[48:51]
  ds_read_b128 v[188:191], v3 offset:1152
  v_mfma_f32_16x16x32_bf16 v[52:55], v[160:163], v[192:195], v[52:55]
  s_waitcnt lgkmcnt(4)
  v_mfma_f32_16x16x32_bf16 v[220:223], v[212:215], v[20:23], 0
  v_mfma_f32_16x16x32_bf16 v[224:227], v[212:215], v[24:27], 0
  v_mfma_f32_16x16x32_bf16 v[228:231], v[212:215], v[28:31], 0
  s_waitcnt lgkmcnt(3)
  v_mfma_f32_16x16x32_bf16 v[232:235], v[216:219], v[32:35], 0
  v_mfma_f32_16x16x32_bf16 v[236:239], v[212:215], v[36:39], 0
  v_mfma_f32_16x16x32_bf16 v[240:243], v[216:219], v[40:43], 0
  v_mfma_f32_16x16x32_bf16 v[48:51], v[124:127], v[196:199], v[48:51]
  ds_read_b128 v[192:195], v3 offset:1216
  v_mfma_f32_16x16x32_bf16 v[52:55], v[156:159], v[196:199], v[52:55]
  v_mfma_f32_16x16x32_bf16 v[48:51], v[120:123], v[200:203], v[48:51]
  ds_read_b128 v[196:199], v3 offset:1280
  v_mfma_f32_16x16x32_bf16 v[52:55], v[152:155], v[200:203], v[52:55]
  s_waitcnt lgkmcnt(4)
  v_mfma_f32_16x16x32_bf16 v[48:51], v[116:119], v[204:207], v[48:51]
  ds_read_b128 v[200:203], v3 offset:1344
  v_cvt_pk_bf16_f32 v244, v220, v221
  v_mfma_f32_16x16x32_bf16 v[52:55], v[148:151], v[204:207], v[52:55]
  v_cvt_pk_bf16_f32 v245, v222, v223
  v_cvt_pk_bf16_f32 v246, v224, v225
  v_mfma_f32_16x16x32_bf16 v[56:59], v[180:183], v[204:207], v[56:59]
  v_cvt_pk_bf16_f32 v247, v226, v227
  v_cvt_pk_bf16_f32 v248, v228, v229
  s_waitcnt lgkmcnt(4)
  v_mfma_f32_16x16x32_bf16 v[52:55], v[144:147], v[208:211], v[52:55]
  ds_read_b128 v[204:207], v3 offset:1408
  v_cvt_pk_bf16_f32 v249, v230, v231
  v_mfma_f32_16x16x32_bf16 v[56:59], v[176:179], v[208:211], v[56:59]
  v_cvt_pk_bf16_f32 v250, v232, v233
  v_cvt_pk_bf16_f32 v251, v234, v235
  s_waitcnt lgkmcnt(4)
  v_mfma_f32_16x16x32_bf16 v[52:55], v[140:143], v[188:191], v[52:55]
  ds_read_b128 v[208:211], v3 offset:1472
  v_cvt_pk_bf16_f32 v16, v236, v237
  v_mfma_f32_16x16x32_bf16 v[56:59], v[172:175], v[188:191], v[56:59]
  v_cvt_pk_bf16_f32 v17, v238, v239
  v_cvt_pk_bf16_f32 v18, v240, v241
  s_waitcnt lgkmcnt(4)
  v_mfma_f32_16x16x32_bf16 v[52:55], v[136:139], v[192:195], v[52:55]
  ds_read_b128 v[188:191], v3 offset:1536
  v_cvt_pk_bf16_f32 v19, v242, v243
  v_mfma_f32_16x16x32_bf16 v[56:59], v[168:171], v[192:195], v[56:59]
  v_mov_b32 v13, 0
  buffer_load_dword v14, v13, s[56:59], 0 offen sc1
  s_waitcnt lgkmcnt(4)
  v_mfma_f32_16x16x32_bf16 v[52:55], v[132:135], v[196:199], v[52:55]
  ds_read_b128 v[192:195], v3 offset:1600
  v_mfma_f32_16x16x32_bf16 v[56:59], v[164:167], v[196:199], v[56:59]
  v_mfma_f32_16x16x32_bf16 v[56:59], v[244:247], v[76:79], v[56:59]
  v_mfma_f32_16x16x32_bf16 v[60:63], v[244:247], v[80:83], v[60:63]
  v_mfma_f32_16x16x32_bf16 v[64:67], v[244:247], v[84:87], v[64:67]
  v_mfma_f32_16x16x32_bf16 v[56:59], v[248:251], v[88:91], v[56:59]
  v_mfma_f32_16x16x32_bf16 v[60:63], v[248:251], v[92:95], v[60:63]
  v_mfma_f32_16x16x32_bf16 v[64:67], v[248:251], v[96:99], v[64:67]
  v_mfma_f32_16x16x32_bf16 v[64:67], v[16:19], v[100:103], v[64:67]
  v_mfma_f32_16x16x32_bf16 v[68:71], v[16:19], v[104:107], v[68:71]
  v_mfma_f32_16x16x32_bf16 v[72:75], v[16:19], v[108:111], v[72:75]
  s_waitcnt lgkmcnt(4)
  v_mfma_f32_16x16x32_bf16 v[52:55], v[128:131], v[200:203], v[52:55]
  ds_read_b128 v[196:199], v3 offset:1664
  v_mfma_f32_16x16x32_bf16 v[56:59], v[160:163], v[200:203], v[56:59]
  ds_read_b128 v[212:215], v4 offset:1040
  ds_read_b128 v[216:219], v4 offset:1024
  s_waitcnt lgkmcnt(6)
  v_mfma_f32_16x16x32_bf16 v[52:55], v[124:127], v[204:207], v[52:55]
  ds_read_b128 v[200:203], v3 offset:1728
  v_mfma_f32_16x16x32_bf16 v[56:59], v[156:159], v[204:207], v[56:59]
  s_waitcnt lgkmcnt(6)
  v_mfma_f32_16x16x32_bf16 v[52:55], v[120:123], v[208:211], v[52:55]
  ds_read_b128 v[204:207], v3 offset:1792
  v_mfma_f32_16x16x32_bf16 v[56:59], v[152:155], v[208:211], v[56:59]
  s_waitcnt lgkmcnt(6)
  v_mfma_f32_16x16x32_bf16 v[52:55], v[116:119], v[188:191], v[52:55]
  ds_read_b128 v[208:211], v3 offset:1856
  v_mfma_f32_16x16x32_bf16 v[56:59], v[148:151], v[188:191], v[56:59]
  v_mfma_f32_16x16x32_bf16 v[60:63], v[180:183], v[188:191], v[60:63]
  s_waitcnt lgkmcnt(4)
  v_mfma_f32_16x16x32_bf16 v[220:223], v[212:215], v[20:23], 0
  v_mfma_f32_16x16x32_bf16 v[224:227], v[212:215], v[24:27], 0
  v_mfma_f32_16x16x32_bf16 v[228:231], v[212:215], v[28:31], 0
  s_waitcnt lgkmcnt(3)
  v_mfma_f32_16x16x32_bf16 v[232:235], v[216:219], v[32:35], 0
  v_mfma_f32_16x16x32_bf16 v[236:239], v[212:215], v[36:39], 0
  v_mfma_f32_16x16x32_bf16 v[240:243], v[216:219], v[40:43], 0
  v_mfma_f32_16x16x32_bf16 v[56:59], v[144:147], v[192:195], v[56:59]
  ds_read_b128 v[188:191], v3 offset:1920
  v_mfma_f32_16x16x32_bf16 v[60:63], v[176:179], v[192:195], v[60:63]
  v_mfma_f32_16x16x32_bf16 v[56:59], v[140:143], v[196:199], v[56:59]
  ds_read_b128 v[192:195], v3 offset:1984
  v_mfma_f32_16x16x32_bf16 v[60:63], v[172:175], v[196:199], v[60:63]
  s_waitcnt lgkmcnt(4)
  v_mfma_f32_16x16x32_bf16 v[56:59], v[136:139], v[200:203], v[56:59]
  ds_read_b128 v[196:199], v3 offset:2048
  v_cvt_pk_bf16_f32 v244, v220, v221
  v_mfma_f32_16x16x32_bf16 v[60:63], v[168:171], v[200:203], v[60:63]
  v_cvt_pk_bf16_f32 v245, v222, v223
  v_cvt_pk_bf16_f32 v246, v224, v225
  s_waitcnt lgkmcnt(4)
  v_mfma_f32_16x16x32_bf16 v[56:59], v[132:135], v[204:207], v[56:59]
  ds_read_b128 v[200:203], v3 offset:2112
  v_cvt_pk_bf16_f32 v247, v226, v227
  v_mfma_f32_16x16x32_bf16 v[60:63], v[164:167], v[204:207], v[60:63]
  v_cvt_pk_bf16_f32 v248, v228, v229
  v_cvt_pk_bf16_f32 v249, v230, v231
  s_waitcnt lgkmcnt(4)
  v_mfma_f32_16x16x32_bf16 v[56:59], v[128:131], v[208:211], v[56:59]
  ds_read_b128 v[204:207], v3 offset:2176
  v_cvt_pk_bf16_f32 v250, v232, v233
  v_mfma_f32_16x16x32_bf16 v[60:63], v[160:163], v[208:211], v[60:63]
  v_cvt_pk_bf16_f32 v251, v234, v235
  v_cvt_pk_bf16_f32 v16, v236, v237
  s_waitcnt lgkmcnt(4)
  v_mfma_f32_16x16x32_bf16 v[56:59], v[124:127], v[188:191], v[56:59]
  ds_read_b128 v[208:211], v3 offset:2240
  v_cvt_pk_bf16_f32 v17, v238, v239
  v_mfma_f32_16x16x32_bf16 v[60:63], v[156:159], v[188:191], v[60:63]
  v_cvt_pk_bf16_f32 v18, v240, v241
  v_cvt_pk_bf16_f32 v19, v242, v243
  s_waitcnt lgkmcnt(4)
  v_mfma_f32_16x16x32_bf16 v[56:59], v[120:123], v[192:195], v[56:59]
  ds_read_b128 v[188:191], v3 offset:2304
  v_mfma_f32_16x16x32_bf16 v[60:63], v[152:155], v[192:195], v[60:63]
  v_mfma_f32_16x16x32_bf16 v[60:63], v[244:247], v[76:79], v[60:63]
  v_mfma_f32_16x16x32_bf16 v[64:67], v[244:247], v[80:83], v[64:67]
  v_mfma_f32_16x16x32_bf16 v[68:71], v[244:247], v[84:87], v[68:71]
  v_mfma_f32_16x16x32_bf16 v[60:63], v[248:251], v[88:91], v[60:63]
  v_mfma_f32_16x16x32_bf16 v[64:67], v[248:251], v[92:95], v[64:67]
  v_mfma_f32_16x16x32_bf16 v[68:71], v[248:251], v[96:99], v[68:71]
  v_mfma_f32_16x16x32_bf16 v[68:71], v[16:19], v[100:103], v[68:71]
  v_mfma_f32_16x16x32_bf16 v[72:75], v[16:19], v[104:107], v[72:75]
  s_waitcnt lgkmcnt(4)
  v_mfma_f32_16x16x32_bf16 v[56:59], v[116:119], v[196:199], v[56:59]
  ds_read_b128 v[192:195], v3 offset:2368
  v_mfma_f32_16x16x32_bf16 v[60:63], v[148:151], v[196:199], v[60:63]
  v_mfma_f32_16x16x32_bf16 v[64:67], v[180:183], v[196:199], v[64:67]
  ds_read_b128 v[212:215], v4 offset:1552
  ds_read_b128 v[216:219], v4 offset:1536
  s_waitcnt lgkmcnt(6)
  v_mfma_f32_16x16x32_bf16 v[60:63], v[144:147], v[200:203], v[60:63]
  ds_read_b128 v[196:199], v3 offset:2432
  v_mfma_f32_16x16x32_bf16 v[64:67], v[176:179], v[200:203], v[64:67]
  s_waitcnt lgkmcnt(6)
  v_mfma_f32_16x16x32_bf16 v[60:63], v[140:143], v[204:207], v[60:63]
  ds_read_b128 v[200:203], v3 offset:2496
  v_mfma_f32_16x16x32_bf16 v[64:67], v[172:175], v[204:207], v[64:67]
  s_waitcnt vmcnt(0)
  v_readfirstlane_b32 s50, v14
  s_bfe_u32 s51, s2, 0x10002
  s_lshl_b32 s51, s51, 4
  s_add_u32 s51, s51, s64
  s_mul_i32 s51, s51, 20736
  s_add_u32 s51, s51, 6208512
  s_sub_u32 s84, s75, 7168
  s_cmp_ge_u32 s50, 8
  s_cselect_b32 s50, 1, 0
  s_andn2_b32 s50, s50, s83
  s_waitcnt lgkmcnt(6)
  v_mfma_f32_16x16x32_bf16 v[60:63], v[136:139], v[208:211], v[60:63]
  ds_read_b128 v[204:207], v3 offset:2560
  v_mfma_f32_16x16x32_bf16 v[64:67], v[168:171], v[208:211], v[64:67]
  s_cmp_eq_u32 s50, 0
  s_cbranch_scc1 L_nd_37
  s_add_u32 m0, s84, 0
  s_add_u32 s85, s51, 0
  buffer_load_dwordx4 v10, s[52:55], s85 offen offset:0 sc1 lds
  buffer_load_dwordx4 v10, s[52:55], s85 offen offset:1024 sc1 lds
  buffer_load_dwordx4 v10, s[52:55], s85 offen offset:2048 sc1 lds
  buffer_load_dwordx4 v10, s[52:55], s85 offen offset:3072 sc1 lds
L_nd_37:
  s_waitcnt lgkmcnt(4)
  v_mfma_f32_16x16x32_bf16 v[220:223], v[212:215], v[20:23], 0
  v_mfma_f32_16x16x32_bf16 v[224:227], v[212:215], v[24:27], 0
  v_mfma_f32_16x16x32_bf16 v[228:231], v[212:215], v[28:31], 0
  s_waitcnt lgkmcnt(3)
  v_mfma_f32_16x16x32_bf16 v[232:235], v[216:219], v[32:35], 0
  v_mfma_f32_16x16x32_bf16 v[236:239], v[212:215], v[36:39], 0
  v_mfma_f32_16x16x32_bf16 v[240:243], v[216:219], v[40:43], 0
  v_mfma_f32_16x16x32_bf16 v[60:63], v[132:135], v[188:191], v[60:63]
  ds_read_b128 v[208:211], v3 offset:2624
  v_mfma_f32_16x16x32_bf16 v[64:67], v[164:167], v[188:191], v[64:67]
  v_mfma_f32_16x16x32_bf16 v[60:63], v[128:131], v[192:195], v[60:63]
  ds_read_b128 v[188:191], v3 offset:2688
  v_mfma_f32_16x16x32_bf16 v[64:67], v[160:163], v[192:195], v[64:67]
  s_waitcnt lgkmcnt(4)
  v_mfma_f32_16x16x32_bf16 v[60:63], v[124:127], v[196:199], v[60:63]
  ds_read_b128 v[192:195], v3 offset:2752
  v_cvt_pk_bf16_f32 v244, v220, v221
  v_mfma_f32_16x16x32_bf16 v[64:67], v[156:159], v[196:199], v[64:67]
  v_cvt_pk_bf16_f32 v245, v222, v223
  v_cvt_pk_bf16_f32 v246, v224, v225
  s_waitcnt lgkmcnt(4)
  v_mfma_f32_16x16x32_bf16 v[60:63], v[120:123], v[200:203], v[60:63]
  ds_read_b128 v[196:199], v3 offset:2816
  v_cvt_pk_bf16_f32 v247, v226, v227
  v_mfma_f32_16x16x32_bf16 v[64:67], v[152:155], v[200:203], v[64:67]
  v_cvt_pk_bf16_f32 v248, v228, v229
  v_cvt_pk_bf16_f32 v249, v230, v231
  s_waitcnt lgkmcnt(4)
  v_mfma_f32_16x16x32_bf16 v[60:63], v[116:119], v[204:207], v[60:63]
  ds_read_b128 v[200:203], v3 offset:2880
  v_cvt_pk_bf16_f32 v250, v232, v233
  v_mfma_f32_16x16x32_bf16 v[64:67], v[148:151], v[204:207], v[64:67]
  v_cvt_pk_bf16_f32 v251, v234, v235
  v_cvt_pk_bf16_f32 v16, v236, v237
  v_mfma_f32_16x16x32_bf16 v[68:71], v[180:183], v[204:207], v[68:71]
  v_cvt_pk_bf16_f32 v17, v238, v239
  v_cvt_pk_bf16_f32 v18, v240, v241
  s_waitcnt lgkmcnt(4)
  v_mfma_f32_16x16x32_bf16 v[64:67], v[144:147], v[208:211], v[64:67]
  ds_read_b128 v[204:207], v3 offset:2944
  v_cvt_pk_bf16_f32 v19, v242, v243
  v_mfma_f32_16x16x32_bf16 v[68:71], v[176:179], v[208:211], v[68:71]
  s_cmp_eq_u32 s50, 0
  s_cbranch_scc1 L_nd_38
  s_add_u32 m0, s84, 4096
  s_add_u32 s85, s51, 4096
  buffer_load_dwordx4 v10, s[52:55], s85 offen offset:0 sc1 lds
  buffer_load_dwordx4 v10, s[52:55], s85 offen offset:1024 sc1 lds
  buffer_load_dwordx4 v10, s[52:55], s85 offen offset:2048 sc1 lds
  buffer_load_dwordx4 v10, s[52:55], s85 offen offset:3072 sc1 lds
L_nd_38:
  s_waitcnt lgkmcnt(4)
  v_mfma_f32_16x16x32_bf16 v[64:67], v[140:143], v[188:191], v[64:67]
  ds_read_b128 v[208:211], v3 offset:3008
  v_mfma_f32_16x16x32_bf16 v[68:71], v[172:175], v[188:191], v[68:71]
  v_mfma_f32_16x16x32_bf16 v[64:67], v[244:247], v[76:79], v[64:67]
  v_mfma_f32_16x16x32_bf16 v[68:71], v[244:247], v[80:83], v[68:71]
  v_mfma_f32_16x16x32_bf16 v[72:75], v[244:247], v[84:87], v[72:75]
  v_mfma_f32_16x16x32_bf16 v[64:67], v[248:251], v[88:91], v[64:67]
  v_mfma_f32_16x16x32_bf16 v[68:71], v[248:251], v[92:95], v[68:71]
  v_mfma_f32_16x16x32_bf16 v[72:75], v[248:251], v[96:99], v[72:75]
  v_mfma_f32_16x16x32_bf16 v[72:75], v[16:19], v[100:103], v[72:75]
  s_waitcnt lgkmcnt(4)
  v_mfma_f32_16x16x32_bf16 v[64:67], v[136:139], v[192:195], v[64:67]
  ds_read_b128 v[188:191], v3 offset:3072
  v_mfma_f32_16x16x32_bf16 v[68:71], v[168:171], v[192:195], v[68:71]
  ds_read_b128 v[212:215], v4 offset:2064
  ds_read_b128 v[216:219], v4 offset:2048
  s_waitcnt lgkmcnt(6)
  v_mfma_f32_16x16x32_bf16 v[64:67], v[132:135], v[196:199], v[64:67]
  ds_read_b128 v[192:195], v3 offset:3136
  v_mfma_f32_16x16x32_bf16 v[68:71], v[164:167], v[196:199], v[68:71]
  s_waitcnt lgkmcnt(6)
  v_mfma_f32_16x16x32_bf16 v[64:67], v[128:131], v[200:203], v[64:67]
  ds_read_b128 v[196:199], v3 offset:3200
  v_mfma_f32_16x16x32_bf16 v[68:71], v[160:163], v[200:203], v[68:71]
  s_waitcnt lgkmcnt(6)
  v_mfma_f32_16x16x32_bf16 v[64:67], v[124:127], v[204:207], v[64:67]
  ds_read_b128 v[200:203], v3 offset:3264
  v_mfma_f32_16x16x32_bf16 v[68:71], v[156:159], v[204:207], v[68:71]
  s_waitcnt lgkmcnt(4)
  v_mfma_f32_16x16x32_bf16 v[220:223], v[212:215], v[20:23], 0
  v_mfma_f32_16x16x32_bf16 v[224:227], v[212:215], v[24:27], 0
  v_mfma_f32_16x16x32_bf16 v[228:231], v[212:215], v[28:31], 0
  s_waitcnt lgkmcnt(3)
  v_mfma_f32_16x16x32_bf16 v[232:235], v[216:219], v[32:35], 0
  v_mfma_f32_16x16x32_bf16 v[64:67], v[120:123], v[208:211], v[64:67]
  ds_read_b128 v[204:207], v3 offset:3328
  v_mfma_f32_16x16x32_bf16 v[68:71], v[152:155], v[208:211], v[68:71]
  s_cmp_eq_u32 s50, 0
  s_cbranch_scc1 L_nd_39
  s_add_u32 m0, s84, 8192
  s_add_u32 s85, s51, 8192
  buffer_load_dwordx4 v10, s[52:55], s85 offen offset:0 sc1 lds
  buffer_load_dwordx4 v10, s[52:55], s85 offen offset:1024 sc1 lds
  buffer_load_dwordx4 v10, s[52:55], s85 offen offset:2048 sc1 lds
  buffer_load_dwordx4 v10, s[52:55], s85 offen offset:3072 sc1 lds
L_nd_39:
  v_mfma_f32_16x16x32_bf16 v[64:67], v[116:119], v[188:191], v[64:67]
  ds_read_b128 v[208:211], v3 offset:3392
  v_mfma_f32_16x16x32_bf16 v[68:71], v[148:151], v[188:191], v[68:71]
  v_mfma_f32_16x16x32_bf16 v[72:75], v[180:183], v[188:191], v[72:75]
  s_waitcnt lgkmcnt(4)
  v_mfma_f32_16x16x32_bf16 v[68:71], v[144:147], v[192:195], v[68:71]
  ds_read_b128 v[188:191], v3 offset:3456
  v_cvt_pk_bf16_f32 v244, v220, v221
  v_mfma_f32_16x16x32_bf16 v[72:75], v[176:179], v[192:195], v[72:75]
  v_cvt_pk_bf16_f32 v245, v222, v223
  v_cvt_pk_bf16_f32 v246, v224, v225
  s_waitcnt lgkmcnt(4)
  v_mfma_f32_16x16x32_bf16 v[68:71], v[140:143], v[196:199], v[68:71]
  ds_read_b128 v[192:195], v3 offset:3520
  v_cvt_pk_bf16_f32 v247, v226, v227
  v_mfma_f32_16x16x32_bf16 v[72:75], v[172:175], v[196:199], v[72:75]
  v_cvt_pk_bf16_f32 v248, v228, v229
  v_cvt_pk_bf16_f32 v249, v230, v231
  s_waitcnt lgkmcnt(4)
  v_mfma_f32_16x16x32_bf16 v[68:71], v[136:139], v[200:203], v[68:71]
  ds_read_b128 v[196:199], v3 offset:3584
  v_cvt_pk_bf16_f32 v250, v232, v233
  v_mfma_f32_16x16x32_bf16 v[72:75], v[168:171], v[200:203], v[72:75]
  v_cvt_pk_bf16_f32 v251, v234, v235
  s_waitcnt lgkmcnt(4)
  v_mfma_f32_16x16x32_bf16 v[68:71], v[132:135], v[204:207], v[68:71]
  ds_read_b128 v[200:203], v3 offset:3648
  v_mfma_f32_16x16x32_bf16 v[72:75], v[164:167], v[204:207], v[72:75]
  s_waitcnt lgkmcnt(4)
  v_mfma_f32_16x16x32_bf16 v[68:71], v[128:131], v[208:211], v[68:71]
  ds_read_b128 v[204:207], v3 offset:3712
  v_mfma_f32_16x16x32_bf16 v[72:75], v[160:163], v[208:211], v[72:75]
  s_cmp_eq_u32 s50, 0
  s_cbranch_scc1 L_nd_40
  s_add_u32 m0, s84, 12288
  s_add_u32 s85, s51, 12288
  buffer_load_dwordx4 v10, s[52:55], s85 offen offset:0 sc1 lds
  buffer_load_dwordx4 v10, s[52:55], s85 offen offset:1024 sc1 lds
  buffer_load_dwordx4 v10, s[52:55], s85 offen offset:2048 sc1 lds
L_nd_40:
  v_mfma_f32_16x16x32_bf16 v[68:71], v[244:247], v[76:79], v[68:71]
  v_mfma_f32_16x16x32_bf16 v[72:75], v[244:247], v[80:83], v[72:75]
  v_mfma_f32_16x16x32_bf16 v[68:71], v[248:251], v[88:91], v[68:71]
  v_mfma_f32_16x16x32_bf16 v[72:75], v[248:251], v[92:95], v[72:75]
  s_waitcnt lgkmcnt(4)
  v_mfma_f32_16x16x32_bf16 v[68:71], v[124:127], v[188:191], v[68:71]
  ds_read_b128 v[208:211], v3 offset:3776
  s_and_b32 s67, s64, 3
  v_mfma_f32_16x16x32_bf16 v[72:75], v[156:159], v[188:191], v[72:75]
  s_mul_i32 s68, s83, 27200
  s_add_u32 s68, s68, 117696
  ds_read_b128 v[212:215], v4 offset:2576
  ds_read_b128 v[216:219], v4 offset:2560
  s_waitcnt lgkmcnt(6)
  v_mfma_f32_16x16x32_bf16 v[68:71], v[120:123], v[192:195], v[68:71]
  ds_read_b128 v[188:191], v3 offset:3840
  s_mul_i32 s69, s67, 4608
  v_mfma_f32_16x16x32_bf16 v[72:75], v[152:155], v[192:195], v[72:75]
  s_add_u32 s69, s69, s68
  v_lshrrev_b32 v1, 4, v0
  s_waitcnt lgkmcnt(6)
  v_mfma_f32_16x16x32_bf16 v[68:71], v[116:119], v[196:199], v[68:71]
  ds_read_b128 v[192:195], v3 offset:3904
  v_lshlrev_b32 v1, 6, v1
  v_mfma_f32_16x16x32_bf16 v[72:75], v[148:151], v[196:199], v[72:75]
  v_xor_b32 v1, v1, v10
  v_add_u32 v1, s69, v1
  s_waitcnt lgkmcnt(6)
  v_mfma_f32_16x16x32_bf16 v[72:75], v[144:147], v[200:203], v[72:75]
  ds_read_b128 v[196:199], v3 offset:3968
  v_mov_b32 v164, 1
  s_cmp_eq_u32 s83, 0
  s_cbranch_scc0 L_na_41
  buffer_load_dword v15, v13, s[56:59], 0 offen offset:128 sc1
L_na_41:
  s_waitcnt lgkmcnt(4)
  v_mfma_f32_16x16x32_bf16 v[220:223], v[212:215], v[20:23], 0
  v_mfma_f32_16x16x32_bf16 v[224:227], v[212:215], v[24:27], 0
  v_mfma_f32_16x16x32_bf16 v[228:231], v[212:215], v[28:31], 0
  s_waitcnt lgkmcnt(3)
  v_mfma_f32_16x16x32_bf16 v[232:235], v[216:219], v[32:35], 0
  v_mfma_f32_16x16x32_bf16 v[72:75], v[140:143], v[204:207], v[72:75]
  ds_read_b128 v[200:203], v3 offset:4032
  s_lshl_b32 s70, s83, 2
  v_mfma_f32_16x16x32_bf16 v[72:75], v[136:139], v[208:211], v[72:75]
  ds_read_b128 v[204:207], v3 offset:4096
  v_add_u32 v160, s70, v12
  s_waitcnt lgkmcnt(4)
  v_mfma_f32_16x16x32_bf16 v[72:75], v[132:135], v[188:191], v[72:75]
  ds_read_b128 v[208:211], v3 offset:16
  v_cvt_pk_bf16_f32 v244, v220, v221
  s_waitcnt lgkmcnt(4)
  v_mfma_f32_16x16x32_bf16 v[72:75], v[128:131], v[192:195], v[72:75]
  ds_read_b128 v[188:191], v3 offset:528
  v_cvt_pk_bf16_f32 v245, v222, v223
  s_waitcnt lgkmcnt(4)
  v_mfma_f32_16x16x32_bf16 v[72:75], v[124:127], v[196:199], v[72:75]
  ds_read_b128 v[192:195], v3 offset:1040
  v_cvt_pk_bf16_f32 v246, v224, v225
  s_waitcnt lgkmcnt(4)
  v_mfma_f32_16x16x32_bf16 v[72:75], v[120:123], v[200:203], v[72:75]
  ds_read_b128 v[196:199], v3 offset:1552
  v_cvt_pk_bf16_f32 v247, v226, v227
  s_waitcnt lgkmcnt(4)
  v_mfma_f32_16x16x32_bf16 v[72:75], v[116:119], v[204:207], v[72:75]
  ds_read_b128 v[200:203], v3 offset:2064
  v_cvt_pk_bf16_f32 v248, v228, v229
  v_cvt_pk_bf16_f32 v249, v230, v231
  v_cvt_pk_bf16_f32 v250, v232, v233
  v_cvt_pk_bf16_f32 v251, v234, v235
  v_mfma_f32_16x16x32_bf16 v[72:75], v[244:247], v[76:79], v[72:75]
  s_nop 0
  v_mfma_f32_16x16x32_bf16 v[72:75], v[248:251], v[88:91], v[72:75]
  s_waitcnt lgkmcnt(4)
  v_mfma_f32_16x16x32_bf16 v[56:59], v[184:187], v[208:211], v[56:59]
  v_and_b32 v163, 1, v0
  v_mul_u32_u24 v163, 9216, v163
  s_waitcnt lgkmcnt(3)
  v_mfma_f32_16x16x32_bf16 v[60:63], v[184:187], v[188:191], v[60:63]
  v_bfe_u32 v161, v0, 1, 2
  v_lshl_add_u32 v163, v161, 8, v163
  s_waitcnt lgkmcnt(2)
  v_mfma_f32_16x16x32_bf16 v[64:67], v[184:187], v[192:195], v[64:67]
  v_lshlrev_b32 v161, 2, v161
  v_lshrrev_b32 v162, 3, v0
  s_waitcnt lgkmcnt(1)
  v_mfma_f32_16x16x32_bf16 v[68:71], v[184:187], v[196:199], v[68:71]
  v_xor_b32 v161, v161, v162
  v_xor_b32 v162, 8, v161
  s_waitcnt lgkmcnt(0)
  v_mfma_f32_16x16x32_bf16 v[72:75], v[184:187], v[200:203], v[72:75]
  s_lshl_b32 s69, s67, 10
  s_add_u32 s69, s69, s68
  v_add_u32 v163, s69, v163
  v_lshl_add_u32 v161, v161, 4, v163
  v_lshl_add_u32 v162, v162, 4, v163
  s_lshl_b32 s48, s66, 12
  s_add_u32 s48, s48, 2490368
  v_cvt_pk_bf16_f32 v188, v44, v45
  v_cvt_pk_bf16_f32 v189, v46, v47
  v_cvt_pk_bf16_f32 v190, v48, v49
  v_cvt_pk_bf16_f32 v191, v50, v51
  ds_write_b128 v1, v[188:191] offset:0
  v_cvt_pk_bf16_f32 v192, v52, v53
  v_cvt_pk_bf16_f32 v193, v54, v55
  v_cvt_pk_bf16_f32 v194, v56, v57
  v_cvt_pk_bf16_f32 v195, v58, v59
  ds_write_b128 v1, v[192:195] offset:1024
  v_cvt_pk_bf16_f32 v196, v60, v61
  v_cvt_pk_bf16_f32 v197, v62, v63
  v_cvt_pk_bf16_f32 v198, v64, v65
  v_cvt_pk_bf16_f32 v199, v66, v67
  ds_write_b128 v1, v[196:199] offset:2048
  v_cvt_pk_bf16_f32 v200, v68, v69
  v_cvt_pk_bf16_f32 v201, v70, v71
  v_cvt_pk_bf16_f32 v202, v72, v73
  v_cvt_pk_bf16_f32 v203, v74, v75
  ds_write_b128 v1, v[200:203] offset:3072
  s_mov_b64 exec, 1
  ds_add_u32 v160, v164 offset:16
  s_mov_b64 exec, -1
  s_mov_b32 s68, 0
  s_setprio 0
  s_cmp_eq_u32 s50, 1
  s_cbranch_scc1 L_dk_42
  s_mov_b32 s68, 0
  s_nop 0
L_zp_43:
  v_readfirstlane_b32 s69, v14
  s_cmp_ge_u32 s69, 8
  s_cbranch_scc1 L_ze_44
  s_add_u32 s68, s68, 1
  s_cmp_gt_u32 s68, 8192
  s_cbranch_scc1 L_ze_44

  buffer_load_dword v14, v13, s[56:59], 0 offen offset:0 sc0 sc1
  s_waitcnt vmcnt(0)
  s_branch L_zp_43
L_ze_44:
  s_cmp_eq_u32 s83, 0
  s_cbranch_scc0 L_na_45
  s_waitcnt vmcnt(0)
  s_add_u32 m0, s84, 0
  s_add_u32 s85, s51, 0
  buffer_load_dwordx4 v10, s[52:55], s85 offen offset:0 sc1 lds
  buffer_load_dwordx4 v10, s[52:55], s85 offen offset:1024 sc1 lds
  buffer_load_dwordx4 v10, s[52:55], s85 offen offset:2048 sc1 lds
  buffer_load_dwordx4 v10, s[52:55], s85 offen offset:3072 sc1 lds
  s_add_u32 m0, s84, 4096
  s_add_u32 s85, s51, 4096
  buffer_load_dwordx4 v10, s[52:55], s85 offen offset:0 sc1 lds
  buffer_load_dwordx4 v10, s[52:55], s85 offen offset:1024 sc1 lds
  buffer_load_dwordx4 v10, s[52:55], s85 offen offset:2048 sc1 lds
  buffer_load_dwordx4 v10, s[52:55], s85 offen offset:3072 sc1 lds
  s_add_u32 m0, s84, 8192
  s_add_u32 s85, s51, 8192
  buffer_load_dwordx4 v10, s[52:55], s85 offen offset:0 sc1 lds
  buffer_load_dwordx4 v10, s[52:55], s85 offen offset:1024 sc1 lds
  buffer_load_dwordx4 v10, s[52:55], s85 offen offset:2048 sc1 lds
  buffer_load_dwordx4 v10, s[52:55], s85 offen offset:3072 sc1 lds
  s_add_u32 m0, s84, 12288
  s_add_u32 s85, s51, 12288
  buffer_load_dwordx4 v10, s[52:55], s85 offen offset:0 sc1 lds
  buffer_load_dwordx4 v10, s[52:55], s85 offen offset:1024 sc1 lds
  buffer_load_dwordx4 v10, s[52:55], s85 offen offset:2048 sc1 lds
L_na_45:
L_dk_42:
  s_cmp_eq_u32 s83, 0
  s_cbranch_scc0 L_na_46
  s_add_u32 m0, s84, 12288
  s_add_u32 s85, s51, 12288
  buffer_load_dwordx4 v10, s[52:55], s85 offen offset:3072 sc1 lds
  s_add_u32 m0, s84, 16384
  s_add_u32 s85, s51, 16384
  buffer_load_dwordx4 v10, s[52:55], s85 offen offset:0 sc1 lds
  buffer_load_dwordx4 v10, s[52:55], s85 offen offset:1024 sc1 lds
  buffer_load_dwordx4 v10, s[52:55], s85 offen offset:2048 sc1 lds
  buffer_load_dwordx4 v10, s[52:55], s85 offen offset:3072 sc1 lds
  s_add_u32 m0, s84, 20480
  s_add_u32 s85, s51, 20480
  s_mov_b64 exec, 0xffff
  buffer_load_dwordx4 v10, s[52:55], s85 offen offset:0 sc1 lds
  s_mov_b64 exec, -1
L_na_46:
  s_mov_b32 s68, 0
L_tw_47:
  ds_read_b32 v2, v160 offset:16
  s_add_u32 s68, s68, 1
  s_cmp_gt_u32 s68, 8192
  s_cbranch_scc1 L_te_48
  s_waitcnt lgkmcnt(0)
  v_readfirstlane_b32 s69, v2
  s_cmp_ge_u32 s69, 4
  s_cbranch_scc1 L_te_48
  s_sleep 1
  s_branch L_tw_47
L_te_48:
  ds_read_b64 v[44:45], v161 offset:0
  ds_read_b64 v[46:47], v161 offset:4608
  ds_read_b64 v[48:49], v162 offset:0
  ds_read_b64 v[50:51], v162 offset:4608
  ds_read_b64 v[52:53], v161 offset:8
  ds_read_b64 v[54:55], v161 offset:4616
  ds_read_b64 v[56:57], v162 offset:8
  ds_read_b64 v[58:59], v162 offset:4616
  s_waitcnt lgkmcnt(6)
  buffer_store_dwordx4 v[44:47], v10, s[52:55], s48 offen offset:0 sc0 sc1
  s_waitcnt lgkmcnt(4)
  buffer_store_dwordx4 v[48:51], v10, s[52:55], s48 offen offset:1024 sc0 sc1
  s_waitcnt lgkmcnt(2)
  buffer_store_dwordx4 v[52:55], v10, s[52:55], s48 offen offset:2048 sc0 sc1
  s_waitcnt lgkmcnt(0)
  buffer_store_dwordx4 v[56:59], v10, s[52:55], s48 offen offset:3072 sc0 sc1
  s_cmp_eq_u32 s83, 0
  s_cbranch_scc0 L_na_49
  s_mov_b32 s68, 0
  s_waitcnt vmcnt(10)
L_zp_50:
  v_readfirstlane_b32 s69, v15
  s_cmp_ge_u32 s69, 8
  s_cbranch_scc1 L_ze_51
  s_add_u32 s68, s68, 1
  s_cmp_gt_u32 s68, 8192
  s_cbranch_scc1 L_ze_51

  buffer_load_dword v15, v13, s[56:59], 0 offen offset:128 sc0 sc1
  s_waitcnt vmcnt(0)
  s_branch L_zp_50
L_ze_51:
L_na_49:
  s_nop 4
  s_branch L_p2
.p2align 3
L1_kv_c:
  s_waitcnt lgkmcnt(0)
  s_mov_b32 s52, s42
  s_and_b32 s53, s43, 0xffff
  s_mov_b32 s54, 9764864
  s_mov_b32 s55, 0x20000
  s_mov_b32 s56, s40
  s_and_b32 s57, s41, 0xffff
  s_mov_b32 s58, 256
  s_mov_b32 s59, 0x20000
  s_mov_b32 s75, s96
  s_mov_b32 s71, s97
  s_mov_b32 s74, 0x358637bd
  v_mov_b32 v144, v0
  s_lshr_b32 s67, s64, 1
  s_and_b32 s68, s64, 1
  v_and_b32 v145, 15, v144
  v_lshrrev_b32 v146, 4, v144
  v_bfe_u32 v147, v144, 2, 2
  v_and_b32 v148, 3, v144
  s_lshl_b32 s69, s67, 13
  v_lshrrev_b32 v138, 1, v145
  v_xor_b32 v138, v138, v146
  v_lshlrev_b32 v138, 4, v138
  v_lshl_add_u32 v138, v145, 7, v138
  v_add_u32 v138, s69, v138
  v_mov_b32 v149, 0
  v_mov_b32 v150, 0
  v_xor_b32 v139, 64, v138
  s_mul_i32 s69, s68, 72
  s_add_u32 s69, s69, 16384
  v_lshl_add_u32 v145, v146, 3, v147
  v_and_b32 v141, 1, v146
  v_lshlrev_b32 v141, 2, v141
  v_xor_b32 v140, v145, v141
  v_xor_b32 v141, 4, v140
  v_mul_u32_u24 v140, 288, v140
  v_mul_u32_u24 v141, 288, v141
  v_add_u32 v140, s69, v140
  v_add_u32 v141, s69, v141
  v_mul_u32_u24 v147, 144, v148
  v_add_u32 v147, 32, v147
  v_add_u32 v142, v140, v147
  v_add_u32 v143, v141, v147
  v_lshl_add_u32 v140, v148, 3, v140
  v_lshl_add_u32 v141, v148, 3, v141
  v_cmp_lt_u32 s[84:85], 1, v148
  v_lshlrev_b32 v145, 3, v145
  v_add_u32 v147, 32, v145
  v_cndmask_b32 v142, v142, v145, s[84:85]
  v_cndmask_b32 v143, v143, v147, s[84:85]
  s_mov_b32 s97, 1
  s_mov_b32 s96, 41024
  s_mov_b32 s101, 0
  s_mov_b32 s91, 0
  s_mov_b32 s98, 4
  s_mul_i32 s100, s66, 4096
  s_mov_b32 s99, 1
  s_add_u32 s100, s100, 4849664
  v_and_b32 v145, 15, v144
  v_lshrrev_b32 v146, 4, v144
  v_cmp_gt_u32 vcc, 4, v145
  s_mul_i32 s69, s67, 6144
  s_add_u32 s69, s69, 151552
  s_lshl_b32 s70, s68, 11
  s_add_u32 s70, s70, s69
  v_lshl_add_u32 v245, v144, 4, s70
  s_lshl_b32 s70, s68, 8
  s_add_u32 s70, s70, s69
  v_lshl_add_u32 v247, v144, 4, s70
  v_and_b32 v147, 1, v145
  v_add_u32 v248, 8, v147
  v_bfe_u32 v148, v145, 1, 1
  v_lshl_add_u32 v147, v147, 2, v148
  v_cndmask_b32 v147, v147, v248, vcc
  v_lshl_add_u32 v147, s68, 1, v147
  v_lshl_add_u32 v248, v147, 3, s69
  v_mul_u32_u24 v246, 192, v146
  v_lshl_add_u32 v246, v147, 4, v246
  v_add_u32 v246, s69, v246
  v_mov_b32 v252, 40960
  s_lshl_b32 s69, s64, 8
  v_lshl_add_u32 v249, v144, 2, s69
  v_add_u32 v250, 151552, v249
  s_lshl_b32 s69, s66, 13
  s_lshl_b32 s70, s65, 9
  s_add_u32 s69, s69, s70
  s_lshl_b32 s70, s67, 8
  s_add_u32 s69, s69, s70
  s_add_u32 s69, s69, 2424832
  v_lshl_add_u32 v251, v146, 4, s69
  s_mul_i32 s78, s66, 6144
  s_add_u32 s78, s78, 2359296
  s_add_u32 s79, s78, 4096
  v_mov_b32 v0, 1.0
  v_mov_b32 v1, 1.0
  v_mov_b32 v2, 1.0
  v_mov_b32 v3, 1.0
  v_mov_b32 v4, 1.0
  v_mov_b32 v5, 1.0
  v_mov_b32 v6, 1.0
  v_mov_b32 v7, 1.0
  v_mov_b32 v8, 0
  v_mov_b32 v9, 0
  v_mov_b32 v10, 0
  v_mov_b32 v11, 0
  v_mov_b32 v12, 0
  v_mov_b32 v13, 0
  v_mov_b32 v14, 0
  v_mov_b32 v15, 0
  v_cndmask_b32 v16, 0, 1.0, vcc
  v_cndmask_b32 v17, 0, 1.0, vcc
  v_cndmask_b32 v18, 0, 1.0, vcc
  v_cndmask_b32 v19, 0, 1.0, vcc
  v_mov_b32 v20, 1.0
  v_mov_b32 v21, 1.0
  v_mov_b32 v22, 1.0
  v_mov_b32 v23, 1.0
  v_mov_b32 v24, 1.0
  v_mov_b32 v25, 1.0
  v_mov_b32 v26, 1.0
  v_mov_b32 v27, 1.0
  v_mov_b32 v28, 0
  v_mov_b32 v29, 0
  v_mov_b32 v30, 0
  v_mov_b32 v31, 0
  v_mov_b32 v32, 0
  v_mov_b32 v33, 0
  v_mov_b32 v34, 0
  v_mov_b32 v35, 0
  v_cndmask_b32 v36, 0, 1.0, vcc
  v_cndmask_b32 v37, 0, 1.0, vcc
  v_cndmask_b32 v38, 0, 1.0, vcc
  v_cndmask_b32 v39, 0, 1.0, vcc
  v_mov_b32 v40, 1.0
  v_mov_b32 v41, 1.0
  v_mov_b32 v42, 1.0
  v_mov_b32 v43, 1.0
  v_mov_b32 v44, 1.0
  v_mov_b32 v45, 1.0
  v_mov_b32 v46, 1.0
  v_mov_b32 v47, 1.0
  v_mov_b32 v48, 0
  v_mov_b32 v49, 0
  v_mov_b32 v50, 0
  v_mov_b32 v51, 0
  v_mov_b32 v52, 0
  v_mov_b32 v53, 0
  v_mov_b32 v54, 0
  v_mov_b32 v55, 0
  v_cndmask_b32 v56, 0, 1.0, vcc
  v_cndmask_b32 v57, 0, 1.0, vcc
  v_cndmask_b32 v58, 0, 1.0, vcc
  v_cndmask_b32 v59, 0, 1.0, vcc
  v_mov_b32 v60, 1.0
  v_mov_b32 v61, 1.0
  v_mov_b32 v62, 1.0
  v_mov_b32 v63, 1.0
  v_mov_b32 v64, 1.0
  v_mov_b32 v65, 1.0
  v_mov_b32 v66, 1.0
  v_mov_b32 v67, 1.0
  v_mov_b32 v68, 0
  v_mov_b32 v69, 0
  v_mov_b32 v70, 0
  v_mov_b32 v71, 0
  v_mov_b32 v72, 0
  v_mov_b32 v73, 0
  v_mov_b32 v74, 0
  v_mov_b32 v75, 0
  v_cndmask_b32 v76, 0, 1.0, vcc
  v_cndmask_b32 v77, 0, 1.0, vcc
  v_cndmask_b32 v78, 0, 1.0, vcc
  v_cndmask_b32 v79, 0, 1.0, vcc
  s_mov_b32 s76, 0
  s_mov_b32 s77, 0
L_wr_kv:
  s_lshl_b32 s82, s75, 8
  s_add_u32 s82, s82, 139264
  v_mov_b32 v145, s76
  v_mov_b32 v146, s82
  v_cndmask_b32 v145, v145, v146, s[84:85]
  s_and_b32 s75, s71, 15
  s_lshr_b32 s71, s71, 4
  s_barrier
  v_add_u32 v132, s76, v138
  v_add_u32 v133, s76, v139
  ds_read_b128 v[80:83], v132 offset:0
  ds_read_b128 v[84:87], v132 offset:2048
  ds_read_b128 v[88:91], v132 offset:4096
  ds_read_b128 v[92:95], v132 offset:6144
  v_add_u32 v134, s76, v140
  v_add_u32 v135, s76, v141
  ds_read_b64_tr_b16 v[112:113], v134 offset:0
  ds_read_b64_tr_b16 v[114:115], v135 offset:0
  v_add_u32 v136, v145, v142
  v_add_u32 v137, v145, v143
  ds_read_b64_tr_b16 v[116:117], v134 offset:40
  ds_read_b64_tr_b16 v[118:119], v135 offset:40
  s_add_u32 s76, s76, 34816
  s_cmp_eq_u32 s76, 139264
  s_cselect_b32 s76, 0, s76
  ds_read_b64_tr_b16 v[120:121], v134 offset:144
  ds_read_b64_tr_b16 v[122:123], v135 offset:144
.p2align 3
L_gl_52:
  s_waitcnt lgkmcnt(4)
  v_mfma_f32_16x16x32_bf16 v[0:3], v[80:83], v[112:115], v[0:3]
  ds_read_b64_tr_b16 v[124:125], v134 offset:184
  ds_read_b64_tr_b16 v[126:127], v135 offset:184
  v_mfma_f32_16x16x32_bf16 v[20:23], v[84:87], v[112:115], v[20:23]
  ds_read_b128 v[96:99], v133 offset:0
  ds_read_b128 v[100:103], v133 offset:2048
  v_mfma_f32_16x16x32_bf16 v[40:43], v[88:91], v[112:115], v[40:43]
  ds_read_b128 v[104:107], v133 offset:4096
  ds_read_b128 v[108:111], v133 offset:6144
  v_mfma_f32_16x16x32_bf16 v[60:63], v[92:95], v[112:115], v[60:63]
  s_waitcnt lgkmcnt(8)
  v_mfma_f32_16x16x32_bf16 v[4:7], v[80:83], v[116:119], v[4:7]
  ds_read_b64_tr_b16 v[128:129], v136 offset:0
  ds_read_b64_tr_b16 v[130:131], v137 offset:0
  s_lshl_b32 s82, s75, 8
  v_mfma_f32_16x16x32_bf16 v[24:27], v[84:87], v[116:119], v[24:27]
  s_add_u32 s82, s82, 139264
  v_mov_b32 v145, s76
  v_mov_b32 v146, s82
  v_mfma_f32_16x16x32_bf16 v[44:47], v[88:91], v[116:119], v[44:47]
  v_cndmask_b32 v145, v145, v146, s[84:85]
  s_and_b32 s75, s71, 15
  s_lshr_b32 s71, s71, 4
  v_mfma_f32_16x16x32_bf16 v[64:67], v[92:95], v[116:119], v[64:67]
  s_waitcnt lgkmcnt(8)
  v_mfma_f32_16x16x32_bf16 v[8:11], v[80:83], v[120:123], v[8:11]
  ds_read_b64_tr_b16 v[112:113], v134 offset:9216
  v_mfma_f32_16x16x32_bf16 v[28:31], v[84:87], v[120:123], v[28:31]
  ds_read_b64_tr_b16 v[114:115], v135 offset:9216
  v_mfma_f32_16x16x32_bf16 v[48:51], v[88:91], v[120:123], v[48:51]
  v_mfma_f32_16x16x32_bf16 v[68:71], v[92:95], v[120:123], v[68:71]
  s_waitcnt lgkmcnt(8)
  v_mfma_f32_16x16x32_bf16 v[12:15], v[80:83], v[124:127], v[12:15]
  ds_read_b64_tr_b16 v[116:117], v134 offset:9256
  v_mfma_f32_16x16x32_bf16 v[32:35], v[84:87], v[124:127], v[32:35]
  ds_read_b64_tr_b16 v[118:119], v135 offset:9256
  v_mfma_f32_16x16x32_bf16 v[52:55], v[88:91], v[124:127], v[52:55]
  v_mfma_f32_16x16x32_bf16 v[72:75], v[92:95], v[124:127], v[72:75]
  s_waitcnt lgkmcnt(4)
  v_mfma_f32_16x16x32_bf16 v[16:19], v[80:83], v[128:131], v[16:19]
  ds_read_b64_tr_b16 v[120:121], v134 offset:9360
  v_mfma_f32_16x16x32_bf16 v[36:39], v[84:87], v[128:131], v[36:39]
  ds_read_b64_tr_b16 v[122:123], v135 offset:9360
  v_mfma_f32_16x16x32_bf16 v[56:59], v[88:91], v[128:131], v[56:59]
  v_mfma_f32_16x16x32_bf16 v[76:79], v[92:95], v[128:131], v[76:79]
  s_waitcnt lgkmcnt(4)
  v_mfma_f32_16x16x32_bf16 v[0:3], v[96:99], v[112:115], v[0:3]
  ds_read_b64_tr_b16 v[124:125], v134 offset:9400
  v_mfma_f32_16x16x32_bf16 v[20:23], v[100:103], v[112:115], v[20:23]
  ds_read_b64_tr_b16 v[126:127], v135 offset:9400
  v_mfma_f32_16x16x32_bf16 v[40:43], v[104:107], v[112:115], v[40:43]
  v_mfma_f32_16x16x32_bf16 v[60:63], v[108:111], v[112:115], v[60:63]
  s_waitcnt lgkmcnt(4)
  v_mfma_f32_16x16x32_bf16 v[4:7], v[96:99], v[116:119], v[4:7]
  s_barrier
  v_add_u32 v132, s76, v138
  v_add_u32 v133, s76, v139
  v_mfma_f32_16x16x32_bf16 v[24:27], v[100:103], v[116:119], v[24:27]
  ds_read_b128 v[80:83], v132 offset:0
  ds_read_b128 v[84:87], v132 offset:2048
  ds_read_b128 v[88:91], v132 offset:4096
  v_mfma_f32_16x16x32_bf16 v[44:47], v[104:107], v[116:119], v[44:47]
  ds_read_b128 v[92:95], v132 offset:6144
  ds_read_b64_tr_b16 v[128:129], v136 offset:9216
  ds_read_b64_tr_b16 v[130:131], v137 offset:9216
  v_mfma_f32_16x16x32_bf16 v[64:67], v[108:111], v[116:119], v[64:67]
  s_waitcnt lgkmcnt(8)
  v_mfma_f32_16x16x32_bf16 v[8:11], v[96:99], v[120:123], v[8:11]
  v_add_u32 v134, s76, v140
  v_add_u32 v135, s76, v141
  v_mfma_f32_16x16x32_bf16 v[28:31], v[100:103], v[120:123], v[28:31]
  ds_read_b64_tr_b16 v[112:113], v134 offset:0
  ds_read_b64_tr_b16 v[114:115], v135 offset:0
  v_mfma_f32_16x16x32_bf16 v[48:51], v[104:107], v[120:123], v[48:51]
  v_add_u32 v136, v145, v142
  v_add_u32 v137, v145, v143
  v_mfma_f32_16x16x32_bf16 v[68:71], v[108:111], v[120:123], v[68:71]
  s_waitcnt lgkmcnt(8)
  v_mfma_f32_16x16x32_bf16 v[12:15], v[96:99], v[124:127], v[12:15]
  ds_read_b64_tr_b16 v[116:117], v134 offset:40
  ds_read_b64_tr_b16 v[118:119], v135 offset:40
  v_mfma_f32_16x16x32_bf16 v[32:35], v[100:103], v[124:127], v[32:35]
  s_add_u32 s76, s76, 34816
  s_cmp_eq_u32 s76, 139264
  v_mfma_f32_16x16x32_bf16 v[52:55], v[104:107], v[124:127], v[52:55]
  s_cselect_b32 s76, 0, s76
  v_mfma_f32_16x16x32_bf16 v[72:75], v[108:111], v[124:127], v[72:75]
  s_waitcnt lgkmcnt(4)
  v_mfma_f32_16x16x32_bf16 v[16:19], v[96:99], v[128:131], v[16:19]
  ds_read_b64_tr_b16 v[120:121], v134 offset:144
  v_mfma_f32_16x16x32_bf16 v[36:39], v[100:103], v[128:131], v[36:39]
  ds_read_b64_tr_b16 v[122:123], v135 offset:144
  v_mfma_f32_16x16x32_bf16 v[56:59], v[104:107], v[128:131], v[56:59]
  v_mfma_f32_16x16x32_bf16 v[76:79], v[108:111], v[128:131], v[76:79]
  s_waitcnt lgkmcnt(4)
  v_mfma_f32_16x16x32_bf16 v[0:3], v[80:83], v[112:115], v[0:3]
  ds_read_b64_tr_b16 v[124:125], v134 offset:184
  ds_read_b64_tr_b16 v[126:127], v135 offset:184
  v_mfma_f32_16x16x32_bf16 v[20:23], v[84:87], v[112:115], v[20:23]
  ds_read_b128 v[96:99], v133 offset:0
  ds_read_b128 v[100:103], v133 offset:2048
  v_mfma_f32_16x16x32_bf16 v[40:43], v[88:91], v[112:115], v[40:43]
  ds_read_b128 v[104:107], v133 offset:4096
  ds_read_b128 v[108:111], v133 offset:6144
  v_mfma_f32_16x16x32_bf16 v[60:63], v[92:95], v[112:115], v[60:63]
  s_waitcnt lgkmcnt(8)
  v_mfma_f32_16x16x32_bf16 v[4:7], v[80:83], v[116:119], v[4:7]
  ds_read_b64_tr_b16 v[128:129], v136 offset:0
  ds_read_b64_tr_b16 v[130:131], v137 offset:0
  s_lshl_b32 s82, s75, 8
  v_mfma_f32_16x16x32_bf16 v[24:27], v[84:87], v[116:119], v[24:27]
  s_add_u32 s82, s82, 139264
  v_mov_b32 v145, s76
  v_mov_b32 v146, s82
  v_mfma_f32_16x16x32_bf16 v[44:47], v[88:91], v[116:119], v[44:47]
  v_cndmask_b32 v145, v145, v146, s[84:85]
  s_and_b32 s75, s71, 15
  s_lshr_b32 s71, s71, 4
  v_mfma_f32_16x16x32_bf16 v[64:67], v[92:95], v[116:119], v[64:67]
  s_waitcnt lgkmcnt(8)
  v_mfma_f32_16x16x32_bf16 v[8:11], v[80:83], v[120:123], v[8:11]
  ds_read_b64_tr_b16 v[112:113], v134 offset:9216
  v_mfma_f32_16x16x32_bf16 v[28:31], v[84:87], v[120:123], v[28:31]
  ds_read_b64_tr_b16 v[114:115], v135 offset:9216
  v_mfma_f32_16x16x32_bf16 v[48:51], v[88:91], v[120:123], v[48:51]
  v_mfma_f32_16x16x32_bf16 v[68:71], v[92:95], v[120:123], v[68:71]
  s_waitcnt lgkmcnt(8)
  v_mfma_f32_16x16x32_bf16 v[12:15], v[80:83], v[124:127], v[12:15]
  ds_read_b64_tr_b16 v[116:117], v134 offset:9256
  v_mfma_f32_16x16x32_bf16 v[32:35], v[84:87], v[124:127], v[32:35]
  ds_read_b64_tr_b16 v[118:119], v135 offset:9256
  v_mfma_f32_16x16x32_bf16 v[52:55], v[88:91], v[124:127], v[52:55]
  v_mfma_f32_16x16x32_bf16 v[72:75], v[92:95], v[124:127], v[72:75]
  s_waitcnt lgkmcnt(4)
  v_mfma_f32_16x16x32_bf16 v[16:19], v[80:83], v[128:131], v[16:19]
  ds_read_b64_tr_b16 v[120:121], v134 offset:9360
  v_mfma_f32_16x16x32_bf16 v[36:39], v[84:87], v[128:131], v[36:39]
  ds_read_b64_tr_b16 v[122:123], v135 offset:9360
  v_mfma_f32_16x16x32_bf16 v[56:59], v[88:91], v[128:131], v[56:59]
  v_mfma_f32_16x16x32_bf16 v[76:79], v[92:95], v[128:131], v[76:79]
  s_waitcnt lgkmcnt(4)
  v_mfma_f32_16x16x32_bf16 v[0:3], v[96:99], v[112:115], v[0:3]
  ds_read_b64_tr_b16 v[124:125], v134 offset:9400
  v_mfma_f32_16x16x32_bf16 v[20:23], v[100:103], v[112:115], v[20:23]
  ds_read_b64_tr_b16 v[126:127], v135 offset:9400
  v_mfma_f32_16x16x32_bf16 v[40:43], v[104:107], v[112:115], v[40:43]
  v_mfma_f32_16x16x32_bf16 v[60:63], v[108:111], v[112:115], v[60:63]
  s_waitcnt lgkmcnt(4)
  v_mfma_f32_16x16x32_bf16 v[4:7], v[96:99], v[116:119], v[4:7]
  s_barrier
  v_add_u32 v132, s76, v138
  v_add_u32 v133, s76, v139
  v_mfma_f32_16x16x32_bf16 v[24:27], v[100:103], v[116:119], v[24:27]
  ds_read_b128 v[80:83], v132 offset:0
  ds_read_b128 v[84:87], v132 offset:2048
  ds_read_b128 v[88:91], v132 offset:4096
  v_mfma_f32_16x16x32_bf16 v[44:47], v[104:107], v[116:119], v[44:47]
  ds_read_b128 v[92:95], v132 offset:6144
  ds_read_b64_tr_b16 v[128:129], v136 offset:9216
  ds_read_b64_tr_b16 v[130:131], v137 offset:9216
  v_mfma_f32_16x16x32_bf16 v[64:67], v[108:111], v[116:119], v[64:67]
  s_waitcnt lgkmcnt(8)
  v_mfma_f32_16x16x32_bf16 v[8:11], v[96:99], v[120:123], v[8:11]
  v_add_u32 v134, s76, v140
  v_add_u32 v135, s76, v141
  v_mfma_f32_16x16x32_bf16 v[28:31], v[100:103], v[120:123], v[28:31]
  ds_read_b64_tr_b16 v[112:113], v134 offset:0
  ds_read_b64_tr_b16 v[114:115], v135 offset:0
  v_mfma_f32_16x16x32_bf16 v[48:51], v[104:107], v[120:123], v[48:51]
  v_add_u32 v136, v145, v142
  v_add_u32 v137, v145, v143
  v_mfma_f32_16x16x32_bf16 v[68:71], v[108:111], v[120:123], v[68:71]
  s_waitcnt lgkmcnt(8)
  v_mfma_f32_16x16x32_bf16 v[12:15], v[96:99], v[124:127], v[12:15]
  ds_read_b64_tr_b16 v[116:117], v134 offset:40
  ds_read_b64_tr_b16 v[118:119], v135 offset:40
  v_mfma_f32_16x16x32_bf16 v[32:35], v[100:103], v[124:127], v[32:35]
  s_add_u32 s76, s76, 34816
  s_cmp_eq_u32 s76, 139264
  v_mfma_f32_16x16x32_bf16 v[52:55], v[104:107], v[124:127], v[52:55]
  s_cselect_b32 s76, 0, s76
  v_mfma_f32_16x16x32_bf16 v[72:75], v[108:111], v[124:127], v[72:75]
  s_waitcnt lgkmcnt(4)
  v_mfma_f32_16x16x32_bf16 v[16:19], v[96:99], v[128:131], v[16:19]
  ds_read_b64_tr_b16 v[120:121], v134 offset:144
  v_mfma_f32_16x16x32_bf16 v[36:39], v[100:103], v[128:131], v[36:39]
  ds_read_b64_tr_b16 v[122:123], v135 offset:144
  v_mfma_f32_16x16x32_bf16 v[56:59], v[104:107], v[128:131], v[56:59]
  v_mfma_f32_16x16x32_bf16 v[76:79], v[108:111], v[128:131], v[76:79]
  s_waitcnt lgkmcnt(4)
  v_mfma_f32_16x16x32_bf16 v[0:3], v[80:83], v[112:115], v[0:3]
  ds_read_b64_tr_b16 v[124:125], v134 offset:184
  ds_read_b64_tr_b16 v[126:127], v135 offset:184
  v_mfma_f32_16x16x32_bf16 v[20:23], v[84:87], v[112:115], v[20:23]
  ds_read_b128 v[96:99], v133 offset:0
  ds_read_b128 v[100:103], v133 offset:2048
  v_mfma_f32_16x16x32_bf16 v[40:43], v[88:91], v[112:115], v[40:43]
  ds_read_b128 v[104:107], v133 offset:4096
  ds_read_b128 v[108:111], v133 offset:6144
  v_mfma_f32_16x16x32_bf16 v[60:63], v[92:95], v[112:115], v[60:63]
  s_waitcnt lgkmcnt(8)
  v_mfma_f32_16x16x32_bf16 v[4:7], v[80:83], v[116:119], v[4:7]
  ds_read_b64_tr_b16 v[128:129], v136 offset:0
  ds_read_b64_tr_b16 v[130:131], v137 offset:0
  s_lshl_b32 s82, s75, 8
  v_mfma_f32_16x16x32_bf16 v[24:27], v[84:87], v[116:119], v[24:27]
  s_add_u32 s82, s82, 139264
  v_mov_b32 v145, s76
  v_mov_b32 v146, s82
  v_mfma_f32_16x16x32_bf16 v[44:47], v[88:91], v[116:119], v[44:47]
  v_cndmask_b32 v145, v145, v146, s[84:85]
  s_and_b32 s75, s71, 15
  s_lshr_b32 s71, s71, 4
  v_mfma_f32_16x16x32_bf16 v[64:67], v[92:95], v[116:119], v[64:67]
  s_waitcnt lgkmcnt(8)
  v_mfma_f32_16x16x32_bf16 v[8:11], v[80:83], v[120:123], v[8:11]
  ds_read_b64_tr_b16 v[112:113], v134 offset:9216
  v_mfma_f32_16x16x32_bf16 v[28:31], v[84:87], v[120:123], v[28:31]
  ds_read_b64_tr_b16 v[114:115], v135 offset:9216
  v_mfma_f32_16x16x32_bf16 v[48:51], v[88:91], v[120:123], v[48:51]
  v_mfma_f32_16x16x32_bf16 v[68:71], v[92:95], v[120:123], v[68:71]
  s_waitcnt lgkmcnt(8)
  v_mfma_f32_16x16x32_bf16 v[12:15], v[80:83], v[124:127], v[12:15]
  ds_read_b64_tr_b16 v[116:117], v134 offset:9256
  v_mfma_f32_16x16x32_bf16 v[32:35], v[84:87], v[124:127], v[32:35]
  ds_read_b64_tr_b16 v[118:119], v135 offset:9256
  v_mfma_f32_16x16x32_bf16 v[52:55], v[88:91], v[124:127], v[52:55]
  v_mfma_f32_16x16x32_bf16 v[72:75], v[92:95], v[124:127], v[72:75]
  s_waitcnt lgkmcnt(4)
  v_mfma_f32_16x16x32_bf16 v[16:19], v[80:83], v[128:131], v[16:19]
  ds_read_b64_tr_b16 v[120:121], v134 offset:9360
  v_mfma_f32_16x16x32_bf16 v[36:39], v[84:87], v[128:131], v[36:39]
  ds_read_b64_tr_b16 v[122:123], v135 offset:9360
  v_mfma_f32_16x16x32_bf16 v[56:59], v[88:91], v[128:131], v[56:59]
  v_mfma_f32_16x16x32_bf16 v[76:79], v[92:95], v[128:131], v[76:79]
  s_waitcnt lgkmcnt(4)
  v_mfma_f32_16x16x32_bf16 v[0:3], v[96:99], v[112:115], v[0:3]
  ds_read_b64_tr_b16 v[124:125], v134 offset:9400
  v_mfma_f32_16x16x32_bf16 v[20:23], v[100:103], v[112:115], v[20:23]
  ds_read_b64_tr_b16 v[126:127], v135 offset:9400
  v_mfma_f32_16x16x32_bf16 v[40:43], v[104:107], v[112:115], v[40:43]
  v_mfma_f32_16x16x32_bf16 v[60:63], v[108:111], v[112:115], v[60:63]
  s_waitcnt lgkmcnt(4)
  v_mfma_f32_16x16x32_bf16 v[4:7], v[96:99], v[116:119], v[4:7]
  s_barrier
  v_add_u32 v132, s76, v138
  v_add_u32 v133, s76, v139
  v_mfma_f32_16x16x32_bf16 v[24:27], v[100:103], v[116:119], v[24:27]
  ds_read_b128 v[80:83], v132 offset:0
  ds_read_b128 v[84:87], v132 offset:2048
  ds_read_b128 v[88:91], v132 offset:4096
  v_mfma_f32_16x16x32_bf16 v[44:47], v[104:107], v[116:119], v[44:47]
  ds_read_b128 v[92:95], v132 offset:6144
  ds_read_b64_tr_b16 v[128:129], v136 offset:9216
  ds_read_b64_tr_b16 v[130:131], v137 offset:9216
  v_mfma_f32_16x16x32_bf16 v[64:67], v[108:111], v[116:119], v[64:67]
  s_waitcnt lgkmcnt(8)
  v_mfma_f32_16x16x32_bf16 v[8:11], v[96:99], v[120:123], v[8:11]
  v_add_u32 v134, s76, v140
  v_add_u32 v135, s76, v141
  v_mfma_f32_16x16x32_bf16 v[28:31], v[100:103], v[120:123], v[28:31]
  ds_read_b64_tr_b16 v[112:113], v134 offset:0
  ds_read_b64_tr_b16 v[114:115], v135 offset:0
  v_mfma_f32_16x16x32_bf16 v[48:51], v[104:107], v[120:123], v[48:51]
  v_add_u32 v136, v145, v142
  v_add_u32 v137, v145, v143
  v_mfma_f32_16x16x32_bf16 v[68:71], v[108:111], v[120:123], v[68:71]
  s_waitcnt lgkmcnt(8)
  v_mfma_f32_16x16x32_bf16 v[12:15], v[96:99], v[124:127], v[12:15]
  ds_read_b64_tr_b16 v[116:117], v134 offset:40
  ds_read_b64_tr_b16 v[118:119], v135 offset:40
  v_mfma_f32_16x16x32_bf16 v[32:35], v[100:103], v[124:127], v[32:35]
  s_add_u32 s76, s76, 34816
  s_cmp_eq_u32 s76, 139264
  v_mfma_f32_16x16x32_bf16 v[52:55], v[104:107], v[124:127], v[52:55]
  s_cselect_b32 s76, 0, s76
  v_mfma_f32_16x16x32_bf16 v[72:75], v[108:111], v[124:127], v[72:75]
  s_waitcnt lgkmcnt(4)
  v_mfma_f32_16x16x32_bf16 v[16:19], v[96:99], v[128:131], v[16:19]
  ds_read_b64_tr_b16 v[120:121], v134 offset:144
  v_mfma_f32_16x16x32_bf16 v[36:39], v[100:103], v[128:131], v[36:39]
  ds_read_b64_tr_b16 v[122:123], v135 offset:144
  v_mfma_f32_16x16x32_bf16 v[56:59], v[104:107], v[128:131], v[56:59]
  v_mfma_f32_16x16x32_bf16 v[76:79], v[108:111], v[128:131], v[76:79]
  s_waitcnt lgkmcnt(4)
  v_mfma_f32_16x16x32_bf16 v[0:3], v[80:83], v[112:115], v[0:3]
  ds_read_b64_tr_b16 v[124:125], v134 offset:184
  ds_read_b64_tr_b16 v[126:127], v135 offset:184
  v_mfma_f32_16x16x32_bf16 v[20:23], v[84:87], v[112:115], v[20:23]
  ds_read_b128 v[96:99], v133 offset:0
  ds_read_b128 v[100:103], v133 offset:2048
  v_mfma_f32_16x16x32_bf16 v[40:43], v[88:91], v[112:115], v[40:43]
  ds_read_b128 v[104:107], v133 offset:4096
  ds_read_b128 v[108:111], v133 offset:6144
  v_mfma_f32_16x16x32_bf16 v[60:63], v[92:95], v[112:115], v[60:63]
  s_waitcnt lgkmcnt(8)
  v_mfma_f32_16x16x32_bf16 v[4:7], v[80:83], v[116:119], v[4:7]
  ds_read_b64_tr_b16 v[128:129], v136 offset:0
  ds_read_b64_tr_b16 v[130:131], v137 offset:0
  s_lshl_b32 s82, s75, 8
  v_mfma_f32_16x16x32_bf16 v[24:27], v[84:87], v[116:119], v[24:27]
  s_add_u32 s82, s82, 139264
  v_mov_b32 v145, s76
  v_mov_b32 v146, s82
  v_mfma_f32_16x16x32_bf16 v[44:47], v[88:91], v[116:119], v[44:47]
  v_cndmask_b32 v145, v145, v146, s[84:85]
  s_and_b32 s75, s71, 15
  s_lshr_b32 s71, s71, 4
  v_mfma_f32_16x16x32_bf16 v[64:67], v[92:95], v[116:119], v[64:67]
  s_waitcnt lgkmcnt(8)
  v_mfma_f32_16x16x32_bf16 v[8:11], v[80:83], v[120:123], v[8:11]
  ds_read_b64_tr_b16 v[112:113], v134 offset:9216
  v_mfma_f32_16x16x32_bf16 v[28:31], v[84:87], v[120:123], v[28:31]
  ds_read_b64_tr_b16 v[114:115], v135 offset:9216
  v_mfma_f32_16x16x32_bf16 v[48:51], v[88:91], v[120:123], v[48:51]
  v_mfma_f32_16x16x32_bf16 v[68:71], v[92:95], v[120:123], v[68:71]
  s_waitcnt lgkmcnt(8)
  v_mfma_f32_16x16x32_bf16 v[12:15], v[80:83], v[124:127], v[12:15]
  ds_read_b64_tr_b16 v[116:117], v134 offset:9256
  v_mfma_f32_16x16x32_bf16 v[32:35], v[84:87], v[124:127], v[32:35]
  ds_read_b64_tr_b16 v[118:119], v135 offset:9256
  v_mfma_f32_16x16x32_bf16 v[52:55], v[88:91], v[124:127], v[52:55]
  v_mfma_f32_16x16x32_bf16 v[72:75], v[92:95], v[124:127], v[72:75]
  s_waitcnt lgkmcnt(4)
  v_mfma_f32_16x16x32_bf16 v[16:19], v[80:83], v[128:131], v[16:19]
  ds_read_b64_tr_b16 v[120:121], v134 offset:9360
  v_mfma_f32_16x16x32_bf16 v[36:39], v[84:87], v[128:131], v[36:39]
  ds_read_b64_tr_b16 v[122:123], v135 offset:9360
  v_mfma_f32_16x16x32_bf16 v[56:59], v[88:91], v[128:131], v[56:59]
  v_mfma_f32_16x16x32_bf16 v[76:79], v[92:95], v[128:131], v[76:79]
  s_waitcnt lgkmcnt(4)
  v_mfma_f32_16x16x32_bf16 v[0:3], v[96:99], v[112:115], v[0:3]
  ds_read_b64_tr_b16 v[124:125], v134 offset:9400
  v_mfma_f32_16x16x32_bf16 v[20:23], v[100:103], v[112:115], v[20:23]
  ds_read_b64_tr_b16 v[126:127], v135 offset:9400
  v_mfma_f32_16x16x32_bf16 v[40:43], v[104:107], v[112:115], v[40:43]
  v_mfma_f32_16x16x32_bf16 v[60:63], v[108:111], v[112:115], v[60:63]
  s_waitcnt lgkmcnt(4)
  v_mfma_f32_16x16x32_bf16 v[4:7], v[96:99], v[116:119], v[4:7]
  s_barrier
  v_add_u32 v132, s76, v138
  v_add_u32 v133, s76, v139
  v_mfma_f32_16x16x32_bf16 v[24:27], v[100:103], v[116:119], v[24:27]
  ds_read_b128 v[80:83], v132 offset:0
  ds_read_b128 v[84:87], v132 offset:2048
  ds_read_b128 v[88:91], v132 offset:4096
  v_mfma_f32_16x16x32_bf16 v[44:47], v[104:107], v[116:119], v[44:47]
  ds_read_b128 v[92:95], v132 offset:6144
  ds_read_b64_tr_b16 v[128:129], v136 offset:9216
  ds_read_b64_tr_b16 v[130:131], v137 offset:9216
  v_mfma_f32_16x16x32_bf16 v[64:67], v[108:111], v[116:119], v[64:67]
  s_waitcnt lgkmcnt(8)
  v_mfma_f32_16x16x32_bf16 v[8:11], v[96:99], v[120:123], v[8:11]
  v_add_u32 v134, s76, v140
  v_add_u32 v135, s76, v141
  v_mfma_f32_16x16x32_bf16 v[28:31], v[100:103], v[120:123], v[28:31]
  ds_read_b64_tr_b16 v[112:113], v134 offset:0
  ds_read_b64_tr_b16 v[114:115], v135 offset:0
  v_mfma_f32_16x16x32_bf16 v[48:51], v[104:107], v[120:123], v[48:51]
  v_add_u32 v136, v145, v142
  v_add_u32 v137, v145, v143
  v_mfma_f32_16x16x32_bf16 v[68:71], v[108:111], v[120:123], v[68:71]
  s_waitcnt lgkmcnt(8)
  v_mfma_f32_16x16x32_bf16 v[12:15], v[96:99], v[124:127], v[12:15]
  ds_read_b64_tr_b16 v[116:117], v134 offset:40
  ds_read_b64_tr_b16 v[118:119], v135 offset:40
  v_mfma_f32_16x16x32_bf16 v[32:35], v[100:103], v[124:127], v[32:35]
  s_add_u32 s76, s76, 34816
  s_cmp_eq_u32 s76, 139264
  v_mfma_f32_16x16x32_bf16 v[52:55], v[104:107], v[124:127], v[52:55]
  s_cselect_b32 s76, 0, s76
  v_mfma_f32_16x16x32_bf16 v[72:75], v[108:111], v[124:127], v[72:75]
  s_waitcnt lgkmcnt(4)
  v_mfma_f32_16x16x32_bf16 v[16:19], v[96:99], v[128:131], v[16:19]
  ds_read_b64_tr_b16 v[120:121], v134 offset:144
  v_mfma_f32_16x16x32_bf16 v[36:39], v[100:103], v[128:131], v[36:39]
  ds_read_b64_tr_b16 v[122:123], v135 offset:144
  v_mfma_f32_16x16x32_bf16 v[56:59], v[104:107], v[128:131], v[56:59]
  v_mfma_f32_16x16x32_bf16 v[76:79], v[108:111], v[128:131], v[76:79]
  s_waitcnt lgkmcnt(4)
  v_mfma_f32_16x16x32_bf16 v[0:3], v[80:83], v[112:115], v[0:3]
  ds_read_b64_tr_b16 v[124:125], v134 offset:184
  ds_read_b64_tr_b16 v[126:127], v135 offset:184
  v_mfma_f32_16x16x32_bf16 v[20:23], v[84:87], v[112:115], v[20:23]
  ds_read_b128 v[96:99], v133 offset:0
  ds_read_b128 v[100:103], v133 offset:2048
  v_mfma_f32_16x16x32_bf16 v[40:43], v[88:91], v[112:115], v[40:43]
  ds_read_b128 v[104:107], v133 offset:4096
  ds_read_b128 v[108:111], v133 offset:6144
  v_mfma_f32_16x16x32_bf16 v[60:63], v[92:95], v[112:115], v[60:63]
  s_waitcnt lgkmcnt(8)
  v_mfma_f32_16x16x32_bf16 v[4:7], v[80:83], v[116:119], v[4:7]
  ds_read_b64_tr_b16 v[128:129], v136 offset:0
  ds_read_b64_tr_b16 v[130:131], v137 offset:0
  s_lshl_b32 s82, s75, 8
  v_mfma_f32_16x16x32_bf16 v[24:27], v[84:87], v[116:119], v[24:27]
  s_add_u32 s82, s82, 139264
  v_mov_b32 v145, s76
  v_mov_b32 v146, s82
  v_mfma_f32_16x16x32_bf16 v[44:47], v[88:91], v[116:119], v[44:47]
  v_cndmask_b32 v145, v145, v146, s[84:85]
  s_and_b32 s75, s71, 15
  s_lshr_b32 s71, s71, 4
  v_mfma_f32_16x16x32_bf16 v[64:67], v[92:95], v[116:119], v[64:67]
  s_waitcnt lgkmcnt(8)
  v_mfma_f32_16x16x32_bf16 v[8:11], v[80:83], v[120:123], v[8:11]
  ds_read_b64_tr_b16 v[112:113], v134 offset:9216
  v_mfma_f32_16x16x32_bf16 v[28:31], v[84:87], v[120:123], v[28:31]
  ds_read_b64_tr_b16 v[114:115], v135 offset:9216
  v_mfma_f32_16x16x32_bf16 v[48:51], v[88:91], v[120:123], v[48:51]
  v_mfma_f32_16x16x32_bf16 v[68:71], v[92:95], v[120:123], v[68:71]
  s_waitcnt lgkmcnt(8)
  v_mfma_f32_16x16x32_bf16 v[12:15], v[80:83], v[124:127], v[12:15]
  ds_read_b64_tr_b16 v[116:117], v134 offset:9256
  v_mfma_f32_16x16x32_bf16 v[32:35], v[84:87], v[124:127], v[32:35]
  ds_read_b64_tr_b16 v[118:119], v135 offset:9256
  v_mfma_f32_16x16x32_bf16 v[52:55], v[88:91], v[124:127], v[52:55]
  v_mfma_f32_16x16x32_bf16 v[72:75], v[92:95], v[124:127], v[72:75]
  s_waitcnt lgkmcnt(4)
  v_mfma_f32_16x16x32_bf16 v[16:19], v[80:83], v[128:131], v[16:19]
  ds_read_b64_tr_b16 v[120:121], v134 offset:9360
  v_mfma_f32_16x16x32_bf16 v[36:39], v[84:87], v[128:131], v[36:39]
  ds_read_b64_tr_b16 v[122:123], v135 offset:9360
  v_mfma_f32_16x16x32_bf16 v[56:59], v[88:91], v[128:131], v[56:59]
  v_mfma_f32_16x16x32_bf16 v[76:79], v[92:95], v[128:131], v[76:79]
  s_waitcnt lgkmcnt(4)
  v_mfma_f32_16x16x32_bf16 v[0:3], v[96:99], v[112:115], v[0:3]
  ds_read_b64_tr_b16 v[124:125], v134 offset:9400
  v_mfma_f32_16x16x32_bf16 v[20:23], v[100:103], v[112:115], v[20:23]
  ds_read_b64_tr_b16 v[126:127], v135 offset:9400
  v_mfma_f32_16x16x32_bf16 v[40:43], v[104:107], v[112:115], v[40:43]
  v_mfma_f32_16x16x32_bf16 v[60:63], v[108:111], v[112:115], v[60:63]
  s_waitcnt lgkmcnt(4)
  v_mfma_f32_16x16x32_bf16 v[4:7], v[96:99], v[116:119], v[4:7]
  s_barrier
  v_add_u32 v132, s76, v138
  v_add_u32 v133, s76, v139
  v_mfma_f32_16x16x32_bf16 v[24:27], v[100:103], v[116:119], v[24:27]
  ds_read_b128 v[80:83], v132 offset:0
  ds_read_b128 v[84:87], v132 offset:2048
  ds_read_b128 v[88:91], v132 offset:4096
  v_mfma_f32_16x16x32_bf16 v[44:47], v[104:107], v[116:119], v[44:47]
  ds_read_b128 v[92:95], v132 offset:6144
  ds_read_b64_tr_b16 v[128:129], v136 offset:9216
  ds_read_b64_tr_b16 v[130:131], v137 offset:9216
  v_mfma_f32_16x16x32_bf16 v[64:67], v[108:111], v[116:119], v[64:67]
  s_waitcnt lgkmcnt(8)
  v_mfma_f32_16x16x32_bf16 v[8:11], v[96:99], v[120:123], v[8:11]
  v_add_u32 v134, s76, v140
  v_add_u32 v135, s76, v141
  v_mfma_f32_16x16x32_bf16 v[28:31], v[100:103], v[120:123], v[28:31]
  ds_read_b64_tr_b16 v[112:113], v134 offset:0
  ds_read_b64_tr_b16 v[114:115], v135 offset:0
  v_mfma_f32_16x16x32_bf16 v[48:51], v[104:107], v[120:123], v[48:51]
  v_add_u32 v136, v145, v142
  v_add_u32 v137, v145, v143
  v_mfma_f32_16x16x32_bf16 v[68:71], v[108:111], v[120:123], v[68:71]
  s_waitcnt lgkmcnt(8)
  v_mfma_f32_16x16x32_bf16 v[12:15], v[96:99], v[124:127], v[12:15]
  ds_read_b64_tr_b16 v[116:117], v134 offset:40
  ds_read_b64_tr_b16 v[118:119], v135 offset:40
  v_mfma_f32_16x16x32_bf16 v[32:35], v[100:103], v[124:127], v[32:35]
  s_add_u32 s76, s76, 34816
  s_cmp_eq_u32 s76, 139264
  v_mfma_f32_16x16x32_bf16 v[52:55], v[104:107], v[124:127], v[52:55]
  s_cselect_b32 s76, 0, s76
  v_mfma_f32_16x16x32_bf16 v[72:75], v[108:111], v[124:127], v[72:75]
  s_waitcnt lgkmcnt(4)
  v_mfma_f32_16x16x32_bf16 v[16:19], v[96:99], v[128:131], v[16:19]
  ds_read_b64_tr_b16 v[120:121], v134 offset:144
  v_mfma_f32_16x16x32_bf16 v[36:39], v[100:103], v[128:131], v[36:39]
  ds_read_b64_tr_b16 v[122:123], v135 offset:144
  v_mfma_f32_16x16x32_bf16 v[56:59], v[104:107], v[128:131], v[56:59]
  v_mfma_f32_16x16x32_bf16 v[76:79], v[108:111], v[128:131], v[76:79]
  s_waitcnt lgkmcnt(4)
  v_mfma_f32_16x16x32_bf16 v[0:3], v[80:83], v[112:115], v[0:3]
  ds_read_b64_tr_b16 v[124:125], v134 offset:184
  ds_read_b64_tr_b16 v[126:127], v135 offset:184
  v_mfma_f32_16x16x32_bf16 v[20:23], v[84:87], v[112:115], v[20:23]
  ds_read_b128 v[96:99], v133 offset:0
  ds_read_b128 v[100:103], v133 offset:2048
  v_mfma_f32_16x16x32_bf16 v[40:43], v[88:91], v[112:115], v[40:43]
  ds_read_b128 v[104:107], v133 offset:4096
  ds_read_b128 v[108:111], v133 offset:6144
  v_mfma_f32_16x16x32_bf16 v[60:63], v[92:95], v[112:115], v[60:63]
  s_waitcnt lgkmcnt(8)
  v_mfma_f32_16x16x32_bf16 v[4:7], v[80:83], v[116:119], v[4:7]
  ds_read_b64_tr_b16 v[128:129], v136 offset:0
  ds_read_b64_tr_b16 v[130:131], v137 offset:0
  s_lshl_b32 s82, s75, 8
  v_mfma_f32_16x16x32_bf16 v[24:27], v[84:87], v[116:119], v[24:27]
  s_add_u32 s82, s82, 139264
  v_mov_b32 v145, s76
  v_mov_b32 v146, s82
  v_mfma_f32_16x16x32_bf16 v[44:47], v[88:91], v[116:119], v[44:47]
  v_cndmask_b32 v145, v145, v146, s[84:85]
  s_and_b32 s75, s71, 15
  s_lshr_b32 s71, s71, 4
  v_mfma_f32_16x16x32_bf16 v[64:67], v[92:95], v[116:119], v[64:67]
  s_waitcnt lgkmcnt(8)
  v_mfma_f32_16x16x32_bf16 v[8:11], v[80:83], v[120:123], v[8:11]
  ds_read_b64_tr_b16 v[112:113], v134 offset:9216
  v_mfma_f32_16x16x32_bf16 v[28:31], v[84:87], v[120:123], v[28:31]
  ds_read_b64_tr_b16 v[114:115], v135 offset:9216
  v_mfma_f32_16x16x32_bf16 v[48:51], v[88:91], v[120:123], v[48:51]
  v_mfma_f32_16x16x32_bf16 v[68:71], v[92:95], v[120:123], v[68:71]
  s_waitcnt lgkmcnt(8)
  v_mfma_f32_16x16x32_bf16 v[12:15], v[80:83], v[124:127], v[12:15]
  ds_read_b64_tr_b16 v[116:117], v134 offset:9256
  v_mfma_f32_16x16x32_bf16 v[32:35], v[84:87], v[124:127], v[32:35]
  ds_read_b64_tr_b16 v[118:119], v135 offset:9256
  v_mfma_f32_16x16x32_bf16 v[52:55], v[88:91], v[124:127], v[52:55]
  v_mfma_f32_16x16x32_bf16 v[72:75], v[92:95], v[124:127], v[72:75]
  s_waitcnt lgkmcnt(4)
  v_mfma_f32_16x16x32_bf16 v[16:19], v[80:83], v[128:131], v[16:19]
  ds_read_b64_tr_b16 v[120:121], v134 offset:9360
  v_mfma_f32_16x16x32_bf16 v[36:39], v[84:87], v[128:131], v[36:39]
  ds_read_b64_tr_b16 v[122:123], v135 offset:9360
  v_mfma_f32_16x16x32_bf16 v[56:59], v[88:91], v[128:131], v[56:59]
  v_mfma_f32_16x16x32_bf16 v[76:79], v[92:95], v[128:131], v[76:79]
  s_waitcnt lgkmcnt(4)
  v_mfma_f32_16x16x32_bf16 v[0:3], v[96:99], v[112:115], v[0:3]
  ds_read_b64_tr_b16 v[124:125], v134 offset:9400
  v_mfma_f32_16x16x32_bf16 v[20:23], v[100:103], v[112:115], v[20:23]
  ds_read_b64_tr_b16 v[126:127], v135 offset:9400
  v_mfma_f32_16x16x32_bf16 v[40:43], v[104:107], v[112:115], v[40:43]
  v_mfma_f32_16x16x32_bf16 v[60:63], v[108:111], v[112:115], v[60:63]
  s_waitcnt lgkmcnt(4)
  v_mfma_f32_16x16x32_bf16 v[4:7], v[96:99], v[116:119], v[4:7]
  s_barrier
  v_add_u32 v132, s76, v138
  v_add_u32 v133, s76, v139
  v_mfma_f32_16x16x32_bf16 v[24:27], v[100:103], v[116:119], v[24:27]
  ds_read_b128 v[80:83], v132 offset:0
  ds_read_b128 v[84:87], v132 offset:2048
  ds_read_b128 v[88:91], v132 offset:4096
  v_mfma_f32_16x16x32_bf16 v[44:47], v[104:107], v[116:119], v[44:47]
  ds_read_b128 v[92:95], v132 offset:6144
  ds_read_b64_tr_b16 v[128:129], v136 offset:9216
  ds_read_b64_tr_b16 v[130:131], v137 offset:9216
  v_mfma_f32_16x16x32_bf16 v[64:67], v[108:111], v[116:119], v[64:67]
  s_waitcnt lgkmcnt(8)
  v_mfma_f32_16x16x32_bf16 v[8:11], v[96:99], v[120:123], v[8:11]
  v_add_u32 v134, s76, v140
  v_add_u32 v135, s76, v141
  v_mfma_f32_16x16x32_bf16 v[28:31], v[100:103], v[120:123], v[28:31]
  ds_read_b64_tr_b16 v[112:113], v134 offset:0
  ds_read_b64_tr_b16 v[114:115], v135 offset:0
  v_mfma_f32_16x16x32_bf16 v[48:51], v[104:107], v[120:123], v[48:51]
  v_add_u32 v136, v145, v142
  v_add_u32 v137, v145, v143
  v_mfma_f32_16x16x32_bf16 v[68:71], v[108:111], v[120:123], v[68:71]
  s_waitcnt lgkmcnt(8)
  v_mfma_f32_16x16x32_bf16 v[12:15], v[96:99], v[124:127], v[12:15]
  ds_read_b64_tr_b16 v[116:117], v134 offset:40
  ds_read_b64_tr_b16 v[118:119], v135 offset:40
  v_mfma_f32_16x16x32_bf16 v[32:35], v[100:103], v[124:127], v[32:35]
  s_add_u32 s76, s76, 34816
  s_cmp_eq_u32 s76, 139264
  v_mfma_f32_16x16x32_bf16 v[52:55], v[104:107], v[124:127], v[52:55]
  s_cselect_b32 s76, 0, s76
  v_mfma_f32_16x16x32_bf16 v[72:75], v[108:111], v[124:127], v[72:75]
  s_waitcnt lgkmcnt(4)
  v_mfma_f32_16x16x32_bf16 v[16:19], v[96:99], v[128:131], v[16:19]
  ds_read_b64_tr_b16 v[120:121], v134 offset:144
  v_mfma_f32_16x16x32_bf16 v[36:39], v[100:103], v[128:131], v[36:39]
  ds_read_b64_tr_b16 v[122:123], v135 offset:144
  v_mfma_f32_16x16x32_bf16 v[56:59], v[104:107], v[128:131], v[56:59]
  v_mfma_f32_16x16x32_bf16 v[76:79], v[108:111], v[128:131], v[76:79]
  s_waitcnt lgkmcnt(4)
  v_mfma_f32_16x16x32_bf16 v[0:3], v[80:83], v[112:115], v[0:3]
  ds_read_b64_tr_b16 v[124:125], v134 offset:184
  ds_read_b64_tr_b16 v[126:127], v135 offset:184
  v_mfma_f32_16x16x32_bf16 v[20:23], v[84:87], v[112:115], v[20:23]
  ds_read_b128 v[96:99], v133 offset:0
  ds_read_b128 v[100:103], v133 offset:2048
  v_mfma_f32_16x16x32_bf16 v[40:43], v[88:91], v[112:115], v[40:43]
  ds_read_b128 v[104:107], v133 offset:4096
  ds_read_b128 v[108:111], v133 offset:6144
  v_mfma_f32_16x16x32_bf16 v[60:63], v[92:95], v[112:115], v[60:63]
  s_waitcnt lgkmcnt(8)
  v_mfma_f32_16x16x32_bf16 v[4:7], v[80:83], v[116:119], v[4:7]
  ds_read_b64_tr_b16 v[128:129], v136 offset:0
  ds_read_b64_tr_b16 v[130:131], v137 offset:0
  s_lshl_b32 s82, s75, 8
  v_mfma_f32_16x16x32_bf16 v[24:27], v[84:87], v[116:119], v[24:27]
  s_add_u32 s82, s82, 139264
  v_mov_b32 v145, s76
  v_mov_b32 v146, s82
  v_mfma_f32_16x16x32_bf16 v[44:47], v[88:91], v[116:119], v[44:47]
  v_cndmask_b32 v145, v145, v146, s[84:85]
  s_and_b32 s75, s71, 15
  s_lshr_b32 s71, s71, 4
  v_mfma_f32_16x16x32_bf16 v[64:67], v[92:95], v[116:119], v[64:67]
  s_waitcnt lgkmcnt(8)
  v_mfma_f32_16x16x32_bf16 v[8:11], v[80:83], v[120:123], v[8:11]
  ds_read_b64_tr_b16 v[112:113], v134 offset:9216
  v_mfma_f32_16x16x32_bf16 v[28:31], v[84:87], v[120:123], v[28:31]
  ds_read_b64_tr_b16 v[114:115], v135 offset:9216
  v_mfma_f32_16x16x32_bf16 v[48:51], v[88:91], v[120:123], v[48:51]
  v_mfma_f32_16x16x32_bf16 v[68:71], v[92:95], v[120:123], v[68:71]
  s_waitcnt lgkmcnt(8)
  v_mfma_f32_16x16x32_bf16 v[12:15], v[80:83], v[124:127], v[12:15]
  ds_read_b64_tr_b16 v[116:117], v134 offset:9256
  v_mfma_f32_16x16x32_bf16 v[32:35], v[84:87], v[124:127], v[32:35]
  ds_read_b64_tr_b16 v[118:119], v135 offset:9256
  v_mfma_f32_16x16x32_bf16 v[52:55], v[88:91], v[124:127], v[52:55]
  v_mfma_f32_16x16x32_bf16 v[72:75], v[92:95], v[124:127], v[72:75]
  s_waitcnt lgkmcnt(4)
  v_mfma_f32_16x16x32_bf16 v[16:19], v[80:83], v[128:131], v[16:19]
  ds_read_b64_tr_b16 v[120:121], v134 offset:9360
  v_mfma_f32_16x16x32_bf16 v[36:39], v[84:87], v[128:131], v[36:39]
  ds_read_b64_tr_b16 v[122:123], v135 offset:9360
  v_mfma_f32_16x16x32_bf16 v[56:59], v[88:91], v[128:131], v[56:59]
  v_mfma_f32_16x16x32_bf16 v[76:79], v[92:95], v[128:131], v[76:79]
  s_waitcnt lgkmcnt(4)
  v_mfma_f32_16x16x32_bf16 v[0:3], v[96:99], v[112:115], v[0:3]
  ds_read_b64_tr_b16 v[124:125], v134 offset:9400
  v_mfma_f32_16x16x32_bf16 v[20:23], v[100:103], v[112:115], v[20:23]
  ds_read_b64_tr_b16 v[126:127], v135 offset:9400
  v_mfma_f32_16x16x32_bf16 v[40:43], v[104:107], v[112:115], v[40:43]
  v_mfma_f32_16x16x32_bf16 v[60:63], v[108:111], v[112:115], v[60:63]
  s_waitcnt lgkmcnt(4)
  v_mfma_f32_16x16x32_bf16 v[4:7], v[96:99], v[116:119], v[4:7]
  s_barrier
  v_add_u32 v132, s76, v138
  v_add_u32 v133, s76, v139
  v_mfma_f32_16x16x32_bf16 v[24:27], v[100:103], v[116:119], v[24:27]
  ds_read_b128 v[80:83], v132 offset:0
  ds_read_b128 v[84:87], v132 offset:2048
  ds_read_b128 v[88:91], v132 offset:4096
  v_mfma_f32_16x16x32_bf16 v[44:47], v[104:107], v[116:119], v[44:47]
  ds_read_b128 v[92:95], v132 offset:6144
  ds_read_b64_tr_b16 v[128:129], v136 offset:9216
  ds_read_b64_tr_b16 v[130:131], v137 offset:9216
  v_mfma_f32_16x16x32_bf16 v[64:67], v[108:111], v[116:119], v[64:67]
  s_waitcnt lgkmcnt(8)
  v_mfma_f32_16x16x32_bf16 v[8:11], v[96:99], v[120:123], v[8:11]
  v_add_u32 v134, s76, v140
  v_add_u32 v135, s76, v141
  v_mfma_f32_16x16x32_bf16 v[28:31], v[100:103], v[120:123], v[28:31]
  ds_read_b64_tr_b16 v[112:113], v134 offset:0
  ds_read_b64_tr_b16 v[114:115], v135 offset:0
  v_mfma_f32_16x16x32_bf16 v[48:51], v[104:107], v[120:123], v[48:51]
  v_add_u32 v136, v145, v142
  v_add_u32 v137, v145, v143
  v_mfma_f32_16x16x32_bf16 v[68:71], v[108:111], v[120:123], v[68:71]
  s_waitcnt lgkmcnt(8)
  v_mfma_f32_16x16x32_bf16 v[12:15], v[96:99], v[124:127], v[12:15]
  ds_read_b64_tr_b16 v[116:117], v134 offset:40
  ds_read_b64_tr_b16 v[118:119], v135 offset:40
  v_mfma_f32_16x16x32_bf16 v[32:35], v[100:103], v[124:127], v[32:35]
  s_add_u32 s76, s76, 34816
  s_cmp_eq_u32 s76, 139264
  v_mfma_f32_16x16x32_bf16 v[52:55], v[104:107], v[124:127], v[52:55]
  s_cselect_b32 s76, 0, s76
  v_mfma_f32_16x16x32_bf16 v[72:75], v[108:111], v[124:127], v[72:75]
  s_waitcnt lgkmcnt(4)
  v_mfma_f32_16x16x32_bf16 v[16:19], v[96:99], v[128:131], v[16:19]
  ds_read_b64_tr_b16 v[120:121], v134 offset:144
  v_mfma_f32_16x16x32_bf16 v[36:39], v[100:103], v[128:131], v[36:39]
  ds_read_b64_tr_b16 v[122:123], v135 offset:144
  v_mfma_f32_16x16x32_bf16 v[56:59], v[104:107], v[128:131], v[56:59]
  v_mfma_f32_16x16x32_bf16 v[76:79], v[108:111], v[128:131], v[76:79]
  s_waitcnt lgkmcnt(4)
  v_mfma_f32_16x16x32_bf16 v[0:3], v[80:83], v[112:115], v[0:3]
  ds_read_b64_tr_b16 v[124:125], v134 offset:184
  ds_read_b64_tr_b16 v[126:127], v135 offset:184
  v_mfma_f32_16x16x32_bf16 v[20:23], v[84:87], v[112:115], v[20:23]
  ds_read_b128 v[96:99], v133 offset:0
  ds_read_b128 v[100:103], v133 offset:2048
  v_mfma_f32_16x16x32_bf16 v[40:43], v[88:91], v[112:115], v[40:43]
  ds_read_b128 v[104:107], v133 offset:4096
  ds_read_b128 v[108:111], v133 offset:6144
  v_mfma_f32_16x16x32_bf16 v[60:63], v[92:95], v[112:115], v[60:63]
  s_waitcnt lgkmcnt(8)
  v_mfma_f32_16x16x32_bf16 v[4:7], v[80:83], v[116:119], v[4:7]
  ds_read_b64_tr_b16 v[128:129], v136 offset:0
  ds_read_b64_tr_b16 v[130:131], v137 offset:0
  s_lshl_b32 s82, s75, 8
  v_mfma_f32_16x16x32_bf16 v[24:27], v[84:87], v[116:119], v[24:27]
  s_add_u32 s82, s82, 139264
  v_mov_b32 v145, s76
  v_mov_b32 v146, s82
  v_mfma_f32_16x16x32_bf16 v[44:47], v[88:91], v[116:119], v[44:47]
  v_cndmask_b32 v145, v145, v146, s[84:85]
  s_and_b32 s75, s71, 15
  s_lshr_b32 s71, s71, 4
  v_mfma_f32_16x16x32_bf16 v[64:67], v[92:95], v[116:119], v[64:67]
  s_waitcnt lgkmcnt(8)
  v_mfma_f32_16x16x32_bf16 v[8:11], v[80:83], v[120:123], v[8:11]
  ds_read_b64_tr_b16 v[112:113], v134 offset:9216
  v_mfma_f32_16x16x32_bf16 v[28:31], v[84:87], v[120:123], v[28:31]
  ds_read_b64_tr_b16 v[114:115], v135 offset:9216
  v_mfma_f32_16x16x32_bf16 v[48:51], v[88:91], v[120:123], v[48:51]
  v_mfma_f32_16x16x32_bf16 v[68:71], v[92:95], v[120:123], v[68:71]
  s_waitcnt lgkmcnt(8)
  v_mfma_f32_16x16x32_bf16 v[12:15], v[80:83], v[124:127], v[12:15]
  ds_read_b64_tr_b16 v[116:117], v134 offset:9256
  v_mfma_f32_16x16x32_bf16 v[32:35], v[84:87], v[124:127], v[32:35]
  ds_read_b64_tr_b16 v[118:119], v135 offset:9256
  v_mfma_f32_16x16x32_bf16 v[52:55], v[88:91], v[124:127], v[52:55]
  v_mfma_f32_16x16x32_bf16 v[72:75], v[92:95], v[124:127], v[72:75]
  s_waitcnt lgkmcnt(4)
  v_mfma_f32_16x16x32_bf16 v[16:19], v[80:83], v[128:131], v[16:19]
  ds_read_b64_tr_b16 v[120:121], v134 offset:9360
  v_mfma_f32_16x16x32_bf16 v[36:39], v[84:87], v[128:131], v[36:39]
  ds_read_b64_tr_b16 v[122:123], v135 offset:9360
  v_mfma_f32_16x16x32_bf16 v[56:59], v[88:91], v[128:131], v[56:59]
  v_mfma_f32_16x16x32_bf16 v[76:79], v[92:95], v[128:131], v[76:79]
  s_waitcnt lgkmcnt(4)
  v_mfma_f32_16x16x32_bf16 v[0:3], v[96:99], v[112:115], v[0:3]
  ds_read_b64_tr_b16 v[124:125], v134 offset:9400
  v_mfma_f32_16x16x32_bf16 v[20:23], v[100:103], v[112:115], v[20:23]
  ds_read_b64_tr_b16 v[126:127], v135 offset:9400
  v_mfma_f32_16x16x32_bf16 v[40:43], v[104:107], v[112:115], v[40:43]
  v_mfma_f32_16x16x32_bf16 v[60:63], v[108:111], v[112:115], v[60:63]
  s_waitcnt lgkmcnt(4)
  v_mfma_f32_16x16x32_bf16 v[4:7], v[96:99], v[116:119], v[4:7]
  s_barrier
  v_add_u32 v132, s76, v138
  v_add_u32 v133, s76, v139
  v_mfma_f32_16x16x32_bf16 v[24:27], v[100:103], v[116:119], v[24:27]
  ds_read_b128 v[80:83], v132 offset:0
  ds_read_b128 v[84:87], v132 offset:2048
  ds_read_b128 v[88:91], v132 offset:4096
  v_mfma_f32_16x16x32_bf16 v[44:47], v[104:107], v[116:119], v[44:47]
  ds_read_b128 v[92:95], v132 offset:6144
  ds_read_b64_tr_b16 v[128:129], v136 offset:9216
  ds_read_b64_tr_b16 v[130:131], v137 offset:9216
  v_mfma_f32_16x16x32_bf16 v[64:67], v[108:111], v[116:119], v[64:67]
  s_waitcnt lgkmcnt(8)
  v_mfma_f32_16x16x32_bf16 v[8:11], v[96:99], v[120:123], v[8:11]
  v_add_u32 v134, s76, v140
  v_add_u32 v135, s76, v141
  v_mfma_f32_16x16x32_bf16 v[28:31], v[100:103], v[120:123], v[28:31]
  ds_read_b64_tr_b16 v[112:113], v134 offset:0
  ds_read_b64_tr_b16 v[114:115], v135 offset:0
  v_mfma_f32_16x16x32_bf16 v[48:51], v[104:107], v[120:123], v[48:51]
  v_add_u32 v136, v145, v142
  v_add_u32 v137, v145, v143
  v_mfma_f32_16x16x32_bf16 v[68:71], v[108:111], v[120:123], v[68:71]
  s_waitcnt lgkmcnt(8)
  v_mfma_f32_16x16x32_bf16 v[12:15], v[96:99], v[124:127], v[12:15]
  ds_read_b64_tr_b16 v[116:117], v134 offset:40
  ds_read_b64_tr_b16 v[118:119], v135 offset:40
  v_mfma_f32_16x16x32_bf16 v[32:35], v[100:103], v[124:127], v[32:35]
  s_add_u32 s76, s76, 34816
  s_cmp_eq_u32 s76, 139264
  v_mfma_f32_16x16x32_bf16 v[52:55], v[104:107], v[124:127], v[52:55]
  s_cselect_b32 s76, 0, s76
  v_mfma_f32_16x16x32_bf16 v[72:75], v[108:111], v[124:127], v[72:75]
  s_waitcnt lgkmcnt(4)
  v_mfma_f32_16x16x32_bf16 v[16:19], v[96:99], v[128:131], v[16:19]
  ds_read_b64_tr_b16 v[120:121], v134 offset:144
  v_mfma_f32_16x16x32_bf16 v[36:39], v[100:103], v[128:131], v[36:39]
  ds_read_b64_tr_b16 v[122:123], v135 offset:144
  v_mfma_f32_16x16x32_bf16 v[56:59], v[104:107], v[128:131], v[56:59]
  v_mfma_f32_16x16x32_bf16 v[76:79], v[108:111], v[128:131], v[76:79]
  s_waitcnt lgkmcnt(4)
  v_mfma_f32_16x16x32_bf16 v[0:3], v[80:83], v[112:115], v[0:3]
  ds_read_b64_tr_b16 v[124:125], v134 offset:184
  ds_read_b64_tr_b16 v[126:127], v135 offset:184
  v_mfma_f32_16x16x32_bf16 v[20:23], v[84:87], v[112:115], v[20:23]
  ds_read_b128 v[96:99], v133 offset:0
  ds_read_b128 v[100:103], v133 offset:2048
  v_mfma_f32_16x16x32_bf16 v[40:43], v[88:91], v[112:115], v[40:43]
  ds_read_b128 v[104:107], v133 offset:4096
  ds_read_b128 v[108:111], v133 offset:6144
  v_mfma_f32_16x16x32_bf16 v[60:63], v[92:95], v[112:115], v[60:63]
  s_waitcnt lgkmcnt(8)
  v_mfma_f32_16x16x32_bf16 v[4:7], v[80:83], v[116:119], v[4:7]
  ds_read_b64_tr_b16 v[128:129], v136 offset:0
  ds_read_b64_tr_b16 v[130:131], v137 offset:0
  s_lshl_b32 s82, s75, 8
  v_mfma_f32_16x16x32_bf16 v[24:27], v[84:87], v[116:119], v[24:27]
  s_add_u32 s82, s82, 139264
  v_mov_b32 v145, s76
  v_mov_b32 v146, s82
  v_mfma_f32_16x16x32_bf16 v[44:47], v[88:91], v[116:119], v[44:47]
  v_cndmask_b32 v145, v145, v146, s[84:85]
  s_and_b32 s75, s71, 15
  s_lshr_b32 s71, s71, 4
  v_mfma_f32_16x16x32_bf16 v[64:67], v[92:95], v[116:119], v[64:67]
  s_waitcnt lgkmcnt(8)
  v_mfma_f32_16x16x32_bf16 v[8:11], v[80:83], v[120:123], v[8:11]
  ds_read_b64_tr_b16 v[112:113], v134 offset:9216
  v_mfma_f32_16x16x32_bf16 v[28:31], v[84:87], v[120:123], v[28:31]
  ds_read_b64_tr_b16 v[114:115], v135 offset:9216
  v_mfma_f32_16x16x32_bf16 v[48:51], v[88:91], v[120:123], v[48:51]
  v_mfma_f32_16x16x32_bf16 v[68:71], v[92:95], v[120:123], v[68:71]
  s_waitcnt lgkmcnt(8)
  v_mfma_f32_16x16x32_bf16 v[12:15], v[80:83], v[124:127], v[12:15]
  ds_read_b64_tr_b16 v[116:117], v134 offset:9256
  v_mfma_f32_16x16x32_bf16 v[32:35], v[84:87], v[124:127], v[32:35]
  ds_read_b64_tr_b16 v[118:119], v135 offset:9256
  v_mfma_f32_16x16x32_bf16 v[52:55], v[88:91], v[124:127], v[52:55]
  v_mfma_f32_16x16x32_bf16 v[72:75], v[92:95], v[124:127], v[72:75]
  s_waitcnt lgkmcnt(4)
  v_mfma_f32_16x16x32_bf16 v[16:19], v[80:83], v[128:131], v[16:19]
  ds_read_b64_tr_b16 v[120:121], v134 offset:9360
  v_mfma_f32_16x16x32_bf16 v[36:39], v[84:87], v[128:131], v[36:39]
  ds_read_b64_tr_b16 v[122:123], v135 offset:9360
  v_mfma_f32_16x16x32_bf16 v[56:59], v[88:91], v[128:131], v[56:59]
  v_mfma_f32_16x16x32_bf16 v[76:79], v[92:95], v[128:131], v[76:79]
  s_waitcnt lgkmcnt(4)
  v_mfma_f32_16x16x32_bf16 v[0:3], v[96:99], v[112:115], v[0:3]
  ds_read_b64_tr_b16 v[124:125], v134 offset:9400
  v_mfma_f32_16x16x32_bf16 v[20:23], v[100:103], v[112:115], v[20:23]
  ds_read_b64_tr_b16 v[126:127], v135 offset:9400
  v_mfma_f32_16x16x32_bf16 v[40:43], v[104:107], v[112:115], v[40:43]
  v_mfma_f32_16x16x32_bf16 v[60:63], v[108:111], v[112:115], v[60:63]
  s_waitcnt lgkmcnt(4)
  v_mfma_f32_16x16x32_bf16 v[4:7], v[96:99], v[116:119], v[4:7]
  v_add_u32 v132, s76, v138
  v_add_u32 v133, s76, v139
  v_mfma_f32_16x16x32_bf16 v[24:27], v[100:103], v[116:119], v[24:27]
  ds_read_b128 v[80:83], v132 offset:0
  ds_read_b128 v[84:87], v132 offset:2048
  ds_read_b128 v[88:91], v132 offset:4096
  v_mfma_f32_16x16x32_bf16 v[44:47], v[104:107], v[116:119], v[44:47]
  ds_read_b128 v[92:95], v132 offset:6144
  ds_read_b64_tr_b16 v[128:129], v136 offset:9216
  ds_read_b64_tr_b16 v[130:131], v137 offset:9216
  v_mfma_f32_16x16x32_bf16 v[64:67], v[108:111], v[116:119], v[64:67]
  s_waitcnt lgkmcnt(8)
  v_mfma_f32_16x16x32_bf16 v[8:11], v[96:99], v[120:123], v[8:11]
  v_add_u32 v134, s76, v140
  v_add_u32 v135, s76, v141
  v_mfma_f32_16x16x32_bf16 v[28:31], v[100:103], v[120:123], v[28:31]
  ds_read_b64_tr_b16 v[112:113], v134 offset:0
  ds_read_b64_tr_b16 v[114:115], v135 offset:0
  v_mfma_f32_16x16x32_bf16 v[48:51], v[104:107], v[120:123], v[48:51]
  v_add_u32 v136, v145, v142
  v_add_u32 v137, v145, v143
  v_mfma_f32_16x16x32_bf16 v[68:71], v[108:111], v[120:123], v[68:71]
  s_waitcnt lgkmcnt(8)
  v_mfma_f32_16x16x32_bf16 v[12:15], v[96:99], v[124:127], v[12:15]
  ds_read_b64_tr_b16 v[116:117], v134 offset:40
  ds_read_b64_tr_b16 v[118:119], v135 offset:40
  v_mfma_f32_16x16x32_bf16 v[32:35], v[100:103], v[124:127], v[32:35]
  s_add_u32 s76, s76, 34816
  s_cmp_eq_u32 s76, 139264
  v_mfma_f32_16x16x32_bf16 v[52:55], v[104:107], v[124:127], v[52:55]
  s_cselect_b32 s76, 0, s76
  v_mfma_f32_16x16x32_bf16 v[72:75], v[108:111], v[124:127], v[72:75]
  s_waitcnt lgkmcnt(4)
  v_mfma_f32_16x16x32_bf16 v[16:19], v[96:99], v[128:131], v[16:19]
  ds_read_b64_tr_b16 v[120:121], v134 offset:144
  v_mfma_f32_16x16x32_bf16 v[36:39], v[100:103], v[128:131], v[36:39]
  ds_read_b64_tr_b16 v[122:123], v135 offset:144
  v_mfma_f32_16x16x32_bf16 v[56:59], v[104:107], v[128:131], v[56:59]
  v_mfma_f32_16x16x32_bf16 v[76:79], v[108:111], v[128:131], v[76:79]
  s_setprio 2
  s_waitcnt lgkmcnt(0)
  v_mov_b32 v147, 0x3f803f80
  v_mov_b32 v148, 1
  v_pk_fma_f32 v[192:193], v[0:1], s[72:73], s[72:73] op_sel:[0,1,1] op_sel_hi:[1,1,1] neg_lo:[0,0,1] neg_hi:[0,0,1]
  v_pk_fma_f32 v[194:195], v[2:3], s[72:73], s[72:73] op_sel:[0,1,1] op_sel_hi:[1,1,1] neg_lo:[0,0,1] neg_hi:[0,0,1]
  v_pk_fma_f32 v[196:197], v[20:21], s[72:73], s[72:73] op_sel:[0,1,1] op_sel_hi:[1,1,1] neg_lo:[0,0,1] neg_hi:[0,0,1]
  v_pk_fma_f32 v[198:199], v[22:23], s[72:73], s[72:73] op_sel:[0,1,1] op_sel_hi:[1,1,1] neg_lo:[0,0,1] neg_hi:[0,0,1]
  v_exp_f32 v192, v192 clamp
  v_exp_f32 v193, v193 clamp
  v_exp_f32 v194, v194 clamp
  v_exp_f32 v195, v195 clamp
  v_exp_f32 v196, v196 clamp
  v_exp_f32 v197, v197 clamp
  v_exp_f32 v198, v198 clamp
  v_exp_f32 v199, v199 clamp
  v_max_f32 v192, v0, v192
  v_max_f32 v193, v1, v193
  v_max_f32 v194, v2, v194
  v_max_f32 v195, v3, v195
  v_max_f32 v196, v20, v196
  v_max_f32 v197, v21, v197
  v_max_f32 v198, v22, v198
  v_max_f32 v199, v23, v199
  v_pk_add_f32 v[192:193], v[192:193], s[74:75] op_sel:[0,0] op_sel_hi:[1,0]
  v_pk_add_f32 v[194:195], v[194:195], s[74:75] op_sel:[0,0] op_sel_hi:[1,0]
  v_pk_add_f32 v[196:197], v[196:197], s[74:75] op_sel:[0,0] op_sel_hi:[1,0]
  v_pk_add_f32 v[198:199], v[198:199], s[74:75] op_sel:[0,0] op_sel_hi:[1,0]
  v_cvt_pk_bf16_f32 v152, v192, v193
  v_cvt_pk_bf16_f32 v153, v194, v195
  v_cvt_pk_bf16_f32 v154, v196, v197
  v_cvt_pk_bf16_f32 v155, v198, v199
  s_cmp_lg_u32 s68, 0
  s_cbranch_scc1 L_nog_53
  s_mov_b32 exec_lo, 0x01000100
  s_mov_b32 exec_hi, 0x01000100
  buffer_store_dwordx4 v[16:19], v251, s[52:55], 0 offen offset:0 sc0 sc1
  buffer_store_dwordx4 v[36:39], v251, s[52:55], 0 offen offset:64 sc0 sc1
  buffer_store_dwordx4 v[56:59], v251, s[52:55], 0 offen offset:128 sc0 sc1
  buffer_store_dwordx4 v[76:79], v251, s[52:55], 0 offen offset:192 sc0 sc1
  s_mov_b64 exec, -1
L_nog_53:
  v_cvt_pk_bf16_f32 v184, v8, v9
  v_cvt_pk_bf16_f32 v185, v10, v11
  v_cvt_pk_bf16_f32 v186, v28, v29
  v_cvt_pk_bf16_f32 v187, v30, v31
  v_cvt_pk_bf16_f32 v188, v48, v49
  v_cvt_pk_bf16_f32 v189, v50, v51
  v_cvt_pk_bf16_f32 v190, v68, v69
  v_cvt_pk_bf16_f32 v191, v70, v71
  v_cvt_pk_bf16_f32 v176, v16, v17
  v_cvt_pk_bf16_f32 v177, v18, v19
  v_cvt_pk_bf16_f32 v178, v36, v37
  v_cvt_pk_bf16_f32 v179, v38, v39
  v_cvt_pk_bf16_f32 v180, v56, v57
  v_cvt_pk_bf16_f32 v181, v58, v59
  v_cvt_pk_bf16_f32 v182, v76, v77
  v_cvt_pk_bf16_f32 v183, v78, v79
  v_cndmask_b32 v176, v176, v147, vcc
  v_cndmask_b32 v177, v177, v147, vcc
  v_cndmask_b32 v178, v178, v147, vcc
  v_cndmask_b32 v179, v179, v147, vcc
  v_cndmask_b32 v180, v180, v147, vcc
  v_cndmask_b32 v181, v181, v147, vcc
  v_cndmask_b32 v182, v182, v147, vcc
  v_cndmask_b32 v183, v183, v147, vcc
  v_pk_fma_f32 v[200:201], v[40:41], s[72:73], s[72:73] op_sel:[0,1,1] op_sel_hi:[1,1,1] neg_lo:[0,0,1] neg_hi:[0,0,1]
  v_pk_fma_f32 v[202:203], v[42:43], s[72:73], s[72:73] op_sel:[0,1,1] op_sel_hi:[1,1,1] neg_lo:[0,0,1] neg_hi:[0,0,1]
  v_pk_fma_f32 v[204:205], v[60:61], s[72:73], s[72:73] op_sel:[0,1,1] op_sel_hi:[1,1,1] neg_lo:[0,0,1] neg_hi:[0,0,1]
  v_pk_fma_f32 v[206:207], v[62:63], s[72:73], s[72:73] op_sel:[0,1,1] op_sel_hi:[1,1,1] neg_lo:[0,0,1] neg_hi:[0,0,1]
  v_mfma_f32_16x16x32_bf16 v[216:219], v[152:155], v[184:187], 0
  v_exp_f32 v200, v200 clamp
  v_mfma_f32_16x16x32_bf16 v[224:227], v[152:155], v[176:179], 0
  v_exp_f32 v201, v201 clamp
  v_exp_f32 v202, v202 clamp
  v_exp_f32 v203, v203 clamp
  v_exp_f32 v204, v204 clamp
  v_exp_f32 v205, v205 clamp
  v_exp_f32 v206, v206 clamp
  v_exp_f32 v207, v207 clamp
  v_max_f32 v200, v40, v200
  v_max_f32 v201, v41, v201
  v_max_f32 v202, v42, v202
  v_max_f32 v203, v43, v203
  v_max_f32 v204, v60, v204
  v_max_f32 v205, v61, v205
  v_max_f32 v206, v62, v206
  v_max_f32 v207, v63, v207
  v_pk_add_f32 v[200:201], v[200:201], s[74:75] op_sel:[0,0] op_sel_hi:[1,0]
  v_pk_add_f32 v[202:203], v[202:203], s[74:75] op_sel:[0,0] op_sel_hi:[1,0]
  v_pk_add_f32 v[204:205], v[204:205], s[74:75] op_sel:[0,0] op_sel_hi:[1,0]
  v_pk_add_f32 v[206:207], v[206:207], s[74:75] op_sel:[0,0] op_sel_hi:[1,0]
  v_cvt_pk_bf16_f32 v156, v200, v201
  v_cvt_pk_bf16_f32 v157, v202, v203
  v_cvt_pk_bf16_f32 v158, v204, v205
  v_cvt_pk_bf16_f32 v159, v206, v207
  v_pk_fma_f32 v[192:193], v[4:5], s[72:73], s[72:73] op_sel:[0,1,1] op_sel_hi:[1,1,1] neg_lo:[0,0,1] neg_hi:[0,0,1]
  v_pk_fma_f32 v[194:195], v[6:7], s[72:73], s[72:73] op_sel:[0,1,1] op_sel_hi:[1,1,1] neg_lo:[0,0,1] neg_hi:[0,0,1]
  v_pk_fma_f32 v[196:197], v[24:25], s[72:73], s[72:73] op_sel:[0,1,1] op_sel_hi:[1,1,1] neg_lo:[0,0,1] neg_hi:[0,0,1]
  v_pk_fma_f32 v[198:199], v[26:27], s[72:73], s[72:73] op_sel:[0,1,1] op_sel_hi:[1,1,1] neg_lo:[0,0,1] neg_hi:[0,0,1]
  v_mfma_f32_16x16x32_bf16 v[216:219], v[156:159], v[188:191], v[216:219]
  v_exp_f32 v192, v192 clamp
  v_mfma_f32_16x16x32_bf16 v[224:227], v[156:159], v[180:183], v[224:227]
  v_exp_f32 v193, v193 clamp
  v_exp_f32 v194, v194 clamp
  v_exp_f32 v195, v195 clamp
  v_exp_f32 v196, v196 clamp
  v_exp_f32 v197, v197 clamp
  v_exp_f32 v198, v198 clamp
  v_exp_f32 v199, v199 clamp
  v_max_f32 v192, v4, v192
  v_max_f32 v193, v5, v193
  v_max_f32 v194, v6, v194
  v_max_f32 v195, v7, v195
  v_max_f32 v196, v24, v196
  v_max_f32 v197, v25, v197
  v_max_f32 v198, v26, v198
  v_max_f32 v199, v27, v199
  v_pk_add_f32 v[192:193], v[192:193], s[74:75] op_sel:[0,0] op_sel_hi:[1,0]
  v_pk_add_f32 v[194:195], v[194:195], s[74:75] op_sel:[0,0] op_sel_hi:[1,0]
  v_pk_add_f32 v[196:197], v[196:197], s[74:75] op_sel:[0,0] op_sel_hi:[1,0]
  v_pk_add_f32 v[198:199], v[198:199], s[74:75] op_sel:[0,0] op_sel_hi:[1,0]
  v_cvt_pk_bf16_f32 v160, v192, v193
  v_cvt_pk_bf16_f32 v161, v194, v195
  v_cvt_pk_bf16_f32 v162, v196, v197
  v_cvt_pk_bf16_f32 v163, v198, v199
  v_cvt_pk_bf16_f32 v208, v12, v13
  v_cvt_pk_bf16_f32 v209, v14, v15
  v_cvt_pk_bf16_f32 v210, v32, v33
  v_cvt_pk_bf16_f32 v211, v34, v35
  v_cvt_pk_bf16_f32 v212, v52, v53
  v_cvt_pk_bf16_f32 v213, v54, v55
  v_cvt_pk_bf16_f32 v214, v72, v73
  v_cvt_pk_bf16_f32 v215, v74, v75
  v_pk_fma_f32 v[200:201], v[44:45], s[72:73], s[72:73] op_sel:[0,1,1] op_sel_hi:[1,1,1] neg_lo:[0,0,1] neg_hi:[0,0,1]
  v_pk_fma_f32 v[202:203], v[46:47], s[72:73], s[72:73] op_sel:[0,1,1] op_sel_hi:[1,1,1] neg_lo:[0,0,1] neg_hi:[0,0,1]
  v_pk_fma_f32 v[204:205], v[64:65], s[72:73], s[72:73] op_sel:[0,1,1] op_sel_hi:[1,1,1] neg_lo:[0,0,1] neg_hi:[0,0,1]
  v_pk_fma_f32 v[206:207], v[66:67], s[72:73], s[72:73] op_sel:[0,1,1] op_sel_hi:[1,1,1] neg_lo:[0,0,1] neg_hi:[0,0,1]
  v_mfma_f32_16x16x32_bf16 v[220:223], v[160:163], v[208:211], 0
  v_exp_f32 v200, v200 clamp
  v_mfma_f32_16x16x32_bf16 v[228:231], v[160:163], v[176:179], 0
  v_exp_f32 v201, v201 clamp
  v_exp_f32 v202, v202 clamp
  v_exp_f32 v203, v203 clamp
  v_exp_f32 v204, v204 clamp
  v_exp_f32 v205, v205 clamp
  v_exp_f32 v206, v206 clamp
  v_exp_f32 v207, v207 clamp
  v_max_f32 v200, v44, v200
  v_max_f32 v201, v45, v201
  v_max_f32 v202, v46, v202
  v_max_f32 v203, v47, v203
  v_max_f32 v204, v64, v204
  v_max_f32 v205, v65, v205
  v_max_f32 v206, v66, v206
  v_max_f32 v207, v67, v207
  v_pk_add_f32 v[200:201], v[200:201], s[74:75] op_sel:[0,0] op_sel_hi:[1,0]
  v_pk_add_f32 v[202:203], v[202:203], s[74:75] op_sel:[0,0] op_sel_hi:[1,0]
  v_pk_add_f32 v[204:205], v[204:205], s[74:75] op_sel:[0,0] op_sel_hi:[1,0]
  v_pk_add_f32 v[206:207], v[206:207], s[74:75] op_sel:[0,0] op_sel_hi:[1,0]
  v_cvt_pk_bf16_f32 v164, v200, v201
  v_cvt_pk_bf16_f32 v165, v202, v203
  v_cvt_pk_bf16_f32 v166, v204, v205
  v_cvt_pk_bf16_f32 v167, v206, v207
  v_pk_fma_f32 v[192:193], v[16:17], s[72:73], s[72:73] op_sel:[0,1,1] op_sel_hi:[1,1,1] neg_lo:[0,0,1] neg_hi:[0,0,1]
  v_pk_fma_f32 v[194:195], v[18:19], s[72:73], s[72:73] op_sel:[0,1,1] op_sel_hi:[1,1,1] neg_lo:[0,0,1] neg_hi:[0,0,1]
  v_pk_fma_f32 v[196:197], v[36:37], s[72:73], s[72:73] op_sel:[0,1,1] op_sel_hi:[1,1,1] neg_lo:[0,0,1] neg_hi:[0,0,1]
  v_pk_fma_f32 v[198:199], v[38:39], s[72:73], s[72:73] op_sel:[0,1,1] op_sel_hi:[1,1,1] neg_lo:[0,0,1] neg_hi:[0,0,1]
  v_mfma_f32_16x16x32_bf16 v[220:223], v[164:167], v[212:215], v[220:223]
  v_exp_f32 v192, v192 clamp
  v_mfma_f32_16x16x32_bf16 v[228:231], v[164:167], v[180:183], v[228:231]
  v_exp_f32 v193, v193 clamp
  v_exp_f32 v194, v194 clamp
  v_exp_f32 v195, v195 clamp
  v_exp_f32 v196, v196 clamp
  v_exp_f32 v197, v197 clamp
  v_exp_f32 v198, v198 clamp
  v_exp_f32 v199, v199 clamp
  v_max_f32 v192, v16, v192
  v_max_f32 v193, v17, v193
  v_max_f32 v194, v18, v194
  v_max_f32 v195, v19, v195
  v_max_f32 v196, v36, v196
  v_max_f32 v197, v37, v197
  v_max_f32 v198, v38, v198
  v_max_f32 v199, v39, v199
  v_pk_add_f32 v[192:193], v[192:193], s[74:75] op_sel:[0,0] op_sel_hi:[1,0]
  v_pk_add_f32 v[194:195], v[194:195], s[74:75] op_sel:[0,0] op_sel_hi:[1,0]
  v_pk_add_f32 v[196:197], v[196:197], s[74:75] op_sel:[0,0] op_sel_hi:[1,0]
  v_pk_add_f32 v[198:199], v[198:199], s[74:75] op_sel:[0,0] op_sel_hi:[1,0]
  v_cvt_pk_bf16_f32 v168, v192, v193
  v_cvt_pk_bf16_f32 v169, v194, v195
  v_cvt_pk_bf16_f32 v170, v196, v197
  v_cvt_pk_bf16_f32 v171, v198, v199
  v_pk_fma_f32 v[200:201], v[56:57], s[72:73], s[72:73] op_sel:[0,1,1] op_sel_hi:[1,1,1] neg_lo:[0,0,1] neg_hi:[0,0,1]
  v_pk_fma_f32 v[202:203], v[58:59], s[72:73], s[72:73] op_sel:[0,1,1] op_sel_hi:[1,1,1] neg_lo:[0,0,1] neg_hi:[0,0,1]
  v_pk_fma_f32 v[204:205], v[76:77], s[72:73], s[72:73] op_sel:[0,1,1] op_sel_hi:[1,1,1] neg_lo:[0,0,1] neg_hi:[0,0,1]
  v_pk_fma_f32 v[206:207], v[78:79], s[72:73], s[72:73] op_sel:[0,1,1] op_sel_hi:[1,1,1] neg_lo:[0,0,1] neg_hi:[0,0,1]
  v_mfma_f32_16x16x32_bf16 v[240:243], v[168:171], v[176:179], 0
  v_exp_f32 v200, v200 clamp
  v_mfma_f32_16x16x32_bf16 v[232:235], v[168:171], v[184:187], 0
  v_exp_f32 v201, v201 clamp
  v_mfma_f32_16x16x32_bf16 v[236:239], v[168:171], v[208:211], 0
  v_exp_f32 v202, v202 clamp
  v_exp_f32 v203, v203 clamp
  v_exp_f32 v204, v204 clamp
  v_exp_f32 v205, v205 clamp
  v_exp_f32 v206, v206 clamp
  v_exp_f32 v207, v207 clamp
  v_max_f32 v200, v56, v200
  v_max_f32 v201, v57, v201
  v_max_f32 v202, v58, v202
  v_max_f32 v203, v59, v203
  v_max_f32 v204, v76, v204
  v_max_f32 v205, v77, v205
  v_max_f32 v206, v78, v206
  v_max_f32 v207, v79, v207
  v_pk_add_f32 v[200:201], v[200:201], s[74:75] op_sel:[0,0] op_sel_hi:[1,0]
  v_pk_add_f32 v[202:203], v[202:203], s[74:75] op_sel:[0,0] op_sel_hi:[1,0]
  v_pk_add_f32 v[204:205], v[204:205], s[74:75] op_sel:[0,0] op_sel_hi:[1,0]
  v_pk_add_f32 v[206:207], v[206:207], s[74:75] op_sel:[0,0] op_sel_hi:[1,0]
  v_cvt_pk_bf16_f32 v172, v200, v201
  v_cvt_pk_bf16_f32 v173, v202, v203
  v_cvt_pk_bf16_f32 v174, v204, v205
  v_cvt_pk_bf16_f32 v175, v206, v207
  s_nop 1
  v_mfma_f32_16x16x32_bf16 v[240:243], v[172:175], v[180:183], v[240:243]
  v_mfma_f32_16x16x32_bf16 v[232:235], v[172:175], v[188:191], v[232:235]
  v_mfma_f32_16x16x32_bf16 v[236:239], v[172:175], v[212:215], v[236:239]
  ds_write_b128 v245, v[216:219] offset:0
  s_mov_b32 exec_lo, 0x310031
  s_mov_b32 exec_hi, 0x310031
  ds_write_b128 v246, v[224:227] offset:4096
  s_mov_b64 exec, -1
  ds_write_b128 v245, v[220:223] offset:1024
  s_mov_b32 exec_lo, 0xc200c2
  s_mov_b32 exec_hi, 0xc200c2
  ds_write_b128 v246, v[228:231] offset:4096
  s_mov_b64 exec, -1
  s_mov_b32 exec_hi, 0
  s_mov_b32 exec_lo, 0x31
  ds_write_b64 v248, v[240:241] offset:5376
  s_mov_b32 exec_lo, 0xc2
  ds_write_b64 v248, v[242:243] offset:5376
  s_mov_b32 exec_lo, 0xffff
  ds_write_b64 v247, v[232:233] offset:4864
  ds_write_b64 v247, v[238:239] offset:4872
  s_mov_b32 exec_lo, 1
  ds_add_u32 v252, v148
  s_mov_b64 exec, -1
  s_mov_b32 s77, 0
L_e2_54:
  ds_read2_b32 v[192:193], v252 offset0:0 offset1:3
  s_add_u32 s77, s77, 1
  s_cmp_gt_u32 s77, 8192
  s_cbranch_scc1 L_e2e_55
  s_waitcnt lgkmcnt(0)
  v_and_b32 v192, v192, v193
  s_nop 0
  v_readfirstlane_b32 s70, v192
  s_cmp_lg_u32 s70, 4
  s_cbranch_scc1 L_e2_54
L_e2e_55:
  ds_read2st64_b32 v[80:81], v250 offset0:0 offset1:24
  ds_read2st64_b32 v[82:83], v250 offset0:4 offset1:28
  ds_read2st64_b32 v[84:85], v250 offset0:8 offset1:32
  ds_read2st64_b32 v[86:87], v250 offset0:12 offset1:36
  ds_read2st64_b32 v[88:89], v250 offset0:16 offset1:40
  ds_read2st64_b32 v[90:91], v250 offset0:20 offset1:44
  s_waitcnt lgkmcnt(5)
  v_add_f32 v80, v80, v81
  buffer_atomic_add_f32 v80, v249, s[52:55], s78 offen offset:0 sc1
  s_waitcnt lgkmcnt(4)
  v_add_f32 v82, v82, v83
  buffer_atomic_add_f32 v82, v249, s[52:55], s78 offen offset:1024 sc1
  s_waitcnt lgkmcnt(3)
  v_add_f32 v84, v84, v85
  buffer_atomic_add_f32 v84, v249, s[52:55], s78 offen offset:2048 sc1
  s_waitcnt lgkmcnt(2)
  v_add_f32 v86, v86, v87
  buffer_atomic_add_f32 v86, v249, s[52:55], s78 offen offset:3072 sc1
  s_waitcnt lgkmcnt(1)
  v_add_f32 v88, v88, v89
  buffer_atomic_add_f32 v88, v249, s[52:55], s79 offen offset:0 sc1
  s_waitcnt lgkmcnt(0)
  v_add_f32 v90, v90, v91
  buffer_atomic_add_f32 v90, v249, s[52:55], s79 offen offset:1024 sc1
  s_nop 1
  s_branch L_p2
.p2align 3
L1_q_c:
  s_waitcnt lgkmcnt(0)
  s_mov_b32 s52, s42
  s_and_b32 s53, s43, 0xffff
  s_mov_b32 s54, 9764864
  s_mov_b32 s55, 0x20000
  s_mov_b32 s56, s40
  s_and_b32 s57, s41, 0xffff
  s_mov_b32 s58, 256
  s_mov_b32 s59, 0x20000
  s_mov_b32 s74, 0x358637bd
  v_mov_b32 v164, v0
  s_lshr_b32 s67, s64, 1
  s_and_b32 s68, s64, 1
  v_and_b32 v165, 15, v164
  v_lshrrev_b32 v166, 4, v164
  v_bfe_u32 v167, v164, 2, 2
  v_and_b32 v168, 3, v164
  s_lshl_b32 s69, s67, 13
  v_lshrrev_b32 v158, 1, v165
  v_xor_b32 v158, v158, v166
  v_lshlrev_b32 v158, 4, v158
  v_lshl_add_u32 v158, v165, 7, v158
  v_add_u32 v158, s69, v158
  s_lshl_b32 s69, s66, 1
  s_add_u32 s69, s69, s68
  s_cmp_ge_u32 s69, 3
  s_cselect_b32 s69, 2048, 0
  v_add_u32 v158, s69, v158
  v_mov_b32 v171, 0
  v_mov_b32 v172, 0
  v_xor_b32 v159, 64, v158
  v_lshl_add_u32 v165, v166, 3, v167
  v_mul_u32_u24 v165, 384, v165
  v_lshl_add_u32 v165, v168, 3, v165
  v_add_u32 v165, 16384, v165
  v_lshrrev_b32 v167, 1, v167
  v_and_b32 v166, 1, v166
  v_lshl_add_u32 v166, v166, 1, v167
  s_mul_i32 s69, s68, 6
  s_add_u32 s70, s69, 0
  s_and_b32 s77, s70, 3
  s_lshr_b32 s70, s70, 2
  s_lshl_b32 s70, s70, 7
  v_xor_b32 v167, s77, v166
  v_lshl_add_u32 v160, v167, 5, v165
  v_add_u32 v160, s70, v160
  s_add_u32 s70, s69, 1
  s_and_b32 s77, s70, 3
  s_lshr_b32 s70, s70, 2
  s_lshl_b32 s70, s70, 7
  v_xor_b32 v167, s77, v166
  v_lshl_add_u32 v161, v167, 5, v165
  v_add_u32 v161, s70, v161
  s_add_u32 s70, s69, 2
  s_and_b32 s77, s70, 3
  s_lshr_b32 s70, s70, 2
  s_lshl_b32 s70, s70, 7
  v_xor_b32 v167, s77, v166
  v_lshl_add_u32 v162, v167, 5, v165
  v_add_u32 v162, s70, v162
  s_add_u32 s70, s69, 3
  s_and_b32 s77, s70, 3
  s_lshr_b32 s70, s70, 2
  s_lshl_b32 s70, s70, 7
  v_xor_b32 v167, s77, v166
  v_lshl_add_u32 v163, v167, 5, v165
  v_add_u32 v163, s70, v163
  s_mul_i32 s69, s66, 48
  s_mul_i32 s70, s68, 24
  s_add_u32 s69, s69, s70
  s_add_u32 s69, s69, 0
  v_lshrrev_b32 v165, 4, v164
  v_add_u32 v165, s69, v165
  v_mul_u32_u24 v166, 7282, v165
  v_lshrrev_b32 v166, 16, v166
  v_mul_u32_u24 v167, 9, v166
  v_sub_u32 v167, v165, v167
  v_lshrrev_b32 v165, 1, v166
  v_mul_u32_u24 v165, 4608, v165
  v_and_b32 v166, 1, v166
  v_cmp_lt_u32 vcc, 4, v167
  v_lshl_add_u32 v173, v166, 3, v167
  v_add_u32 v168, 16, v166
  v_subbrev_co_u32 v173, vcc, 0, v173, vcc
  v_cmp_eq_u32 vcc, 4, v167
  v_and_b32 v167, 15, v164
  v_lshl_add_u32 v165, v167, 4, v165
  v_cndmask_b32 v173, v173, v168, vcc
  v_lshl_add_u32 v173, v173, 8, v165
  s_mul_i32 s69, s66, 48
  s_mul_i32 s70, s68, 24
  s_add_u32 s69, s69, s70
  s_add_u32 s69, s69, 4
  v_lshrrev_b32 v165, 4, v164
  v_add_u32 v165, s69, v165
  v_mul_u32_u24 v166, 7282, v165
  v_lshrrev_b32 v166, 16, v166
  v_mul_u32_u24 v167, 9, v166
  v_sub_u32 v167, v165, v167
  v_lshrrev_b32 v165, 1, v166
  v_mul_u32_u24 v165, 4608, v165
  v_and_b32 v166, 1, v166
  v_cmp_lt_u32 vcc, 4, v167
  v_lshl_add_u32 v174, v166, 3, v167
  v_add_u32 v168, 16, v166
  v_subbrev_co_u32 v174, vcc, 0, v174, vcc
  v_cmp_eq_u32 vcc, 4, v167
  v_and_b32 v167, 15, v164
  v_lshl_add_u32 v165, v167, 4, v165
  v_cndmask_b32 v174, v174, v168, vcc
  v_lshl_add_u32 v174, v174, 8, v165
  s_mul_i32 s69, s66, 48
  s_mul_i32 s70, s68, 24
  s_add_u32 s69, s69, s70
  s_add_u32 s69, s69, 8
  v_lshrrev_b32 v165, 4, v164
  v_add_u32 v165, s69, v165
  v_mul_u32_u24 v166, 7282, v165
  v_lshrrev_b32 v166, 16, v166
  v_mul_u32_u24 v167, 9, v166
  v_sub_u32 v167, v165, v167
  v_lshrrev_b32 v165, 1, v166
  v_mul_u32_u24 v165, 4608, v165
  v_and_b32 v166, 1, v166
  v_cmp_lt_u32 vcc, 4, v167
  v_lshl_add_u32 v175, v166, 3, v167
  v_add_u32 v168, 16, v166
  v_subbrev_co_u32 v175, vcc, 0, v175, vcc
  v_cmp_eq_u32 vcc, 4, v167
  v_and_b32 v167, 15, v164
  v_lshl_add_u32 v165, v167, 4, v165
  v_cndmask_b32 v175, v175, v168, vcc
  v_lshl_add_u32 v175, v175, 8, v165
  s_mul_i32 s69, s66, 48
  s_mul_i32 s70, s68, 24
  s_add_u32 s69, s69, s70
  s_add_u32 s69, s69, 12
  v_lshrrev_b32 v165, 4, v164
  v_add_u32 v165, s69, v165
  v_mul_u32_u24 v166, 7282, v165
  v_lshrrev_b32 v166, 16, v166
  v_mul_u32_u24 v167, 9, v166
  v_sub_u32 v167, v165, v167
  v_lshrrev_b32 v165, 1, v166
  v_mul_u32_u24 v165, 4608, v165
  v_and_b32 v166, 1, v166
  v_cmp_lt_u32 vcc, 4, v167
  v_lshl_add_u32 v176, v166, 3, v167
  v_add_u32 v168, 16, v166
  v_subbrev_co_u32 v176, vcc, 0, v176, vcc
  v_cmp_eq_u32 vcc, 4, v167
  v_and_b32 v167, 15, v164
  v_lshl_add_u32 v165, v167, 4, v165
  v_cndmask_b32 v176, v176, v168, vcc
  v_lshl_add_u32 v176, v176, 8, v165
  s_mul_i32 s69, s66, 48
  s_mul_i32 s70, s68, 24
  s_add_u32 s69, s69, s70
  s_add_u32 s69, s69, 16
  v_lshrrev_b32 v165, 4, v164
  v_add_u32 v165, s69, v165
  v_mul_u32_u24 v166, 7282, v165
  v_lshrrev_b32 v166, 16, v166
  v_mul_u32_u24 v167, 9, v166
  v_sub_u32 v167, v165, v167
  v_lshrrev_b32 v165, 1, v166
  v_mul_u32_u24 v165, 4608, v165
  v_and_b32 v166, 1, v166
  v_cmp_lt_u32 vcc, 4, v167
  v_lshl_add_u32 v177, v166, 3, v167
  v_add_u32 v168, 16, v166
  v_subbrev_co_u32 v177, vcc, 0, v177, vcc
  v_cmp_eq_u32 vcc, 4, v167
  v_and_b32 v167, 15, v164
  v_lshl_add_u32 v165, v167, 4, v165
  v_cndmask_b32 v177, v177, v168, vcc
  v_lshl_add_u32 v177, v177, 8, v165
  s_mul_i32 s69, s66, 48
  s_mul_i32 s70, s68, 24
  s_add_u32 s69, s69, s70
  s_add_u32 s69, s69, 20
  v_lshrrev_b32 v165, 4, v164
  v_add_u32 v165, s69, v165
  v_mul_u32_u24 v166, 7282, v165
  v_lshrrev_b32 v166, 16, v166
  v_mul_u32_u24 v167, 9, v166
  v_sub_u32 v167, v165, v167
  v_lshrrev_b32 v165, 1, v166
  v_mul_u32_u24 v165, 4608, v165
  v_and_b32 v166, 1, v166
  v_cmp_lt_u32 vcc, 4, v167
  v_lshl_add_u32 v178, v166, 3, v167
  v_add_u32 v168, 16, v166
  v_subbrev_co_u32 v178, vcc, 0, v178, vcc
  v_cmp_eq_u32 vcc, 4, v167
  v_and_b32 v167, 15, v164
  v_lshl_add_u32 v165, v167, 4, v165
  v_cndmask_b32 v178, v178, v168, vcc
  v_lshl_add_u32 v178, v178, 8, v165
  s_mov_b32 s97, 1
  s_mov_b32 s96, 41024
  s_mov_b32 s101, 0
  s_mov_b32 s91, 0
  s_mov_b32 s98, 1
  s_mov_b32 s99, 0
  s_lshl_b32 s100, s65, 1
  s_add_u32 s100, s100, s67
  s_mul_i32 s100, s100, 6
  s_lshl_b32 s69, s66, 1
  s_add_u32 s100, s100, s69
  s_add_u32 s100, s100, s68
  s_lshl_b32 s100, s100, 8
  s_add_u32 s100, s100, 4882432
  v_mov_b32 v0, 1.0
  v_mov_b32 v1, 1.0
  v_mov_b32 v2, 1.0
  v_mov_b32 v3, 1.0
  v_mov_b32 v4, 1.0
  v_mov_b32 v5, 1.0
  v_mov_b32 v6, 1.0
  v_mov_b32 v7, 1.0
  v_mov_b32 v8, 1.0
  v_mov_b32 v9, 1.0
  v_mov_b32 v10, 1.0
  v_mov_b32 v11, 1.0
  v_mov_b32 v12, 1.0
  v_mov_b32 v13, 1.0
  v_mov_b32 v14, 1.0
  v_mov_b32 v15, 1.0
  v_mov_b32 v16, 1.0
  v_mov_b32 v17, 1.0
  v_mov_b32 v18, 1.0
  v_mov_b32 v19, 1.0
  v_mov_b32 v20, 1.0
  v_mov_b32 v21, 1.0
  v_mov_b32 v22, 1.0
  v_mov_b32 v23, 1.0
  v_mov_b32 v24, 1.0
  v_mov_b32 v25, 1.0
  v_mov_b32 v26, 1.0
  v_mov_b32 v27, 1.0
  v_mov_b32 v28, 1.0
  v_mov_b32 v29, 1.0
  v_mov_b32 v30, 1.0
  v_mov_b32 v31, 1.0
  v_mov_b32 v32, 1.0
  v_mov_b32 v33, 1.0
  v_mov_b32 v34, 1.0
  v_mov_b32 v35, 1.0
  v_mov_b32 v36, 1.0
  v_mov_b32 v37, 1.0
  v_mov_b32 v38, 1.0
  v_mov_b32 v39, 1.0
  v_mov_b32 v40, 1.0
  v_mov_b32 v41, 1.0
  v_mov_b32 v42, 1.0
  v_mov_b32 v43, 1.0
  v_mov_b32 v44, 1.0
  v_mov_b32 v45, 1.0
  v_mov_b32 v46, 1.0
  v_mov_b32 v47, 1.0
  v_mov_b32 v48, 1.0
  v_mov_b32 v49, 1.0
  v_mov_b32 v50, 1.0
  v_mov_b32 v51, 1.0
  v_mov_b32 v52, 1.0
  v_mov_b32 v53, 1.0
  v_mov_b32 v54, 1.0
  v_mov_b32 v55, 1.0
  v_mov_b32 v56, 1.0
  v_mov_b32 v57, 1.0
  v_mov_b32 v58, 1.0
  v_mov_b32 v59, 1.0
  v_mov_b32 v60, 1.0
  v_mov_b32 v61, 1.0
  v_mov_b32 v62, 1.0
  v_mov_b32 v63, 1.0
  v_mov_b32 v64, 1.0
  v_mov_b32 v65, 1.0
  v_mov_b32 v66, 1.0
  v_mov_b32 v67, 1.0
  v_mov_b32 v68, 1.0
  v_mov_b32 v69, 1.0
  v_mov_b32 v70, 1.0
  v_mov_b32 v71, 1.0
  v_mov_b32 v72, 1.0
  v_mov_b32 v73, 1.0
  v_mov_b32 v74, 1.0
  v_mov_b32 v75, 1.0
  v_mov_b32 v76, 1.0
  v_mov_b32 v77, 1.0
  v_mov_b32 v78, 1.0
  v_mov_b32 v79, 1.0
  v_mov_b32 v80, 1.0
  v_mov_b32 v81, 1.0
  v_mov_b32 v82, 1.0
  v_mov_b32 v83, 1.0
  v_mov_b32 v84, 1.0
  v_mov_b32 v85, 1.0
  v_mov_b32 v86, 1.0
  v_mov_b32 v87, 1.0
  v_mov_b32 v88, 1.0
  v_mov_b32 v89, 1.0
  v_mov_b32 v90, 1.0
  v_mov_b32 v91, 1.0
  v_mov_b32 v92, 1.0
  v_mov_b32 v93, 1.0
  v_mov_b32 v94, 1.0
  v_mov_b32 v95, 1.0
  s_mov_b32 s76, 0
  s_mov_b32 s77, 0
L_wr_q:
  s_barrier
  v_add_u32 v152, s76, v158
  v_add_u32 v153, s76, v159
  v_xor_b32 v169, 2048, v152
  v_xor_b32 v170, 2048, v153
  ds_read_b128 v[96:99], v152 offset:0
  ds_read_b128 v[100:103], v169 offset:0
  ds_read_b128 v[104:107], v152 offset:4096
  ds_read_b128 v[108:111], v169 offset:4096
  v_add_u32 v154, s76, v160
  v_add_u32 v155, s76, v161
  ds_read_b64_tr_b16 v[128:129], v154 offset:0
  ds_read_b64_tr_b16 v[130:131], v154 offset:1536
  v_add_u32 v156, s76, v162
  v_add_u32 v157, s76, v163
  ds_read_b64_tr_b16 v[132:133], v155 offset:0
  ds_read_b64_tr_b16 v[134:135], v155 offset:1536
  s_add_u32 s76, s76, 40960
  s_cmp_eq_u32 s76, 163840
  s_cselect_b32 s76, 0, s76
  ds_read_b64_tr_b16 v[136:137], v156 offset:0
  ds_read_b64_tr_b16 v[138:139], v156 offset:1536
.p2align 3
L_gl_56:
  s_waitcnt lgkmcnt(4)
  v_mfma_f32_16x16x32_bf16 v[0:3], v[128:131], v[96:99], v[0:3]
  ds_read_b64_tr_b16 v[140:141], v157 offset:0
  ds_read_b64_tr_b16 v[142:143], v157 offset:1536
  v_mfma_f32_16x16x32_bf16 v[24:27], v[128:131], v[100:103], v[24:27]
  ds_read_b128 v[112:115], v153 offset:0
  ds_read_b128 v[116:119], v170 offset:0
  v_mfma_f32_16x16x32_bf16 v[48:51], v[128:131], v[104:107], v[48:51]
  ds_read_b128 v[120:123], v153 offset:4096
  ds_read_b128 v[124:127], v170 offset:4096
  v_mfma_f32_16x16x32_bf16 v[72:75], v[128:131], v[108:111], v[72:75]
  s_waitcnt lgkmcnt(8)
  v_mfma_f32_16x16x32_bf16 v[4:7], v[132:135], v[96:99], v[4:7]
  ds_read_b64_tr_b16 v[144:145], v154 offset:128
  v_mfma_f32_16x16x32_bf16 v[28:31], v[132:135], v[100:103], v[28:31]
  ds_read_b64_tr_b16 v[146:147], v154 offset:1664
  v_mfma_f32_16x16x32_bf16 v[52:55], v[132:135], v[104:107], v[52:55]
  v_mfma_f32_16x16x32_bf16 v[76:79], v[132:135], v[108:111], v[76:79]
  s_waitcnt lgkmcnt(8)
  v_mfma_f32_16x16x32_bf16 v[8:11], v[136:139], v[96:99], v[8:11]
  ds_read_b64_tr_b16 v[148:149], v155 offset:128
  v_mfma_f32_16x16x32_bf16 v[32:35], v[136:139], v[100:103], v[32:35]
  ds_read_b64_tr_b16 v[150:151], v155 offset:1664
  v_mfma_f32_16x16x32_bf16 v[56:59], v[136:139], v[104:107], v[56:59]
  v_mfma_f32_16x16x32_bf16 v[80:83], v[136:139], v[108:111], v[80:83]
  s_waitcnt lgkmcnt(8)
  v_mfma_f32_16x16x32_bf16 v[12:15], v[140:143], v[96:99], v[12:15]
  ds_read_b64_tr_b16 v[128:129], v154 offset:12288
  v_mfma_f32_16x16x32_bf16 v[36:39], v[140:143], v[100:103], v[36:39]
  ds_read_b64_tr_b16 v[130:131], v154 offset:13824
  v_mfma_f32_16x16x32_bf16 v[60:63], v[140:143], v[104:107], v[60:63]
  v_mfma_f32_16x16x32_bf16 v[84:87], v[140:143], v[108:111], v[84:87]
  s_waitcnt lgkmcnt(4)
  v_mfma_f32_16x16x32_bf16 v[16:19], v[144:147], v[96:99], v[16:19]
  ds_read_b64_tr_b16 v[132:133], v155 offset:12288
  v_mfma_f32_16x16x32_bf16 v[40:43], v[144:147], v[100:103], v[40:43]
  ds_read_b64_tr_b16 v[134:135], v155 offset:13824
  v_mfma_f32_16x16x32_bf16 v[64:67], v[144:147], v[104:107], v[64:67]
  v_mfma_f32_16x16x32_bf16 v[88:91], v[144:147], v[108:111], v[88:91]
  s_waitcnt lgkmcnt(4)
  v_mfma_f32_16x16x32_bf16 v[20:23], v[148:151], v[96:99], v[20:23]
  ds_read_b64_tr_b16 v[136:137], v156 offset:12288
  v_mfma_f32_16x16x32_bf16 v[44:47], v[148:151], v[100:103], v[44:47]
  ds_read_b64_tr_b16 v[138:139], v156 offset:13824
  v_mfma_f32_16x16x32_bf16 v[68:71], v[148:151], v[104:107], v[68:71]
  v_mfma_f32_16x16x32_bf16 v[92:95], v[148:151], v[108:111], v[92:95]
  s_waitcnt lgkmcnt(4)
  v_mfma_f32_16x16x32_bf16 v[0:3], v[128:131], v[112:115], v[0:3]
  ds_read_b64_tr_b16 v[140:141], v157 offset:12288
  v_mfma_f32_16x16x32_bf16 v[24:27], v[128:131], v[116:119], v[24:27]
  ds_read_b64_tr_b16 v[142:143], v157 offset:13824
  v_mfma_f32_16x16x32_bf16 v[48:51], v[128:131], v[120:123], v[48:51]
  v_mfma_f32_16x16x32_bf16 v[72:75], v[128:131], v[124:127], v[72:75]
  s_waitcnt lgkmcnt(4)
  v_mfma_f32_16x16x32_bf16 v[4:7], v[132:135], v[112:115], v[4:7]
  s_barrier
  v_add_u32 v152, s76, v158
  v_add_u32 v153, s76, v159
  v_mfma_f32_16x16x32_bf16 v[28:31], v[132:135], v[116:119], v[28:31]
  v_xor_b32 v169, 2048, v152
  v_xor_b32 v170, 2048, v153
  ds_read_b128 v[96:99], v152 offset:0
  v_mfma_f32_16x16x32_bf16 v[52:55], v[132:135], v[120:123], v[52:55]
  ds_read_b128 v[100:103], v169 offset:0
  ds_read_b128 v[104:107], v152 offset:4096
  ds_read_b128 v[108:111], v169 offset:4096
  v_mfma_f32_16x16x32_bf16 v[76:79], v[132:135], v[124:127], v[76:79]
  ds_read_b64_tr_b16 v[144:145], v154 offset:12416
  ds_read_b64_tr_b16 v[146:147], v154 offset:13952
  s_waitcnt lgkmcnt(8)
  v_mfma_f32_16x16x32_bf16 v[8:11], v[136:139], v[112:115], v[8:11]
  ds_read_b64_tr_b16 v[148:149], v155 offset:12416
  v_mfma_f32_16x16x32_bf16 v[32:35], v[136:139], v[116:119], v[32:35]
  ds_read_b64_tr_b16 v[150:151], v155 offset:13952
  v_mfma_f32_16x16x32_bf16 v[56:59], v[136:139], v[120:123], v[56:59]
  v_mfma_f32_16x16x32_bf16 v[80:83], v[136:139], v[124:127], v[80:83]
  s_waitcnt lgkmcnt(8)
  v_mfma_f32_16x16x32_bf16 v[12:15], v[140:143], v[112:115], v[12:15]
  v_add_u32 v154, s76, v160
  v_add_u32 v155, s76, v161
  v_mfma_f32_16x16x32_bf16 v[36:39], v[140:143], v[116:119], v[36:39]
  ds_read_b64_tr_b16 v[128:129], v154 offset:0
  ds_read_b64_tr_b16 v[130:131], v154 offset:1536
  v_mfma_f32_16x16x32_bf16 v[60:63], v[140:143], v[120:123], v[60:63]
  v_add_u32 v156, s76, v162
  v_add_u32 v157, s76, v163
  v_mfma_f32_16x16x32_bf16 v[84:87], v[140:143], v[124:127], v[84:87]
  s_waitcnt lgkmcnt(4)
  v_mfma_f32_16x16x32_bf16 v[16:19], v[144:147], v[112:115], v[16:19]
  ds_read_b64_tr_b16 v[132:133], v155 offset:0
  ds_read_b64_tr_b16 v[134:135], v155 offset:1536
  v_mfma_f32_16x16x32_bf16 v[40:43], v[144:147], v[116:119], v[40:43]
  s_add_u32 s76, s76, 40960
  s_cmp_eq_u32 s76, 163840
  v_mfma_f32_16x16x32_bf16 v[64:67], v[144:147], v[120:123], v[64:67]
  s_cselect_b32 s76, 0, s76
  v_mfma_f32_16x16x32_bf16 v[88:91], v[144:147], v[124:127], v[88:91]
  s_waitcnt lgkmcnt(4)
  v_mfma_f32_16x16x32_bf16 v[20:23], v[148:151], v[112:115], v[20:23]
  ds_read_b64_tr_b16 v[136:137], v156 offset:0
  v_mfma_f32_16x16x32_bf16 v[44:47], v[148:151], v[116:119], v[44:47]
  ds_read_b64_tr_b16 v[138:139], v156 offset:1536
  v_mfma_f32_16x16x32_bf16 v[68:71], v[148:151], v[120:123], v[68:71]
  v_mfma_f32_16x16x32_bf16 v[92:95], v[148:151], v[124:127], v[92:95]
  s_waitcnt lgkmcnt(4)
  v_mfma_f32_16x16x32_bf16 v[0:3], v[128:131], v[96:99], v[0:3]
  ds_read_b64_tr_b16 v[140:141], v157 offset:0
  ds_read_b64_tr_b16 v[142:143], v157 offset:1536
  v_mfma_f32_16x16x32_bf16 v[24:27], v[128:131], v[100:103], v[24:27]
  ds_read_b128 v[112:115], v153 offset:0
  ds_read_b128 v[116:119], v170 offset:0
  v_mfma_f32_16x16x32_bf16 v[48:51], v[128:131], v[104:107], v[48:51]
  ds_read_b128 v[120:123], v153 offset:4096
  ds_read_b128 v[124:127], v170 offset:4096
  v_mfma_f32_16x16x32_bf16 v[72:75], v[128:131], v[108:111], v[72:75]
  s_waitcnt lgkmcnt(8)
  v_mfma_f32_16x16x32_bf16 v[4:7], v[132:135], v[96:99], v[4:7]
  ds_read_b64_tr_b16 v[144:145], v154 offset:128
  v_mfma_f32_16x16x32_bf16 v[28:31], v[132:135], v[100:103], v[28:31]
  ds_read_b64_tr_b16 v[146:147], v154 offset:1664
  v_mfma_f32_16x16x32_bf16 v[52:55], v[132:135], v[104:107], v[52:55]
  v_mfma_f32_16x16x32_bf16 v[76:79], v[132:135], v[108:111], v[76:79]
  s_waitcnt lgkmcnt(8)
  v_mfma_f32_16x16x32_bf16 v[8:11], v[136:139], v[96:99], v[8:11]
  ds_read_b64_tr_b16 v[148:149], v155 offset:128
  v_mfma_f32_16x16x32_bf16 v[32:35], v[136:139], v[100:103], v[32:35]
  ds_read_b64_tr_b16 v[150:151], v155 offset:1664
  v_mfma_f32_16x16x32_bf16 v[56:59], v[136:139], v[104:107], v[56:59]
  v_mfma_f32_16x16x32_bf16 v[80:83], v[136:139], v[108:111], v[80:83]
  s_waitcnt lgkmcnt(8)
  v_mfma_f32_16x16x32_bf16 v[12:15], v[140:143], v[96:99], v[12:15]
  ds_read_b64_tr_b16 v[128:129], v154 offset:12288
  v_mfma_f32_16x16x32_bf16 v[36:39], v[140:143], v[100:103], v[36:39]
  ds_read_b64_tr_b16 v[130:131], v154 offset:13824
  v_mfma_f32_16x16x32_bf16 v[60:63], v[140:143], v[104:107], v[60:63]
  v_mfma_f32_16x16x32_bf16 v[84:87], v[140:143], v[108:111], v[84:87]
  s_waitcnt lgkmcnt(4)
  v_mfma_f32_16x16x32_bf16 v[16:19], v[144:147], v[96:99], v[16:19]
  ds_read_b64_tr_b16 v[132:133], v155 offset:12288
  v_mfma_f32_16x16x32_bf16 v[40:43], v[144:147], v[100:103], v[40:43]
  ds_read_b64_tr_b16 v[134:135], v155 offset:13824
  v_mfma_f32_16x16x32_bf16 v[64:67], v[144:147], v[104:107], v[64:67]
  v_mfma_f32_16x16x32_bf16 v[88:91], v[144:147], v[108:111], v[88:91]
  s_waitcnt lgkmcnt(4)
  v_mfma_f32_16x16x32_bf16 v[20:23], v[148:151], v[96:99], v[20:23]
  ds_read_b64_tr_b16 v[136:137], v156 offset:12288
  v_mfma_f32_16x16x32_bf16 v[44:47], v[148:151], v[100:103], v[44:47]
  ds_read_b64_tr_b16 v[138:139], v156 offset:13824
  v_mfma_f32_16x16x32_bf16 v[68:71], v[148:151], v[104:107], v[68:71]
  v_mfma_f32_16x16x32_bf16 v[92:95], v[148:151], v[108:111], v[92:95]
  s_waitcnt lgkmcnt(4)
  v_mfma_f32_16x16x32_bf16 v[0:3], v[128:131], v[112:115], v[0:3]
  ds_read_b64_tr_b16 v[140:141], v157 offset:12288
  v_mfma_f32_16x16x32_bf16 v[24:27], v[128:131], v[116:119], v[24:27]
  ds_read_b64_tr_b16 v[142:143], v157 offset:13824
  v_mfma_f32_16x16x32_bf16 v[48:51], v[128:131], v[120:123], v[48:51]
  v_mfma_f32_16x16x32_bf16 v[72:75], v[128:131], v[124:127], v[72:75]
  s_waitcnt lgkmcnt(4)
  v_mfma_f32_16x16x32_bf16 v[4:7], v[132:135], v[112:115], v[4:7]
  s_barrier
  v_add_u32 v152, s76, v158
  v_add_u32 v153, s76, v159
  v_mfma_f32_16x16x32_bf16 v[28:31], v[132:135], v[116:119], v[28:31]
  v_xor_b32 v169, 2048, v152
  v_xor_b32 v170, 2048, v153
  ds_read_b128 v[96:99], v152 offset:0
  v_mfma_f32_16x16x32_bf16 v[52:55], v[132:135], v[120:123], v[52:55]
  ds_read_b128 v[100:103], v169 offset:0
  ds_read_b128 v[104:107], v152 offset:4096
  ds_read_b128 v[108:111], v169 offset:4096
  v_mfma_f32_16x16x32_bf16 v[76:79], v[132:135], v[124:127], v[76:79]
  ds_read_b64_tr_b16 v[144:145], v154 offset:12416
  ds_read_b64_tr_b16 v[146:147], v154 offset:13952
  s_waitcnt lgkmcnt(8)
  v_mfma_f32_16x16x32_bf16 v[8:11], v[136:139], v[112:115], v[8:11]
  ds_read_b64_tr_b16 v[148:149], v155 offset:12416
  v_mfma_f32_16x16x32_bf16 v[32:35], v[136:139], v[116:119], v[32:35]
  ds_read_b64_tr_b16 v[150:151], v155 offset:13952
  v_mfma_f32_16x16x32_bf16 v[56:59], v[136:139], v[120:123], v[56:59]
  v_mfma_f32_16x16x32_bf16 v[80:83], v[136:139], v[124:127], v[80:83]
  s_waitcnt lgkmcnt(8)
  v_mfma_f32_16x16x32_bf16 v[12:15], v[140:143], v[112:115], v[12:15]
  v_add_u32 v154, s76, v160
  v_add_u32 v155, s76, v161
  v_mfma_f32_16x16x32_bf16 v[36:39], v[140:143], v[116:119], v[36:39]
  ds_read_b64_tr_b16 v[128:129], v154 offset:0
  ds_read_b64_tr_b16 v[130:131], v154 offset:1536
  v_mfma_f32_16x16x32_bf16 v[60:63], v[140:143], v[120:123], v[60:63]
  v_add_u32 v156, s76, v162
  v_add_u32 v157, s76, v163
  v_mfma_f32_16x16x32_bf16 v[84:87], v[140:143], v[124:127], v[84:87]
  s_waitcnt lgkmcnt(4)
  v_mfma_f32_16x16x32_bf16 v[16:19], v[144:147], v[112:115], v[16:19]
  ds_read_b64_tr_b16 v[132:133], v155 offset:0
  ds_read_b64_tr_b16 v[134:135], v155 offset:1536
  v_mfma_f32_16x16x32_bf16 v[40:43], v[144:147], v[116:119], v[40:43]
  s_add_u32 s76, s76, 40960
  s_cmp_eq_u32 s76, 163840
  v_mfma_f32_16x16x32_bf16 v[64:67], v[144:147], v[120:123], v[64:67]
  s_cselect_b32 s76, 0, s76
  v_mfma_f32_16x16x32_bf16 v[88:91], v[144:147], v[124:127], v[88:91]
  s_waitcnt lgkmcnt(4)
  v_mfma_f32_16x16x32_bf16 v[20:23], v[148:151], v[112:115], v[20:23]
  ds_read_b64_tr_b16 v[136:137], v156 offset:0
  v_mfma_f32_16x16x32_bf16 v[44:47], v[148:151], v[116:119], v[44:47]
  ds_read_b64_tr_b16 v[138:139], v156 offset:1536
  v_mfma_f32_16x16x32_bf16 v[68:71], v[148:151], v[120:123], v[68:71]
  v_mfma_f32_16x16x32_bf16 v[92:95], v[148:151], v[124:127], v[92:95]
  s_waitcnt lgkmcnt(4)
  v_mfma_f32_16x16x32_bf16 v[0:3], v[128:131], v[96:99], v[0:3]
  ds_read_b64_tr_b16 v[140:141], v157 offset:0
  ds_read_b64_tr_b16 v[142:143], v157 offset:1536
  v_mfma_f32_16x16x32_bf16 v[24:27], v[128:131], v[100:103], v[24:27]
  ds_read_b128 v[112:115], v153 offset:0
  ds_read_b128 v[116:119], v170 offset:0
  v_mfma_f32_16x16x32_bf16 v[48:51], v[128:131], v[104:107], v[48:51]
  ds_read_b128 v[120:123], v153 offset:4096
  ds_read_b128 v[124:127], v170 offset:4096
  v_mfma_f32_16x16x32_bf16 v[72:75], v[128:131], v[108:111], v[72:75]
  s_waitcnt lgkmcnt(8)
  v_mfma_f32_16x16x32_bf16 v[4:7], v[132:135], v[96:99], v[4:7]
  ds_read_b64_tr_b16 v[144:145], v154 offset:128
  v_mfma_f32_16x16x32_bf16 v[28:31], v[132:135], v[100:103], v[28:31]
  ds_read_b64_tr_b16 v[146:147], v154 offset:1664
  v_mfma_f32_16x16x32_bf16 v[52:55], v[132:135], v[104:107], v[52:55]
  v_mfma_f32_16x16x32_bf16 v[76:79], v[132:135], v[108:111], v[76:79]
  s_waitcnt lgkmcnt(8)
  v_mfma_f32_16x16x32_bf16 v[8:11], v[136:139], v[96:99], v[8:11]
  ds_read_b64_tr_b16 v[148:149], v155 offset:128
  v_mfma_f32_16x16x32_bf16 v[32:35], v[136:139], v[100:103], v[32:35]
  ds_read_b64_tr_b16 v[150:151], v155 offset:1664
  v_mfma_f32_16x16x32_bf16 v[56:59], v[136:139], v[104:107], v[56:59]
  v_mfma_f32_16x16x32_bf16 v[80:83], v[136:139], v[108:111], v[80:83]
  s_waitcnt lgkmcnt(8)
  v_mfma_f32_16x16x32_bf16 v[12:15], v[140:143], v[96:99], v[12:15]
  ds_read_b64_tr_b16 v[128:129], v154 offset:12288
  v_mfma_f32_16x16x32_bf16 v[36:39], v[140:143], v[100:103], v[36:39]
  ds_read_b64_tr_b16 v[130:131], v154 offset:13824
  v_mfma_f32_16x16x32_bf16 v[60:63], v[140:143], v[104:107], v[60:63]
  v_mfma_f32_16x16x32_bf16 v[84:87], v[140:143], v[108:111], v[84:87]
  s_waitcnt lgkmcnt(4)
  v_mfma_f32_16x16x32_bf16 v[16:19], v[144:147], v[96:99], v[16:19]
  ds_read_b64_tr_b16 v[132:133], v155 offset:12288
  v_mfma_f32_16x16x32_bf16 v[40:43], v[144:147], v[100:103], v[40:43]
  ds_read_b64_tr_b16 v[134:135], v155 offset:13824
  v_mfma_f32_16x16x32_bf16 v[64:67], v[144:147], v[104:107], v[64:67]
  v_mfma_f32_16x16x32_bf16 v[88:91], v[144:147], v[108:111], v[88:91]
  s_waitcnt lgkmcnt(4)
  v_mfma_f32_16x16x32_bf16 v[20:23], v[148:151], v[96:99], v[20:23]
  ds_read_b64_tr_b16 v[136:137], v156 offset:12288
  v_mfma_f32_16x16x32_bf16 v[44:47], v[148:151], v[100:103], v[44:47]
  ds_read_b64_tr_b16 v[138:139], v156 offset:13824
  v_mfma_f32_16x16x32_bf16 v[68:71], v[148:151], v[104:107], v[68:71]
  v_mfma_f32_16x16x32_bf16 v[92:95], v[148:151], v[108:111], v[92:95]
  s_waitcnt lgkmcnt(4)
  v_mfma_f32_16x16x32_bf16 v[0:3], v[128:131], v[112:115], v[0:3]
  ds_read_b64_tr_b16 v[140:141], v157 offset:12288
  v_mfma_f32_16x16x32_bf16 v[24:27], v[128:131], v[116:119], v[24:27]
  ds_read_b64_tr_b16 v[142:143], v157 offset:13824
  v_mfma_f32_16x16x32_bf16 v[48:51], v[128:131], v[120:123], v[48:51]
  v_mfma_f32_16x16x32_bf16 v[72:75], v[128:131], v[124:127], v[72:75]
  s_waitcnt lgkmcnt(4)
  v_mfma_f32_16x16x32_bf16 v[4:7], v[132:135], v[112:115], v[4:7]
  s_barrier
  v_add_u32 v152, s76, v158
  v_add_u32 v153, s76, v159
  v_mfma_f32_16x16x32_bf16 v[28:31], v[132:135], v[116:119], v[28:31]
  v_xor_b32 v169, 2048, v152
  v_xor_b32 v170, 2048, v153
  ds_read_b128 v[96:99], v152 offset:0
  v_mfma_f32_16x16x32_bf16 v[52:55], v[132:135], v[120:123], v[52:55]
  ds_read_b128 v[100:103], v169 offset:0
  ds_read_b128 v[104:107], v152 offset:4096
  ds_read_b128 v[108:111], v169 offset:4096
  v_mfma_f32_16x16x32_bf16 v[76:79], v[132:135], v[124:127], v[76:79]
  ds_read_b64_tr_b16 v[144:145], v154 offset:12416
  ds_read_b64_tr_b16 v[146:147], v154 offset:13952
  s_waitcnt lgkmcnt(8)
  v_mfma_f32_16x16x32_bf16 v[8:11], v[136:139], v[112:115], v[8:11]
  ds_read_b64_tr_b16 v[148:149], v155 offset:12416
  v_mfma_f32_16x16x32_bf16 v[32:35], v[136:139], v[116:119], v[32:35]
  ds_read_b64_tr_b16 v[150:151], v155 offset:13952
  v_mfma_f32_16x16x32_bf16 v[56:59], v[136:139], v[120:123], v[56:59]
  v_mfma_f32_16x16x32_bf16 v[80:83], v[136:139], v[124:127], v[80:83]
  s_waitcnt lgkmcnt(8)
  v_mfma_f32_16x16x32_bf16 v[12:15], v[140:143], v[112:115], v[12:15]
  v_add_u32 v154, s76, v160
  v_add_u32 v155, s76, v161
  v_mfma_f32_16x16x32_bf16 v[36:39], v[140:143], v[116:119], v[36:39]
  ds_read_b64_tr_b16 v[128:129], v154 offset:0
  ds_read_b64_tr_b16 v[130:131], v154 offset:1536
  v_mfma_f32_16x16x32_bf16 v[60:63], v[140:143], v[120:123], v[60:63]
  v_add_u32 v156, s76, v162
  v_add_u32 v157, s76, v163
  v_mfma_f32_16x16x32_bf16 v[84:87], v[140:143], v[124:127], v[84:87]
  s_waitcnt lgkmcnt(4)
  v_mfma_f32_16x16x32_bf16 v[16:19], v[144:147], v[112:115], v[16:19]
  ds_read_b64_tr_b16 v[132:133], v155 offset:0
  ds_read_b64_tr_b16 v[134:135], v155 offset:1536
  v_mfma_f32_16x16x32_bf16 v[40:43], v[144:147], v[116:119], v[40:43]
  s_add_u32 s76, s76, 40960
  s_cmp_eq_u32 s76, 163840
  v_mfma_f32_16x16x32_bf16 v[64:67], v[144:147], v[120:123], v[64:67]
  s_cselect_b32 s76, 0, s76
  v_mfma_f32_16x16x32_bf16 v[88:91], v[144:147], v[124:127], v[88:91]
  s_waitcnt lgkmcnt(4)
  v_mfma_f32_16x16x32_bf16 v[20:23], v[148:151], v[112:115], v[20:23]
  ds_read_b64_tr_b16 v[136:137], v156 offset:0
  v_mfma_f32_16x16x32_bf16 v[44:47], v[148:151], v[116:119], v[44:47]
  ds_read_b64_tr_b16 v[138:139], v156 offset:1536
  v_mfma_f32_16x16x32_bf16 v[68:71], v[148:151], v[120:123], v[68:71]
  v_mfma_f32_16x16x32_bf16 v[92:95], v[148:151], v[124:127], v[92:95]
  s_waitcnt lgkmcnt(4)
  v_mfma_f32_16x16x32_bf16 v[0:3], v[128:131], v[96:99], v[0:3]
  ds_read_b64_tr_b16 v[140:141], v157 offset:0
  ds_read_b64_tr_b16 v[142:143], v157 offset:1536
  v_mfma_f32_16x16x32_bf16 v[24:27], v[128:131], v[100:103], v[24:27]
  ds_read_b128 v[112:115], v153 offset:0
  ds_read_b128 v[116:119], v170 offset:0
  v_mfma_f32_16x16x32_bf16 v[48:51], v[128:131], v[104:107], v[48:51]
  ds_read_b128 v[120:123], v153 offset:4096
  ds_read_b128 v[124:127], v170 offset:4096
  v_mfma_f32_16x16x32_bf16 v[72:75], v[128:131], v[108:111], v[72:75]
  s_waitcnt lgkmcnt(8)
  v_mfma_f32_16x16x32_bf16 v[4:7], v[132:135], v[96:99], v[4:7]
  ds_read_b64_tr_b16 v[144:145], v154 offset:128
  v_mfma_f32_16x16x32_bf16 v[28:31], v[132:135], v[100:103], v[28:31]
  ds_read_b64_tr_b16 v[146:147], v154 offset:1664
  v_mfma_f32_16x16x32_bf16 v[52:55], v[132:135], v[104:107], v[52:55]
  v_mfma_f32_16x16x32_bf16 v[76:79], v[132:135], v[108:111], v[76:79]
  s_waitcnt lgkmcnt(8)
  v_mfma_f32_16x16x32_bf16 v[8:11], v[136:139], v[96:99], v[8:11]
  ds_read_b64_tr_b16 v[148:149], v155 offset:128
  v_mfma_f32_16x16x32_bf16 v[32:35], v[136:139], v[100:103], v[32:35]
  ds_read_b64_tr_b16 v[150:151], v155 offset:1664
  v_mfma_f32_16x16x32_bf16 v[56:59], v[136:139], v[104:107], v[56:59]
  v_mfma_f32_16x16x32_bf16 v[80:83], v[136:139], v[108:111], v[80:83]
  s_waitcnt lgkmcnt(8)
  v_mfma_f32_16x16x32_bf16 v[12:15], v[140:143], v[96:99], v[12:15]
  ds_read_b64_tr_b16 v[128:129], v154 offset:12288
  v_mfma_f32_16x16x32_bf16 v[36:39], v[140:143], v[100:103], v[36:39]
  ds_read_b64_tr_b16 v[130:131], v154 offset:13824
  v_mfma_f32_16x16x32_bf16 v[60:63], v[140:143], v[104:107], v[60:63]
  v_mfma_f32_16x16x32_bf16 v[84:87], v[140:143], v[108:111], v[84:87]
  s_waitcnt lgkmcnt(4)
  v_mfma_f32_16x16x32_bf16 v[16:19], v[144:147], v[96:99], v[16:19]
  ds_read_b64_tr_b16 v[132:133], v155 offset:12288
  v_mfma_f32_16x16x32_bf16 v[40:43], v[144:147], v[100:103], v[40:43]
  ds_read_b64_tr_b16 v[134:135], v155 offset:13824
  v_mfma_f32_16x16x32_bf16 v[64:67], v[144:147], v[104:107], v[64:67]
  v_mfma_f32_16x16x32_bf16 v[88:91], v[144:147], v[108:111], v[88:91]
  s_waitcnt lgkmcnt(4)
  v_mfma_f32_16x16x32_bf16 v[20:23], v[148:151], v[96:99], v[20:23]
  ds_read_b64_tr_b16 v[136:137], v156 offset:12288
  v_mfma_f32_16x16x32_bf16 v[44:47], v[148:151], v[100:103], v[44:47]
  ds_read_b64_tr_b16 v[138:139], v156 offset:13824
  v_mfma_f32_16x16x32_bf16 v[68:71], v[148:151], v[104:107], v[68:71]
  v_mfma_f32_16x16x32_bf16 v[92:95], v[148:151], v[108:111], v[92:95]
  s_waitcnt lgkmcnt(4)
  v_mfma_f32_16x16x32_bf16 v[0:3], v[128:131], v[112:115], v[0:3]
  ds_read_b64_tr_b16 v[140:141], v157 offset:12288
  v_mfma_f32_16x16x32_bf16 v[24:27], v[128:131], v[116:119], v[24:27]
  ds_read_b64_tr_b16 v[142:143], v157 offset:13824
  v_mfma_f32_16x16x32_bf16 v[48:51], v[128:131], v[120:123], v[48:51]
  v_mfma_f32_16x16x32_bf16 v[72:75], v[128:131], v[124:127], v[72:75]
  s_waitcnt lgkmcnt(4)
  v_mfma_f32_16x16x32_bf16 v[4:7], v[132:135], v[112:115], v[4:7]
  s_barrier
  v_add_u32 v152, s76, v158
  v_add_u32 v153, s76, v159
  v_mfma_f32_16x16x32_bf16 v[28:31], v[132:135], v[116:119], v[28:31]
  v_xor_b32 v169, 2048, v152
  v_xor_b32 v170, 2048, v153
  ds_read_b128 v[96:99], v152 offset:0
  v_mfma_f32_16x16x32_bf16 v[52:55], v[132:135], v[120:123], v[52:55]
  ds_read_b128 v[100:103], v169 offset:0
  ds_read_b128 v[104:107], v152 offset:4096
  ds_read_b128 v[108:111], v169 offset:4096
  v_mfma_f32_16x16x32_bf16 v[76:79], v[132:135], v[124:127], v[76:79]
  ds_read_b64_tr_b16 v[144:145], v154 offset:12416
  ds_read_b64_tr_b16 v[146:147], v154 offset:13952
  s_waitcnt lgkmcnt(8)
  v_mfma_f32_16x16x32_bf16 v[8:11], v[136:139], v[112:115], v[8:11]
  ds_read_b64_tr_b16 v[148:149], v155 offset:12416
  v_mfma_f32_16x16x32_bf16 v[32:35], v[136:139], v[116:119], v[32:35]
  ds_read_b64_tr_b16 v[150:151], v155 offset:13952
  v_mfma_f32_16x16x32_bf16 v[56:59], v[136:139], v[120:123], v[56:59]
  v_mfma_f32_16x16x32_bf16 v[80:83], v[136:139], v[124:127], v[80:83]
  s_waitcnt lgkmcnt(8)
  v_mfma_f32_16x16x32_bf16 v[12:15], v[140:143], v[112:115], v[12:15]
  v_add_u32 v154, s76, v160
  v_add_u32 v155, s76, v161
  v_mfma_f32_16x16x32_bf16 v[36:39], v[140:143], v[116:119], v[36:39]
  ds_read_b64_tr_b16 v[128:129], v154 offset:0
  ds_read_b64_tr_b16 v[130:131], v154 offset:1536
  v_mfma_f32_16x16x32_bf16 v[60:63], v[140:143], v[120:123], v[60:63]
  v_add_u32 v156, s76, v162
  v_add_u32 v157, s76, v163
  v_mfma_f32_16x16x32_bf16 v[84:87], v[140:143], v[124:127], v[84:87]
  s_waitcnt lgkmcnt(4)
  v_mfma_f32_16x16x32_bf16 v[16:19], v[144:147], v[112:115], v[16:19]
  ds_read_b64_tr_b16 v[132:133], v155 offset:0
  ds_read_b64_tr_b16 v[134:135], v155 offset:1536
  v_mfma_f32_16x16x32_bf16 v[40:43], v[144:147], v[116:119], v[40:43]
  s_add_u32 s76, s76, 40960
  s_cmp_eq_u32 s76, 163840
  v_mfma_f32_16x16x32_bf16 v[64:67], v[144:147], v[120:123], v[64:67]
  s_cselect_b32 s76, 0, s76
  v_mfma_f32_16x16x32_bf16 v[88:91], v[144:147], v[124:127], v[88:91]
  s_waitcnt lgkmcnt(4)
  v_mfma_f32_16x16x32_bf16 v[20:23], v[148:151], v[112:115], v[20:23]
  ds_read_b64_tr_b16 v[136:137], v156 offset:0
  v_mfma_f32_16x16x32_bf16 v[44:47], v[148:151], v[116:119], v[44:47]
  ds_read_b64_tr_b16 v[138:139], v156 offset:1536
  v_mfma_f32_16x16x32_bf16 v[68:71], v[148:151], v[120:123], v[68:71]
  v_mfma_f32_16x16x32_bf16 v[92:95], v[148:151], v[124:127], v[92:95]
  s_waitcnt lgkmcnt(4)
  v_mfma_f32_16x16x32_bf16 v[0:3], v[128:131], v[96:99], v[0:3]
  ds_read_b64_tr_b16 v[140:141], v157 offset:0
  ds_read_b64_tr_b16 v[142:143], v157 offset:1536
  v_mfma_f32_16x16x32_bf16 v[24:27], v[128:131], v[100:103], v[24:27]
  ds_read_b128 v[112:115], v153 offset:0
  ds_read_b128 v[116:119], v170 offset:0
  v_mfma_f32_16x16x32_bf16 v[48:51], v[128:131], v[104:107], v[48:51]
  ds_read_b128 v[120:123], v153 offset:4096
  ds_read_b128 v[124:127], v170 offset:4096
  v_mfma_f32_16x16x32_bf16 v[72:75], v[128:131], v[108:111], v[72:75]
  s_waitcnt lgkmcnt(8)
  v_mfma_f32_16x16x32_bf16 v[4:7], v[132:135], v[96:99], v[4:7]
  ds_read_b64_tr_b16 v[144:145], v154 offset:128
  v_mfma_f32_16x16x32_bf16 v[28:31], v[132:135], v[100:103], v[28:31]
  ds_read_b64_tr_b16 v[146:147], v154 offset:1664
  v_mfma_f32_16x16x32_bf16 v[52:55], v[132:135], v[104:107], v[52:55]
  v_mfma_f32_16x16x32_bf16 v[76:79], v[132:135], v[108:111], v[76:79]
  s_waitcnt lgkmcnt(8)
  v_mfma_f32_16x16x32_bf16 v[8:11], v[136:139], v[96:99], v[8:11]
  ds_read_b64_tr_b16 v[148:149], v155 offset:128
  v_mfma_f32_16x16x32_bf16 v[32:35], v[136:139], v[100:103], v[32:35]
  ds_read_b64_tr_b16 v[150:151], v155 offset:1664
  v_mfma_f32_16x16x32_bf16 v[56:59], v[136:139], v[104:107], v[56:59]
  v_mfma_f32_16x16x32_bf16 v[80:83], v[136:139], v[108:111], v[80:83]
  s_waitcnt lgkmcnt(8)
  v_mfma_f32_16x16x32_bf16 v[12:15], v[140:143], v[96:99], v[12:15]
  ds_read_b64_tr_b16 v[128:129], v154 offset:12288
  v_mfma_f32_16x16x32_bf16 v[36:39], v[140:143], v[100:103], v[36:39]
  ds_read_b64_tr_b16 v[130:131], v154 offset:13824
  v_mfma_f32_16x16x32_bf16 v[60:63], v[140:143], v[104:107], v[60:63]
  v_mfma_f32_16x16x32_bf16 v[84:87], v[140:143], v[108:111], v[84:87]
  s_waitcnt lgkmcnt(4)
  v_mfma_f32_16x16x32_bf16 v[16:19], v[144:147], v[96:99], v[16:19]
  ds_read_b64_tr_b16 v[132:133], v155 offset:12288
  v_mfma_f32_16x16x32_bf16 v[40:43], v[144:147], v[100:103], v[40:43]
  ds_read_b64_tr_b16 v[134:135], v155 offset:13824
  v_mfma_f32_16x16x32_bf16 v[64:67], v[144:147], v[104:107], v[64:67]
  v_mfma_f32_16x16x32_bf16 v[88:91], v[144:147], v[108:111], v[88:91]
  s_waitcnt lgkmcnt(4)
  v_mfma_f32_16x16x32_bf16 v[20:23], v[148:151], v[96:99], v[20:23]
  ds_read_b64_tr_b16 v[136:137], v156 offset:12288
  v_mfma_f32_16x16x32_bf16 v[44:47], v[148:151], v[100:103], v[44:47]
  ds_read_b64_tr_b16 v[138:139], v156 offset:13824
  v_mfma_f32_16x16x32_bf16 v[68:71], v[148:151], v[104:107], v[68:71]
  v_mfma_f32_16x16x32_bf16 v[92:95], v[148:151], v[108:111], v[92:95]
  s_waitcnt lgkmcnt(4)
  v_mfma_f32_16x16x32_bf16 v[0:3], v[128:131], v[112:115], v[0:3]
  ds_read_b64_tr_b16 v[140:141], v157 offset:12288
  v_mfma_f32_16x16x32_bf16 v[24:27], v[128:131], v[116:119], v[24:27]
  ds_read_b64_tr_b16 v[142:143], v157 offset:13824
  v_mfma_f32_16x16x32_bf16 v[48:51], v[128:131], v[120:123], v[48:51]
  v_mfma_f32_16x16x32_bf16 v[72:75], v[128:131], v[124:127], v[72:75]
  s_waitcnt lgkmcnt(4)
  v_mfma_f32_16x16x32_bf16 v[4:7], v[132:135], v[112:115], v[4:7]
  s_barrier
  v_add_u32 v152, s76, v158
  v_add_u32 v153, s76, v159
  v_mfma_f32_16x16x32_bf16 v[28:31], v[132:135], v[116:119], v[28:31]
  v_xor_b32 v169, 2048, v152
  v_xor_b32 v170, 2048, v153
  ds_read_b128 v[96:99], v152 offset:0
  v_mfma_f32_16x16x32_bf16 v[52:55], v[132:135], v[120:123], v[52:55]
  ds_read_b128 v[100:103], v169 offset:0
  ds_read_b128 v[104:107], v152 offset:4096
  ds_read_b128 v[108:111], v169 offset:4096
  v_mfma_f32_16x16x32_bf16 v[76:79], v[132:135], v[124:127], v[76:79]
  ds_read_b64_tr_b16 v[144:145], v154 offset:12416
  ds_read_b64_tr_b16 v[146:147], v154 offset:13952
  s_waitcnt lgkmcnt(8)
  v_mfma_f32_16x16x32_bf16 v[8:11], v[136:139], v[112:115], v[8:11]
  ds_read_b64_tr_b16 v[148:149], v155 offset:12416
  v_mfma_f32_16x16x32_bf16 v[32:35], v[136:139], v[116:119], v[32:35]
  ds_read_b64_tr_b16 v[150:151], v155 offset:13952
  v_mfma_f32_16x16x32_bf16 v[56:59], v[136:139], v[120:123], v[56:59]
  v_mfma_f32_16x16x32_bf16 v[80:83], v[136:139], v[124:127], v[80:83]
  s_waitcnt lgkmcnt(8)
  v_mfma_f32_16x16x32_bf16 v[12:15], v[140:143], v[112:115], v[12:15]
  v_add_u32 v154, s76, v160
  v_add_u32 v155, s76, v161
  v_mfma_f32_16x16x32_bf16 v[36:39], v[140:143], v[116:119], v[36:39]
  ds_read_b64_tr_b16 v[128:129], v154 offset:0
  ds_read_b64_tr_b16 v[130:131], v154 offset:1536
  v_mfma_f32_16x16x32_bf16 v[60:63], v[140:143], v[120:123], v[60:63]
  v_add_u32 v156, s76, v162
  v_add_u32 v157, s76, v163
  v_mfma_f32_16x16x32_bf16 v[84:87], v[140:143], v[124:127], v[84:87]
  s_waitcnt lgkmcnt(4)
  v_mfma_f32_16x16x32_bf16 v[16:19], v[144:147], v[112:115], v[16:19]
  ds_read_b64_tr_b16 v[132:133], v155 offset:0
  ds_read_b64_tr_b16 v[134:135], v155 offset:1536
  v_mfma_f32_16x16x32_bf16 v[40:43], v[144:147], v[116:119], v[40:43]
  s_add_u32 s76, s76, 40960
  s_cmp_eq_u32 s76, 163840
  v_mfma_f32_16x16x32_bf16 v[64:67], v[144:147], v[120:123], v[64:67]
  s_cselect_b32 s76, 0, s76
  v_mfma_f32_16x16x32_bf16 v[88:91], v[144:147], v[124:127], v[88:91]
  s_waitcnt lgkmcnt(4)
  v_mfma_f32_16x16x32_bf16 v[20:23], v[148:151], v[112:115], v[20:23]
  ds_read_b64_tr_b16 v[136:137], v156 offset:0
  v_mfma_f32_16x16x32_bf16 v[44:47], v[148:151], v[116:119], v[44:47]
  ds_read_b64_tr_b16 v[138:139], v156 offset:1536
  v_mfma_f32_16x16x32_bf16 v[68:71], v[148:151], v[120:123], v[68:71]
  v_mfma_f32_16x16x32_bf16 v[92:95], v[148:151], v[124:127], v[92:95]
  s_waitcnt lgkmcnt(4)
  v_mfma_f32_16x16x32_bf16 v[0:3], v[128:131], v[96:99], v[0:3]
  ds_read_b64_tr_b16 v[140:141], v157 offset:0
  ds_read_b64_tr_b16 v[142:143], v157 offset:1536
  v_mfma_f32_16x16x32_bf16 v[24:27], v[128:131], v[100:103], v[24:27]
  ds_read_b128 v[112:115], v153 offset:0
  ds_read_b128 v[116:119], v170 offset:0
  v_mfma_f32_16x16x32_bf16 v[48:51], v[128:131], v[104:107], v[48:51]
  ds_read_b128 v[120:123], v153 offset:4096
  ds_read_b128 v[124:127], v170 offset:4096
  v_mfma_f32_16x16x32_bf16 v[72:75], v[128:131], v[108:111], v[72:75]
  s_waitcnt lgkmcnt(8)
  v_mfma_f32_16x16x32_bf16 v[4:7], v[132:135], v[96:99], v[4:7]
  ds_read_b64_tr_b16 v[144:145], v154 offset:128
  v_mfma_f32_16x16x32_bf16 v[28:31], v[132:135], v[100:103], v[28:31]
  ds_read_b64_tr_b16 v[146:147], v154 offset:1664
  v_mfma_f32_16x16x32_bf16 v[52:55], v[132:135], v[104:107], v[52:55]
  v_mfma_f32_16x16x32_bf16 v[76:79], v[132:135], v[108:111], v[76:79]
  s_waitcnt lgkmcnt(8)
  v_mfma_f32_16x16x32_bf16 v[8:11], v[136:139], v[96:99], v[8:11]
  ds_read_b64_tr_b16 v[148:149], v155 offset:128
  v_mfma_f32_16x16x32_bf16 v[32:35], v[136:139], v[100:103], v[32:35]
  ds_read_b64_tr_b16 v[150:151], v155 offset:1664
  v_mfma_f32_16x16x32_bf16 v[56:59], v[136:139], v[104:107], v[56:59]
  v_mfma_f32_16x16x32_bf16 v[80:83], v[136:139], v[108:111], v[80:83]
  s_waitcnt lgkmcnt(8)
  v_mfma_f32_16x16x32_bf16 v[12:15], v[140:143], v[96:99], v[12:15]
  ds_read_b64_tr_b16 v[128:129], v154 offset:12288
  v_mfma_f32_16x16x32_bf16 v[36:39], v[140:143], v[100:103], v[36:39]
  ds_read_b64_tr_b16 v[130:131], v154 offset:13824
  v_mfma_f32_16x16x32_bf16 v[60:63], v[140:143], v[104:107], v[60:63]
  v_mfma_f32_16x16x32_bf16 v[84:87], v[140:143], v[108:111], v[84:87]
  s_waitcnt lgkmcnt(4)
  v_mfma_f32_16x16x32_bf16 v[16:19], v[144:147], v[96:99], v[16:19]
  ds_read_b64_tr_b16 v[132:133], v155 offset:12288
  v_mfma_f32_16x16x32_bf16 v[40:43], v[144:147], v[100:103], v[40:43]
  ds_read_b64_tr_b16 v[134:135], v155 offset:13824
  v_mfma_f32_16x16x32_bf16 v[64:67], v[144:147], v[104:107], v[64:67]
  v_mfma_f32_16x16x32_bf16 v[88:91], v[144:147], v[108:111], v[88:91]
  s_waitcnt lgkmcnt(4)
  v_mfma_f32_16x16x32_bf16 v[20:23], v[148:151], v[96:99], v[20:23]
  ds_read_b64_tr_b16 v[136:137], v156 offset:12288
  v_mfma_f32_16x16x32_bf16 v[44:47], v[148:151], v[100:103], v[44:47]
  ds_read_b64_tr_b16 v[138:139], v156 offset:13824
  v_mfma_f32_16x16x32_bf16 v[68:71], v[148:151], v[104:107], v[68:71]
  v_mfma_f32_16x16x32_bf16 v[92:95], v[148:151], v[108:111], v[92:95]
  s_waitcnt lgkmcnt(4)
  v_mfma_f32_16x16x32_bf16 v[0:3], v[128:131], v[112:115], v[0:3]
  ds_read_b64_tr_b16 v[140:141], v157 offset:12288
  v_mfma_f32_16x16x32_bf16 v[24:27], v[128:131], v[116:119], v[24:27]
  ds_read_b64_tr_b16 v[142:143], v157 offset:13824
  v_mfma_f32_16x16x32_bf16 v[48:51], v[128:131], v[120:123], v[48:51]
  v_mfma_f32_16x16x32_bf16 v[72:75], v[128:131], v[124:127], v[72:75]
  s_waitcnt lgkmcnt(4)
  v_mfma_f32_16x16x32_bf16 v[4:7], v[132:135], v[112:115], v[4:7]
  s_barrier
  v_add_u32 v152, s76, v158
  v_add_u32 v153, s76, v159
  v_mfma_f32_16x16x32_bf16 v[28:31], v[132:135], v[116:119], v[28:31]
  v_xor_b32 v169, 2048, v152
  v_xor_b32 v170, 2048, v153
  ds_read_b128 v[96:99], v152 offset:0
  v_mfma_f32_16x16x32_bf16 v[52:55], v[132:135], v[120:123], v[52:55]
  ds_read_b128 v[100:103], v169 offset:0
  ds_read_b128 v[104:107], v152 offset:4096
  ds_read_b128 v[108:111], v169 offset:4096
  v_mfma_f32_16x16x32_bf16 v[76:79], v[132:135], v[124:127], v[76:79]
  ds_read_b64_tr_b16 v[144:145], v154 offset:12416
  ds_read_b64_tr_b16 v[146:147], v154 offset:13952
  s_waitcnt lgkmcnt(8)
  v_mfma_f32_16x16x32_bf16 v[8:11], v[136:139], v[112:115], v[8:11]
  ds_read_b64_tr_b16 v[148:149], v155 offset:12416
  v_mfma_f32_16x16x32_bf16 v[32:35], v[136:139], v[116:119], v[32:35]
  ds_read_b64_tr_b16 v[150:151], v155 offset:13952
  v_mfma_f32_16x16x32_bf16 v[56:59], v[136:139], v[120:123], v[56:59]
  v_mfma_f32_16x16x32_bf16 v[80:83], v[136:139], v[124:127], v[80:83]
  s_waitcnt lgkmcnt(8)
  v_mfma_f32_16x16x32_bf16 v[12:15], v[140:143], v[112:115], v[12:15]
  v_add_u32 v154, s76, v160
  v_add_u32 v155, s76, v161
  v_mfma_f32_16x16x32_bf16 v[36:39], v[140:143], v[116:119], v[36:39]
  ds_read_b64_tr_b16 v[128:129], v154 offset:0
  ds_read_b64_tr_b16 v[130:131], v154 offset:1536
  v_mfma_f32_16x16x32_bf16 v[60:63], v[140:143], v[120:123], v[60:63]
  v_add_u32 v156, s76, v162
  v_add_u32 v157, s76, v163
  v_mfma_f32_16x16x32_bf16 v[84:87], v[140:143], v[124:127], v[84:87]
  s_waitcnt lgkmcnt(4)
  v_mfma_f32_16x16x32_bf16 v[16:19], v[144:147], v[112:115], v[16:19]
  ds_read_b64_tr_b16 v[132:133], v155 offset:0
  ds_read_b64_tr_b16 v[134:135], v155 offset:1536
  v_mfma_f32_16x16x32_bf16 v[40:43], v[144:147], v[116:119], v[40:43]
  s_add_u32 s76, s76, 40960
  s_cmp_eq_u32 s76, 163840
  v_mfma_f32_16x16x32_bf16 v[64:67], v[144:147], v[120:123], v[64:67]
  s_cselect_b32 s76, 0, s76
  v_mfma_f32_16x16x32_bf16 v[88:91], v[144:147], v[124:127], v[88:91]
  s_waitcnt lgkmcnt(4)
  v_mfma_f32_16x16x32_bf16 v[20:23], v[148:151], v[112:115], v[20:23]
  ds_read_b64_tr_b16 v[136:137], v156 offset:0
  v_mfma_f32_16x16x32_bf16 v[44:47], v[148:151], v[116:119], v[44:47]
  ds_read_b64_tr_b16 v[138:139], v156 offset:1536
  v_mfma_f32_16x16x32_bf16 v[68:71], v[148:151], v[120:123], v[68:71]
  v_mfma_f32_16x16x32_bf16 v[92:95], v[148:151], v[124:127], v[92:95]
  s_waitcnt lgkmcnt(4)
  v_mfma_f32_16x16x32_bf16 v[0:3], v[128:131], v[96:99], v[0:3]
  ds_read_b64_tr_b16 v[140:141], v157 offset:0
  ds_read_b64_tr_b16 v[142:143], v157 offset:1536
  v_mfma_f32_16x16x32_bf16 v[24:27], v[128:131], v[100:103], v[24:27]
  ds_read_b128 v[112:115], v153 offset:0
  ds_read_b128 v[116:119], v170 offset:0
  v_mfma_f32_16x16x32_bf16 v[48:51], v[128:131], v[104:107], v[48:51]
  ds_read_b128 v[120:123], v153 offset:4096
  ds_read_b128 v[124:127], v170 offset:4096
  v_mfma_f32_16x16x32_bf16 v[72:75], v[128:131], v[108:111], v[72:75]
  s_waitcnt lgkmcnt(8)
  v_mfma_f32_16x16x32_bf16 v[4:7], v[132:135], v[96:99], v[4:7]
  ds_read_b64_tr_b16 v[144:145], v154 offset:128
  v_mfma_f32_16x16x32_bf16 v[28:31], v[132:135], v[100:103], v[28:31]
  ds_read_b64_tr_b16 v[146:147], v154 offset:1664
  v_mfma_f32_16x16x32_bf16 v[52:55], v[132:135], v[104:107], v[52:55]
  v_mfma_f32_16x16x32_bf16 v[76:79], v[132:135], v[108:111], v[76:79]
  s_waitcnt lgkmcnt(8)
  v_mfma_f32_16x16x32_bf16 v[8:11], v[136:139], v[96:99], v[8:11]
  ds_read_b64_tr_b16 v[148:149], v155 offset:128
  v_mfma_f32_16x16x32_bf16 v[32:35], v[136:139], v[100:103], v[32:35]
  ds_read_b64_tr_b16 v[150:151], v155 offset:1664
  v_mfma_f32_16x16x32_bf16 v[56:59], v[136:139], v[104:107], v[56:59]
  v_mfma_f32_16x16x32_bf16 v[80:83], v[136:139], v[108:111], v[80:83]
  s_waitcnt lgkmcnt(8)
  v_mfma_f32_16x16x32_bf16 v[12:15], v[140:143], v[96:99], v[12:15]
  ds_read_b64_tr_b16 v[128:129], v154 offset:12288
  v_mfma_f32_16x16x32_bf16 v[36:39], v[140:143], v[100:103], v[36:39]
  ds_read_b64_tr_b16 v[130:131], v154 offset:13824
  v_mfma_f32_16x16x32_bf16 v[60:63], v[140:143], v[104:107], v[60:63]
  v_mfma_f32_16x16x32_bf16 v[84:87], v[140:143], v[108:111], v[84:87]
  s_waitcnt lgkmcnt(4)
  v_mfma_f32_16x16x32_bf16 v[16:19], v[144:147], v[96:99], v[16:19]
  ds_read_b64_tr_b16 v[132:133], v155 offset:12288
  v_mfma_f32_16x16x32_bf16 v[40:43], v[144:147], v[100:103], v[40:43]
  ds_read_b64_tr_b16 v[134:135], v155 offset:13824
  v_mfma_f32_16x16x32_bf16 v[64:67], v[144:147], v[104:107], v[64:67]
  v_mfma_f32_16x16x32_bf16 v[88:91], v[144:147], v[108:111], v[88:91]
  s_waitcnt lgkmcnt(4)
  v_mfma_f32_16x16x32_bf16 v[20:23], v[148:151], v[96:99], v[20:23]
  ds_read_b64_tr_b16 v[136:137], v156 offset:12288
  v_mfma_f32_16x16x32_bf16 v[44:47], v[148:151], v[100:103], v[44:47]
  ds_read_b64_tr_b16 v[138:139], v156 offset:13824
  v_mfma_f32_16x16x32_bf16 v[68:71], v[148:151], v[104:107], v[68:71]
  v_mfma_f32_16x16x32_bf16 v[92:95], v[148:151], v[108:111], v[92:95]
  s_waitcnt lgkmcnt(4)
  v_mfma_f32_16x16x32_bf16 v[0:3], v[128:131], v[112:115], v[0:3]
  ds_read_b64_tr_b16 v[140:141], v157 offset:12288
  v_mfma_f32_16x16x32_bf16 v[24:27], v[128:131], v[116:119], v[24:27]
  ds_read_b64_tr_b16 v[142:143], v157 offset:13824
  v_mfma_f32_16x16x32_bf16 v[48:51], v[128:131], v[120:123], v[48:51]
  v_mfma_f32_16x16x32_bf16 v[72:75], v[128:131], v[124:127], v[72:75]
  s_waitcnt lgkmcnt(4)
  v_mfma_f32_16x16x32_bf16 v[4:7], v[132:135], v[112:115], v[4:7]
  s_barrier
  v_add_u32 v152, s76, v158
  v_add_u32 v153, s76, v159
  v_mfma_f32_16x16x32_bf16 v[28:31], v[132:135], v[116:119], v[28:31]
  v_xor_b32 v169, 2048, v152
  v_xor_b32 v170, 2048, v153
  ds_read_b128 v[96:99], v152 offset:0
  v_mfma_f32_16x16x32_bf16 v[52:55], v[132:135], v[120:123], v[52:55]
  ds_read_b128 v[100:103], v169 offset:0
  ds_read_b128 v[104:107], v152 offset:4096
  ds_read_b128 v[108:111], v169 offset:4096
  v_mfma_f32_16x16x32_bf16 v[76:79], v[132:135], v[124:127], v[76:79]
  ds_read_b64_tr_b16 v[144:145], v154 offset:12416
  ds_read_b64_tr_b16 v[146:147], v154 offset:13952
  s_waitcnt lgkmcnt(8)
  v_mfma_f32_16x16x32_bf16 v[8:11], v[136:139], v[112:115], v[8:11]
  ds_read_b64_tr_b16 v[148:149], v155 offset:12416
  v_mfma_f32_16x16x32_bf16 v[32:35], v[136:139], v[116:119], v[32:35]
  ds_read_b64_tr_b16 v[150:151], v155 offset:13952
  v_mfma_f32_16x16x32_bf16 v[56:59], v[136:139], v[120:123], v[56:59]
  v_mfma_f32_16x16x32_bf16 v[80:83], v[136:139], v[124:127], v[80:83]
  s_waitcnt lgkmcnt(8)
  v_mfma_f32_16x16x32_bf16 v[12:15], v[140:143], v[112:115], v[12:15]
  v_add_u32 v154, s76, v160
  v_add_u32 v155, s76, v161
  v_mfma_f32_16x16x32_bf16 v[36:39], v[140:143], v[116:119], v[36:39]
  ds_read_b64_tr_b16 v[128:129], v154 offset:0
  ds_read_b64_tr_b16 v[130:131], v154 offset:1536
  v_mfma_f32_16x16x32_bf16 v[60:63], v[140:143], v[120:123], v[60:63]
  v_add_u32 v156, s76, v162
  v_add_u32 v157, s76, v163
  v_mfma_f32_16x16x32_bf16 v[84:87], v[140:143], v[124:127], v[84:87]
  s_waitcnt lgkmcnt(4)
  v_mfma_f32_16x16x32_bf16 v[16:19], v[144:147], v[112:115], v[16:19]
  ds_read_b64_tr_b16 v[132:133], v155 offset:0
  ds_read_b64_tr_b16 v[134:135], v155 offset:1536
  v_mfma_f32_16x16x32_bf16 v[40:43], v[144:147], v[116:119], v[40:43]
  s_add_u32 s76, s76, 40960
  s_cmp_eq_u32 s76, 163840
  v_mfma_f32_16x16x32_bf16 v[64:67], v[144:147], v[120:123], v[64:67]
  s_cselect_b32 s76, 0, s76
  v_mfma_f32_16x16x32_bf16 v[88:91], v[144:147], v[124:127], v[88:91]
  s_waitcnt lgkmcnt(4)
  v_mfma_f32_16x16x32_bf16 v[20:23], v[148:151], v[112:115], v[20:23]
  ds_read_b64_tr_b16 v[136:137], v156 offset:0
  v_mfma_f32_16x16x32_bf16 v[44:47], v[148:151], v[116:119], v[44:47]
  ds_read_b64_tr_b16 v[138:139], v156 offset:1536
  v_mfma_f32_16x16x32_bf16 v[68:71], v[148:151], v[120:123], v[68:71]
  v_mfma_f32_16x16x32_bf16 v[92:95], v[148:151], v[124:127], v[92:95]
  s_waitcnt lgkmcnt(4)
  v_mfma_f32_16x16x32_bf16 v[0:3], v[128:131], v[96:99], v[0:3]
  ds_read_b64_tr_b16 v[140:141], v157 offset:0
  ds_read_b64_tr_b16 v[142:143], v157 offset:1536
  v_mfma_f32_16x16x32_bf16 v[24:27], v[128:131], v[100:103], v[24:27]
  ds_read_b128 v[112:115], v153 offset:0
  ds_read_b128 v[116:119], v170 offset:0
  v_mfma_f32_16x16x32_bf16 v[48:51], v[128:131], v[104:107], v[48:51]
  ds_read_b128 v[120:123], v153 offset:4096
  ds_read_b128 v[124:127], v170 offset:4096
  v_mfma_f32_16x16x32_bf16 v[72:75], v[128:131], v[108:111], v[72:75]
  s_waitcnt lgkmcnt(8)
  v_mfma_f32_16x16x32_bf16 v[4:7], v[132:135], v[96:99], v[4:7]
  ds_read_b64_tr_b16 v[144:145], v154 offset:128
  v_mfma_f32_16x16x32_bf16 v[28:31], v[132:135], v[100:103], v[28:31]
  ds_read_b64_tr_b16 v[146:147], v154 offset:1664
  v_mfma_f32_16x16x32_bf16 v[52:55], v[132:135], v[104:107], v[52:55]
  v_mfma_f32_16x16x32_bf16 v[76:79], v[132:135], v[108:111], v[76:79]
  s_waitcnt lgkmcnt(8)
  v_mfma_f32_16x16x32_bf16 v[8:11], v[136:139], v[96:99], v[8:11]
  ds_read_b64_tr_b16 v[148:149], v155 offset:128
  v_mfma_f32_16x16x32_bf16 v[32:35], v[136:139], v[100:103], v[32:35]
  ds_read_b64_tr_b16 v[150:151], v155 offset:1664
  v_mfma_f32_16x16x32_bf16 v[56:59], v[136:139], v[104:107], v[56:59]
  v_mfma_f32_16x16x32_bf16 v[80:83], v[136:139], v[108:111], v[80:83]
  s_waitcnt lgkmcnt(8)
  v_mfma_f32_16x16x32_bf16 v[12:15], v[140:143], v[96:99], v[12:15]
  ds_read_b64_tr_b16 v[128:129], v154 offset:12288
  v_mfma_f32_16x16x32_bf16 v[36:39], v[140:143], v[100:103], v[36:39]
  ds_read_b64_tr_b16 v[130:131], v154 offset:13824
  v_mfma_f32_16x16x32_bf16 v[60:63], v[140:143], v[104:107], v[60:63]
  v_mfma_f32_16x16x32_bf16 v[84:87], v[140:143], v[108:111], v[84:87]
  s_waitcnt lgkmcnt(4)
  v_mfma_f32_16x16x32_bf16 v[16:19], v[144:147], v[96:99], v[16:19]
  ds_read_b64_tr_b16 v[132:133], v155 offset:12288
  v_mfma_f32_16x16x32_bf16 v[40:43], v[144:147], v[100:103], v[40:43]
  ds_read_b64_tr_b16 v[134:135], v155 offset:13824
  v_mfma_f32_16x16x32_bf16 v[64:67], v[144:147], v[104:107], v[64:67]
  v_mfma_f32_16x16x32_bf16 v[88:91], v[144:147], v[108:111], v[88:91]
  s_waitcnt lgkmcnt(4)
  v_mfma_f32_16x16x32_bf16 v[20:23], v[148:151], v[96:99], v[20:23]
  ds_read_b64_tr_b16 v[136:137], v156 offset:12288
  v_mfma_f32_16x16x32_bf16 v[44:47], v[148:151], v[100:103], v[44:47]
  ds_read_b64_tr_b16 v[138:139], v156 offset:13824
  v_mfma_f32_16x16x32_bf16 v[68:71], v[148:151], v[104:107], v[68:71]
  v_mfma_f32_16x16x32_bf16 v[92:95], v[148:151], v[108:111], v[92:95]
  s_waitcnt lgkmcnt(4)
  v_mfma_f32_16x16x32_bf16 v[0:3], v[128:131], v[112:115], v[0:3]
  ds_read_b64_tr_b16 v[140:141], v157 offset:12288
  v_mfma_f32_16x16x32_bf16 v[24:27], v[128:131], v[116:119], v[24:27]
  ds_read_b64_tr_b16 v[142:143], v157 offset:13824
  v_mfma_f32_16x16x32_bf16 v[48:51], v[128:131], v[120:123], v[48:51]
  v_mfma_f32_16x16x32_bf16 v[72:75], v[128:131], v[124:127], v[72:75]
  s_waitcnt lgkmcnt(4)
  v_mfma_f32_16x16x32_bf16 v[4:7], v[132:135], v[112:115], v[4:7]
  s_barrier
  v_add_u32 v152, s76, v158
  v_add_u32 v153, s76, v159
  v_mfma_f32_16x16x32_bf16 v[28:31], v[132:135], v[116:119], v[28:31]
  v_xor_b32 v169, 2048, v152
  v_xor_b32 v170, 2048, v153
  ds_read_b128 v[96:99], v152 offset:0
  v_mfma_f32_16x16x32_bf16 v[52:55], v[132:135], v[120:123], v[52:55]
  ds_read_b128 v[100:103], v169 offset:0
  ds_read_b128 v[104:107], v152 offset:4096
  ds_read_b128 v[108:111], v169 offset:4096
  v_mfma_f32_16x16x32_bf16 v[76:79], v[132:135], v[124:127], v[76:79]
  ds_read_b64_tr_b16 v[144:145], v154 offset:12416
  ds_read_b64_tr_b16 v[146:147], v154 offset:13952
  s_waitcnt lgkmcnt(8)
  v_mfma_f32_16x16x32_bf16 v[8:11], v[136:139], v[112:115], v[8:11]
  ds_read_b64_tr_b16 v[148:149], v155 offset:12416
  v_mfma_f32_16x16x32_bf16 v[32:35], v[136:139], v[116:119], v[32:35]
  ds_read_b64_tr_b16 v[150:151], v155 offset:13952
  v_mfma_f32_16x16x32_bf16 v[56:59], v[136:139], v[120:123], v[56:59]
  v_mfma_f32_16x16x32_bf16 v[80:83], v[136:139], v[124:127], v[80:83]
  s_waitcnt lgkmcnt(8)
  v_mfma_f32_16x16x32_bf16 v[12:15], v[140:143], v[112:115], v[12:15]
  v_add_u32 v154, s76, v160
  v_add_u32 v155, s76, v161
  v_mfma_f32_16x16x32_bf16 v[36:39], v[140:143], v[116:119], v[36:39]
  ds_read_b64_tr_b16 v[128:129], v154 offset:0
  ds_read_b64_tr_b16 v[130:131], v154 offset:1536
  v_mfma_f32_16x16x32_bf16 v[60:63], v[140:143], v[120:123], v[60:63]
  v_add_u32 v156, s76, v162
  v_add_u32 v157, s76, v163
  v_mfma_f32_16x16x32_bf16 v[84:87], v[140:143], v[124:127], v[84:87]
  s_waitcnt lgkmcnt(4)
  v_mfma_f32_16x16x32_bf16 v[16:19], v[144:147], v[112:115], v[16:19]
  ds_read_b64_tr_b16 v[132:133], v155 offset:0
  ds_read_b64_tr_b16 v[134:135], v155 offset:1536
  v_mfma_f32_16x16x32_bf16 v[40:43], v[144:147], v[116:119], v[40:43]
  s_add_u32 s76, s76, 40960
  s_cmp_eq_u32 s76, 163840
  v_mfma_f32_16x16x32_bf16 v[64:67], v[144:147], v[120:123], v[64:67]
  s_cselect_b32 s76, 0, s76
  v_mfma_f32_16x16x32_bf16 v[88:91], v[144:147], v[124:127], v[88:91]
  s_waitcnt lgkmcnt(4)
  v_mfma_f32_16x16x32_bf16 v[20:23], v[148:151], v[112:115], v[20:23]
  ds_read_b64_tr_b16 v[136:137], v156 offset:0
  v_mfma_f32_16x16x32_bf16 v[44:47], v[148:151], v[116:119], v[44:47]
  ds_read_b64_tr_b16 v[138:139], v156 offset:1536
  v_mfma_f32_16x16x32_bf16 v[68:71], v[148:151], v[120:123], v[68:71]
  v_mfma_f32_16x16x32_bf16 v[92:95], v[148:151], v[124:127], v[92:95]
  s_waitcnt lgkmcnt(4)
  v_mfma_f32_16x16x32_bf16 v[0:3], v[128:131], v[96:99], v[0:3]
  ds_read_b64_tr_b16 v[140:141], v157 offset:0
  ds_read_b64_tr_b16 v[142:143], v157 offset:1536
  v_mfma_f32_16x16x32_bf16 v[24:27], v[128:131], v[100:103], v[24:27]
  ds_read_b128 v[112:115], v153 offset:0
  ds_read_b128 v[116:119], v170 offset:0
  v_mfma_f32_16x16x32_bf16 v[48:51], v[128:131], v[104:107], v[48:51]
  ds_read_b128 v[120:123], v153 offset:4096
  ds_read_b128 v[124:127], v170 offset:4096
  v_mfma_f32_16x16x32_bf16 v[72:75], v[128:131], v[108:111], v[72:75]
  s_waitcnt lgkmcnt(8)
  v_mfma_f32_16x16x32_bf16 v[4:7], v[132:135], v[96:99], v[4:7]
  ds_read_b64_tr_b16 v[144:145], v154 offset:128
  v_mfma_f32_16x16x32_bf16 v[28:31], v[132:135], v[100:103], v[28:31]
  ds_read_b64_tr_b16 v[146:147], v154 offset:1664
  v_mfma_f32_16x16x32_bf16 v[52:55], v[132:135], v[104:107], v[52:55]
  v_mfma_f32_16x16x32_bf16 v[76:79], v[132:135], v[108:111], v[76:79]
  s_waitcnt lgkmcnt(8)
  v_mfma_f32_16x16x32_bf16 v[8:11], v[136:139], v[96:99], v[8:11]
  ds_read_b64_tr_b16 v[148:149], v155 offset:128
  v_mfma_f32_16x16x32_bf16 v[32:35], v[136:139], v[100:103], v[32:35]
  ds_read_b64_tr_b16 v[150:151], v155 offset:1664
  v_mfma_f32_16x16x32_bf16 v[56:59], v[136:139], v[104:107], v[56:59]
  v_mfma_f32_16x16x32_bf16 v[80:83], v[136:139], v[108:111], v[80:83]
  s_waitcnt lgkmcnt(8)
  v_mfma_f32_16x16x32_bf16 v[12:15], v[140:143], v[96:99], v[12:15]
  ds_read_b64_tr_b16 v[128:129], v154 offset:12288
  v_mfma_f32_16x16x32_bf16 v[36:39], v[140:143], v[100:103], v[36:39]
  ds_read_b64_tr_b16 v[130:131], v154 offset:13824
  v_mfma_f32_16x16x32_bf16 v[60:63], v[140:143], v[104:107], v[60:63]
  v_mfma_f32_16x16x32_bf16 v[84:87], v[140:143], v[108:111], v[84:87]
  s_waitcnt lgkmcnt(4)
  v_mfma_f32_16x16x32_bf16 v[16:19], v[144:147], v[96:99], v[16:19]
  ds_read_b64_tr_b16 v[132:133], v155 offset:12288
  v_mfma_f32_16x16x32_bf16 v[40:43], v[144:147], v[100:103], v[40:43]
  ds_read_b64_tr_b16 v[134:135], v155 offset:13824
  v_mfma_f32_16x16x32_bf16 v[64:67], v[144:147], v[104:107], v[64:67]
  v_mfma_f32_16x16x32_bf16 v[88:91], v[144:147], v[108:111], v[88:91]
  s_waitcnt lgkmcnt(4)
  v_mfma_f32_16x16x32_bf16 v[20:23], v[148:151], v[96:99], v[20:23]
  ds_read_b64_tr_b16 v[136:137], v156 offset:12288
  v_mfma_f32_16x16x32_bf16 v[44:47], v[148:151], v[100:103], v[44:47]
  ds_read_b64_tr_b16 v[138:139], v156 offset:13824
  v_mfma_f32_16x16x32_bf16 v[68:71], v[148:151], v[104:107], v[68:71]
  v_mfma_f32_16x16x32_bf16 v[92:95], v[148:151], v[108:111], v[92:95]
  s_waitcnt lgkmcnt(4)
  v_mfma_f32_16x16x32_bf16 v[0:3], v[128:131], v[112:115], v[0:3]
  ds_read_b64_tr_b16 v[140:141], v157 offset:12288
  v_mfma_f32_16x16x32_bf16 v[24:27], v[128:131], v[116:119], v[24:27]
  ds_read_b64_tr_b16 v[142:143], v157 offset:13824
  v_mfma_f32_16x16x32_bf16 v[48:51], v[128:131], v[120:123], v[48:51]
  v_mfma_f32_16x16x32_bf16 v[72:75], v[128:131], v[124:127], v[72:75]
  s_waitcnt lgkmcnt(4)
  v_mfma_f32_16x16x32_bf16 v[4:7], v[132:135], v[112:115], v[4:7]
  v_add_u32 v152, s76, v158
  v_add_u32 v153, s76, v159
  v_mfma_f32_16x16x32_bf16 v[28:31], v[132:135], v[116:119], v[28:31]
  v_xor_b32 v169, 2048, v152
  v_xor_b32 v170, 2048, v153
  ds_read_b128 v[96:99], v152 offset:0
  v_mfma_f32_16x16x32_bf16 v[52:55], v[132:135], v[120:123], v[52:55]
  ds_read_b128 v[100:103], v169 offset:0
  ds_read_b128 v[104:107], v152 offset:4096
  ds_read_b128 v[108:111], v169 offset:4096
  v_mfma_f32_16x16x32_bf16 v[76:79], v[132:135], v[124:127], v[76:79]
  ds_read_b64_tr_b16 v[144:145], v154 offset:12416
  ds_read_b64_tr_b16 v[146:147], v154 offset:13952
  s_waitcnt lgkmcnt(8)
  v_mfma_f32_16x16x32_bf16 v[8:11], v[136:139], v[112:115], v[8:11]
  ds_read_b64_tr_b16 v[148:149], v155 offset:12416
  v_mfma_f32_16x16x32_bf16 v[32:35], v[136:139], v[116:119], v[32:35]
  ds_read_b64_tr_b16 v[150:151], v155 offset:13952
  v_mfma_f32_16x16x32_bf16 v[56:59], v[136:139], v[120:123], v[56:59]
  v_mfma_f32_16x16x32_bf16 v[80:83], v[136:139], v[124:127], v[80:83]
  s_waitcnt lgkmcnt(8)
  v_mfma_f32_16x16x32_bf16 v[12:15], v[140:143], v[112:115], v[12:15]
  v_add_u32 v154, s76, v160
  v_add_u32 v155, s76, v161
  v_mfma_f32_16x16x32_bf16 v[36:39], v[140:143], v[116:119], v[36:39]
  ds_read_b64_tr_b16 v[128:129], v154 offset:0
  ds_read_b64_tr_b16 v[130:131], v154 offset:1536
  v_mfma_f32_16x16x32_bf16 v[60:63], v[140:143], v[120:123], v[60:63]
  v_add_u32 v156, s76, v162
  v_add_u32 v157, s76, v163
  v_mfma_f32_16x16x32_bf16 v[84:87], v[140:143], v[124:127], v[84:87]
  s_waitcnt lgkmcnt(4)
  v_mfma_f32_16x16x32_bf16 v[16:19], v[144:147], v[112:115], v[16:19]
  ds_read_b64_tr_b16 v[132:133], v155 offset:0
  ds_read_b64_tr_b16 v[134:135], v155 offset:1536
  v_mfma_f32_16x16x32_bf16 v[40:43], v[144:147], v[116:119], v[40:43]
  s_add_u32 s76, s76, 40960
  s_cmp_eq_u32 s76, 163840
  v_mfma_f32_16x16x32_bf16 v[64:67], v[144:147], v[120:123], v[64:67]
  s_cselect_b32 s76, 0, s76
  v_mfma_f32_16x16x32_bf16 v[88:91], v[144:147], v[124:127], v[88:91]
  s_waitcnt lgkmcnt(4)
  v_mfma_f32_16x16x32_bf16 v[20:23], v[148:151], v[112:115], v[20:23]
  ds_read_b64_tr_b16 v[136:137], v156 offset:0
  v_mfma_f32_16x16x32_bf16 v[44:47], v[148:151], v[116:119], v[44:47]
  ds_read_b64_tr_b16 v[138:139], v156 offset:1536
  v_mfma_f32_16x16x32_bf16 v[68:71], v[148:151], v[120:123], v[68:71]
  v_mfma_f32_16x16x32_bf16 v[92:95], v[148:151], v[124:127], v[92:95]
  s_setprio 2
  s_waitcnt lgkmcnt(0)
  s_lshl_b32 s69, s65, 2
  s_lshl_b32 s70, s67, 1
  s_add_u32 s69, s69, s70
  s_mul_i32 s69, s69, 36864
  s_add_u32 s70, s69, 36864
  v_mov_b32 v165, 40960
  v_mov_b32 v166, 1
  s_mov_b64 exec, 1
  ds_add_u32 v165, v166
  s_mov_b64 exec, -1
  v_pk_fma_f32 v[212:213], v[0:1], s[72:73], s[72:73] op_sel:[0,1,1] op_sel_hi:[1,1,1] neg_lo:[0,0,1] neg_hi:[0,0,1]
  v_pk_fma_f32 v[214:215], v[2:3], s[72:73], s[72:73] op_sel:[0,1,1] op_sel_hi:[1,1,1] neg_lo:[0,0,1] neg_hi:[0,0,1]
  v_pk_fma_f32 v[216:217], v[24:25], s[72:73], s[72:73] op_sel:[0,1,1] op_sel_hi:[1,1,1] neg_lo:[0,0,1] neg_hi:[0,0,1]
  v_pk_fma_f32 v[218:219], v[26:27], s[72:73], s[72:73] op_sel:[0,1,1] op_sel_hi:[1,1,1] neg_lo:[0,0,1] neg_hi:[0,0,1]
  v_exp_f32 v212, v212 clamp
  v_exp_f32 v213, v213 clamp
  v_exp_f32 v214, v214 clamp
  v_exp_f32 v215, v215 clamp
  v_exp_f32 v216, v216 clamp
  v_exp_f32 v217, v217 clamp
  v_exp_f32 v218, v218 clamp
  v_exp_f32 v219, v219 clamp
  v_max_f32 v0, v0, v212
  v_max_f32 v1, v1, v213
  v_max_f32 v2, v2, v214
  v_max_f32 v3, v3, v215
  v_max_f32 v24, v24, v216
  v_max_f32 v25, v25, v217
  v_max_f32 v26, v26, v218
  v_max_f32 v27, v27, v219
  v_pk_add_f32 v[0:1], v[0:1], s[74:75] op_sel:[0,0] op_sel_hi:[1,0]
  v_pk_add_f32 v[2:3], v[2:3], s[74:75] op_sel:[0,0] op_sel_hi:[1,0]
  v_pk_add_f32 v[24:25], v[24:25], s[74:75] op_sel:[0,0] op_sel_hi:[1,0]
  v_pk_add_f32 v[26:27], v[26:27], s[74:75] op_sel:[0,0] op_sel_hi:[1,0]
  v_cvt_pk_bf16_f32 v220, v0, v1
  v_cvt_pk_bf16_f32 v221, v2, v3
  v_cvt_pk_bf16_f32 v222, v24, v25
  v_cvt_pk_bf16_f32 v223, v26, v27
  buffer_store_dwordx4 v[220:223], v173, s[52:55], s69 offen sc0 sc1
  v_pk_fma_f32 v[224:225], v[4:5], s[72:73], s[72:73] op_sel:[0,1,1] op_sel_hi:[1,1,1] neg_lo:[0,0,1] neg_hi:[0,0,1]
  v_pk_fma_f32 v[226:227], v[6:7], s[72:73], s[72:73] op_sel:[0,1,1] op_sel_hi:[1,1,1] neg_lo:[0,0,1] neg_hi:[0,0,1]
  v_pk_fma_f32 v[228:229], v[28:29], s[72:73], s[72:73] op_sel:[0,1,1] op_sel_hi:[1,1,1] neg_lo:[0,0,1] neg_hi:[0,0,1]
  v_pk_fma_f32 v[230:231], v[30:31], s[72:73], s[72:73] op_sel:[0,1,1] op_sel_hi:[1,1,1] neg_lo:[0,0,1] neg_hi:[0,0,1]
  v_exp_f32 v224, v224 clamp
  v_exp_f32 v225, v225 clamp
  v_exp_f32 v226, v226 clamp
  v_exp_f32 v227, v227 clamp
  v_exp_f32 v228, v228 clamp
  v_exp_f32 v229, v229 clamp
  v_exp_f32 v230, v230 clamp
  v_exp_f32 v231, v231 clamp
  v_max_f32 v4, v4, v224
  v_max_f32 v5, v5, v225
  v_max_f32 v6, v6, v226
  v_max_f32 v7, v7, v227
  v_max_f32 v28, v28, v228
  v_max_f32 v29, v29, v229
  v_max_f32 v30, v30, v230
  v_max_f32 v31, v31, v231
  v_pk_add_f32 v[4:5], v[4:5], s[74:75] op_sel:[0,0] op_sel_hi:[1,0]
  v_pk_add_f32 v[6:7], v[6:7], s[74:75] op_sel:[0,0] op_sel_hi:[1,0]
  v_pk_add_f32 v[28:29], v[28:29], s[74:75] op_sel:[0,0] op_sel_hi:[1,0]
  v_pk_add_f32 v[30:31], v[30:31], s[74:75] op_sel:[0,0] op_sel_hi:[1,0]
  v_cvt_pk_bf16_f32 v232, v4, v5
  v_cvt_pk_bf16_f32 v233, v6, v7
  v_cvt_pk_bf16_f32 v234, v28, v29
  v_cvt_pk_bf16_f32 v235, v30, v31
  buffer_store_dwordx4 v[232:235], v174, s[52:55], s69 offen sc0 sc1
  v_pk_fma_f32 v[236:237], v[8:9], s[72:73], s[72:73] op_sel:[0,1,1] op_sel_hi:[1,1,1] neg_lo:[0,0,1] neg_hi:[0,0,1]
  v_pk_fma_f32 v[238:239], v[10:11], s[72:73], s[72:73] op_sel:[0,1,1] op_sel_hi:[1,1,1] neg_lo:[0,0,1] neg_hi:[0,0,1]
  v_pk_fma_f32 v[240:241], v[32:33], s[72:73], s[72:73] op_sel:[0,1,1] op_sel_hi:[1,1,1] neg_lo:[0,0,1] neg_hi:[0,0,1]
  v_pk_fma_f32 v[242:243], v[34:35], s[72:73], s[72:73] op_sel:[0,1,1] op_sel_hi:[1,1,1] neg_lo:[0,0,1] neg_hi:[0,0,1]
  v_exp_f32 v236, v236 clamp
  v_exp_f32 v237, v237 clamp
  v_exp_f32 v238, v238 clamp
  v_exp_f32 v239, v239 clamp
  v_exp_f32 v240, v240 clamp
  v_exp_f32 v241, v241 clamp
  v_exp_f32 v242, v242 clamp
  v_exp_f32 v243, v243 clamp
  v_max_f32 v8, v8, v236
  v_max_f32 v9, v9, v237
  v_max_f32 v10, v10, v238
  v_max_f32 v11, v11, v239
  v_max_f32 v32, v32, v240
  v_max_f32 v33, v33, v241
  v_max_f32 v34, v34, v242
  v_max_f32 v35, v35, v243
  v_pk_add_f32 v[8:9], v[8:9], s[74:75] op_sel:[0,0] op_sel_hi:[1,0]
  v_pk_add_f32 v[10:11], v[10:11], s[74:75] op_sel:[0,0] op_sel_hi:[1,0]
  v_pk_add_f32 v[32:33], v[32:33], s[74:75] op_sel:[0,0] op_sel_hi:[1,0]
  v_pk_add_f32 v[34:35], v[34:35], s[74:75] op_sel:[0,0] op_sel_hi:[1,0]
  v_cvt_pk_bf16_f32 v244, v8, v9
  v_cvt_pk_bf16_f32 v245, v10, v11
  v_cvt_pk_bf16_f32 v246, v32, v33
  v_cvt_pk_bf16_f32 v247, v34, v35
  buffer_store_dwordx4 v[244:247], v175, s[52:55], s69 offen sc0 sc1
  v_pk_fma_f32 v[212:213], v[12:13], s[72:73], s[72:73] op_sel:[0,1,1] op_sel_hi:[1,1,1] neg_lo:[0,0,1] neg_hi:[0,0,1]
  v_pk_fma_f32 v[214:215], v[14:15], s[72:73], s[72:73] op_sel:[0,1,1] op_sel_hi:[1,1,1] neg_lo:[0,0,1] neg_hi:[0,0,1]
  v_pk_fma_f32 v[216:217], v[36:37], s[72:73], s[72:73] op_sel:[0,1,1] op_sel_hi:[1,1,1] neg_lo:[0,0,1] neg_hi:[0,0,1]
  v_pk_fma_f32 v[218:219], v[38:39], s[72:73], s[72:73] op_sel:[0,1,1] op_sel_hi:[1,1,1] neg_lo:[0,0,1] neg_hi:[0,0,1]
  v_exp_f32 v212, v212 clamp
  v_exp_f32 v213, v213 clamp
  v_exp_f32 v214, v214 clamp
  v_exp_f32 v215, v215 clamp
  v_exp_f32 v216, v216 clamp
  v_exp_f32 v217, v217 clamp
  v_exp_f32 v218, v218 clamp
  v_exp_f32 v219, v219 clamp
  v_max_f32 v12, v12, v212
  v_max_f32 v13, v13, v213
  v_max_f32 v14, v14, v214
  v_max_f32 v15, v15, v215
  v_max_f32 v36, v36, v216
  v_max_f32 v37, v37, v217
  v_max_f32 v38, v38, v218
  v_max_f32 v39, v39, v219
  v_pk_add_f32 v[12:13], v[12:13], s[74:75] op_sel:[0,0] op_sel_hi:[1,0]
  v_pk_add_f32 v[14:15], v[14:15], s[74:75] op_sel:[0,0] op_sel_hi:[1,0]
  v_pk_add_f32 v[36:37], v[36:37], s[74:75] op_sel:[0,0] op_sel_hi:[1,0]
  v_pk_add_f32 v[38:39], v[38:39], s[74:75] op_sel:[0,0] op_sel_hi:[1,0]
  v_cvt_pk_bf16_f32 v220, v12, v13
  v_cvt_pk_bf16_f32 v221, v14, v15
  v_cvt_pk_bf16_f32 v222, v36, v37
  v_cvt_pk_bf16_f32 v223, v38, v39
  buffer_store_dwordx4 v[220:223], v176, s[52:55], s69 offen sc0 sc1
  v_pk_fma_f32 v[224:225], v[16:17], s[72:73], s[72:73] op_sel:[0,1,1] op_sel_hi:[1,1,1] neg_lo:[0,0,1] neg_hi:[0,0,1]
  v_pk_fma_f32 v[226:227], v[18:19], s[72:73], s[72:73] op_sel:[0,1,1] op_sel_hi:[1,1,1] neg_lo:[0,0,1] neg_hi:[0,0,1]
  v_pk_fma_f32 v[228:229], v[40:41], s[72:73], s[72:73] op_sel:[0,1,1] op_sel_hi:[1,1,1] neg_lo:[0,0,1] neg_hi:[0,0,1]
  v_pk_fma_f32 v[230:231], v[42:43], s[72:73], s[72:73] op_sel:[0,1,1] op_sel_hi:[1,1,1] neg_lo:[0,0,1] neg_hi:[0,0,1]
  v_exp_f32 v224, v224 clamp
  v_exp_f32 v225, v225 clamp
  v_exp_f32 v226, v226 clamp
  v_exp_f32 v227, v227 clamp
  v_exp_f32 v228, v228 clamp
  v_exp_f32 v229, v229 clamp
  v_exp_f32 v230, v230 clamp
  v_exp_f32 v231, v231 clamp
  v_max_f32 v16, v16, v224
  v_max_f32 v17, v17, v225
  v_max_f32 v18, v18, v226
  v_max_f32 v19, v19, v227
  v_max_f32 v40, v40, v228
  v_max_f32 v41, v41, v229
  v_max_f32 v42, v42, v230
  v_max_f32 v43, v43, v231
  v_pk_add_f32 v[16:17], v[16:17], s[74:75] op_sel:[0,0] op_sel_hi:[1,0]
  v_pk_add_f32 v[18:19], v[18:19], s[74:75] op_sel:[0,0] op_sel_hi:[1,0]
  v_pk_add_f32 v[40:41], v[40:41], s[74:75] op_sel:[0,0] op_sel_hi:[1,0]
  v_pk_add_f32 v[42:43], v[42:43], s[74:75] op_sel:[0,0] op_sel_hi:[1,0]
  v_cvt_pk_bf16_f32 v232, v16, v17
  v_cvt_pk_bf16_f32 v233, v18, v19
  v_cvt_pk_bf16_f32 v234, v40, v41
  v_cvt_pk_bf16_f32 v235, v42, v43
  buffer_store_dwordx4 v[232:235], v177, s[52:55], s69 offen sc0 sc1
  v_pk_fma_f32 v[236:237], v[20:21], s[72:73], s[72:73] op_sel:[0,1,1] op_sel_hi:[1,1,1] neg_lo:[0,0,1] neg_hi:[0,0,1]
  v_pk_fma_f32 v[238:239], v[22:23], s[72:73], s[72:73] op_sel:[0,1,1] op_sel_hi:[1,1,1] neg_lo:[0,0,1] neg_hi:[0,0,1]
  v_pk_fma_f32 v[240:241], v[44:45], s[72:73], s[72:73] op_sel:[0,1,1] op_sel_hi:[1,1,1] neg_lo:[0,0,1] neg_hi:[0,0,1]
  v_pk_fma_f32 v[242:243], v[46:47], s[72:73], s[72:73] op_sel:[0,1,1] op_sel_hi:[1,1,1] neg_lo:[0,0,1] neg_hi:[0,0,1]
  v_exp_f32 v236, v236 clamp
  v_exp_f32 v237, v237 clamp
  v_exp_f32 v238, v238 clamp
  v_exp_f32 v239, v239 clamp
  v_exp_f32 v240, v240 clamp
  v_exp_f32 v241, v241 clamp
  v_exp_f32 v242, v242 clamp
  v_exp_f32 v243, v243 clamp
  v_max_f32 v20, v20, v236
  v_max_f32 v21, v21, v237
  v_max_f32 v22, v22, v238
  v_max_f32 v23, v23, v239
  v_max_f32 v44, v44, v240
  v_max_f32 v45, v45, v241
  v_max_f32 v46, v46, v242
  v_max_f32 v47, v47, v243
  v_pk_add_f32 v[20:21], v[20:21], s[74:75] op_sel:[0,0] op_sel_hi:[1,0]
  v_pk_add_f32 v[22:23], v[22:23], s[74:75] op_sel:[0,0] op_sel_hi:[1,0]
  v_pk_add_f32 v[44:45], v[44:45], s[74:75] op_sel:[0,0] op_sel_hi:[1,0]
  v_pk_add_f32 v[46:47], v[46:47], s[74:75] op_sel:[0,0] op_sel_hi:[1,0]
  v_cvt_pk_bf16_f32 v244, v20, v21
  v_cvt_pk_bf16_f32 v245, v22, v23
  v_cvt_pk_bf16_f32 v246, v44, v45
  v_cvt_pk_bf16_f32 v247, v46, v47
  buffer_store_dwordx4 v[244:247], v178, s[52:55], s69 offen sc0 sc1
  v_pk_fma_f32 v[212:213], v[48:49], s[72:73], s[72:73] op_sel:[0,1,1] op_sel_hi:[1,1,1] neg_lo:[0,0,1] neg_hi:[0,0,1]
  v_pk_fma_f32 v[214:215], v[50:51], s[72:73], s[72:73] op_sel:[0,1,1] op_sel_hi:[1,1,1] neg_lo:[0,0,1] neg_hi:[0,0,1]
  v_pk_fma_f32 v[216:217], v[72:73], s[72:73], s[72:73] op_sel:[0,1,1] op_sel_hi:[1,1,1] neg_lo:[0,0,1] neg_hi:[0,0,1]
  v_pk_fma_f32 v[218:219], v[74:75], s[72:73], s[72:73] op_sel:[0,1,1] op_sel_hi:[1,1,1] neg_lo:[0,0,1] neg_hi:[0,0,1]
  v_exp_f32 v212, v212 clamp
  v_exp_f32 v213, v213 clamp
  v_exp_f32 v214, v214 clamp
  v_exp_f32 v215, v215 clamp
  v_exp_f32 v216, v216 clamp
  v_exp_f32 v217, v217 clamp
  v_exp_f32 v218, v218 clamp
  v_exp_f32 v219, v219 clamp
  v_max_f32 v48, v48, v212
  v_max_f32 v49, v49, v213
  v_max_f32 v50, v50, v214
  v_max_f32 v51, v51, v215
  v_max_f32 v72, v72, v216
  v_max_f32 v73, v73, v217
  v_max_f32 v74, v74, v218
  v_max_f32 v75, v75, v219
  v_pk_add_f32 v[48:49], v[48:49], s[74:75] op_sel:[0,0] op_sel_hi:[1,0]
  v_pk_add_f32 v[50:51], v[50:51], s[74:75] op_sel:[0,0] op_sel_hi:[1,0]
  v_pk_add_f32 v[72:73], v[72:73], s[74:75] op_sel:[0,0] op_sel_hi:[1,0]
  v_pk_add_f32 v[74:75], v[74:75], s[74:75] op_sel:[0,0] op_sel_hi:[1,0]
  v_cvt_pk_bf16_f32 v220, v48, v49
  v_cvt_pk_bf16_f32 v221, v50, v51
  v_cvt_pk_bf16_f32 v222, v72, v73
  v_cvt_pk_bf16_f32 v223, v74, v75
  buffer_store_dwordx4 v[220:223], v173, s[52:55], s70 offen sc0 sc1
  v_pk_fma_f32 v[224:225], v[52:53], s[72:73], s[72:73] op_sel:[0,1,1] op_sel_hi:[1,1,1] neg_lo:[0,0,1] neg_hi:[0,0,1]
  v_pk_fma_f32 v[226:227], v[54:55], s[72:73], s[72:73] op_sel:[0,1,1] op_sel_hi:[1,1,1] neg_lo:[0,0,1] neg_hi:[0,0,1]
  v_pk_fma_f32 v[228:229], v[76:77], s[72:73], s[72:73] op_sel:[0,1,1] op_sel_hi:[1,1,1] neg_lo:[0,0,1] neg_hi:[0,0,1]
  v_pk_fma_f32 v[230:231], v[78:79], s[72:73], s[72:73] op_sel:[0,1,1] op_sel_hi:[1,1,1] neg_lo:[0,0,1] neg_hi:[0,0,1]
  v_exp_f32 v224, v224 clamp
  v_exp_f32 v225, v225 clamp
  v_exp_f32 v226, v226 clamp
  v_exp_f32 v227, v227 clamp
  v_exp_f32 v228, v228 clamp
  v_exp_f32 v229, v229 clamp
  v_exp_f32 v230, v230 clamp
  v_exp_f32 v231, v231 clamp
  v_max_f32 v52, v52, v224
  v_max_f32 v53, v53, v225
  v_max_f32 v54, v54, v226
  v_max_f32 v55, v55, v227
  v_max_f32 v76, v76, v228
  v_max_f32 v77, v77, v229
  v_max_f32 v78, v78, v230
  v_max_f32 v79, v79, v231
  v_pk_add_f32 v[52:53], v[52:53], s[74:75] op_sel:[0,0] op_sel_hi:[1,0]
  v_pk_add_f32 v[54:55], v[54:55], s[74:75] op_sel:[0,0] op_sel_hi:[1,0]
  v_pk_add_f32 v[76:77], v[76:77], s[74:75] op_sel:[0,0] op_sel_hi:[1,0]
  v_pk_add_f32 v[78:79], v[78:79], s[74:75] op_sel:[0,0] op_sel_hi:[1,0]
  v_cvt_pk_bf16_f32 v232, v52, v53
  v_cvt_pk_bf16_f32 v233, v54, v55
  v_cvt_pk_bf16_f32 v234, v76, v77
  v_cvt_pk_bf16_f32 v235, v78, v79
  buffer_store_dwordx4 v[232:235], v174, s[52:55], s70 offen sc0 sc1
  v_pk_fma_f32 v[236:237], v[56:57], s[72:73], s[72:73] op_sel:[0,1,1] op_sel_hi:[1,1,1] neg_lo:[0,0,1] neg_hi:[0,0,1]
  v_pk_fma_f32 v[238:239], v[58:59], s[72:73], s[72:73] op_sel:[0,1,1] op_sel_hi:[1,1,1] neg_lo:[0,0,1] neg_hi:[0,0,1]
  v_pk_fma_f32 v[240:241], v[80:81], s[72:73], s[72:73] op_sel:[0,1,1] op_sel_hi:[1,1,1] neg_lo:[0,0,1] neg_hi:[0,0,1]
  v_pk_fma_f32 v[242:243], v[82:83], s[72:73], s[72:73] op_sel:[0,1,1] op_sel_hi:[1,1,1] neg_lo:[0,0,1] neg_hi:[0,0,1]
  v_exp_f32 v236, v236 clamp
  v_exp_f32 v237, v237 clamp
  v_exp_f32 v238, v238 clamp
  v_exp_f32 v239, v239 clamp
  v_exp_f32 v240, v240 clamp
  v_exp_f32 v241, v241 clamp
  v_exp_f32 v242, v242 clamp
  v_exp_f32 v243, v243 clamp
  v_max_f32 v56, v56, v236
  v_max_f32 v57, v57, v237
  v_max_f32 v58, v58, v238
  v_max_f32 v59, v59, v239
  v_max_f32 v80, v80, v240
  v_max_f32 v81, v81, v241
  v_max_f32 v82, v82, v242
  v_max_f32 v83, v83, v243
  v_pk_add_f32 v[56:57], v[56:57], s[74:75] op_sel:[0,0] op_sel_hi:[1,0]
  v_pk_add_f32 v[58:59], v[58:59], s[74:75] op_sel:[0,0] op_sel_hi:[1,0]
  v_pk_add_f32 v[80:81], v[80:81], s[74:75] op_sel:[0,0] op_sel_hi:[1,0]
  v_pk_add_f32 v[82:83], v[82:83], s[74:75] op_sel:[0,0] op_sel_hi:[1,0]
  v_cvt_pk_bf16_f32 v244, v56, v57
  v_cvt_pk_bf16_f32 v245, v58, v59
  v_cvt_pk_bf16_f32 v246, v80, v81
  v_cvt_pk_bf16_f32 v247, v82, v83
  buffer_store_dwordx4 v[244:247], v175, s[52:55], s70 offen sc0 sc1
  v_pk_fma_f32 v[212:213], v[60:61], s[72:73], s[72:73] op_sel:[0,1,1] op_sel_hi:[1,1,1] neg_lo:[0,0,1] neg_hi:[0,0,1]
  v_pk_fma_f32 v[214:215], v[62:63], s[72:73], s[72:73] op_sel:[0,1,1] op_sel_hi:[1,1,1] neg_lo:[0,0,1] neg_hi:[0,0,1]
  v_pk_fma_f32 v[216:217], v[84:85], s[72:73], s[72:73] op_sel:[0,1,1] op_sel_hi:[1,1,1] neg_lo:[0,0,1] neg_hi:[0,0,1]
  v_pk_fma_f32 v[218:219], v[86:87], s[72:73], s[72:73] op_sel:[0,1,1] op_sel_hi:[1,1,1] neg_lo:[0,0,1] neg_hi:[0,0,1]
  v_exp_f32 v212, v212 clamp
  v_exp_f32 v213, v213 clamp
  v_exp_f32 v214, v214 clamp
  v_exp_f32 v215, v215 clamp
  v_exp_f32 v216, v216 clamp
  v_exp_f32 v217, v217 clamp
  v_exp_f32 v218, v218 clamp
  v_exp_f32 v219, v219 clamp
  v_max_f32 v60, v60, v212
  v_max_f32 v61, v61, v213
  v_max_f32 v62, v62, v214
  v_max_f32 v63, v63, v215
  v_max_f32 v84, v84, v216
  v_max_f32 v85, v85, v217
  v_max_f32 v86, v86, v218
  v_max_f32 v87, v87, v219
  v_pk_add_f32 v[60:61], v[60:61], s[74:75] op_sel:[0,0] op_sel_hi:[1,0]
  v_pk_add_f32 v[62:63], v[62:63], s[74:75] op_sel:[0,0] op_sel_hi:[1,0]
  v_pk_add_f32 v[84:85], v[84:85], s[74:75] op_sel:[0,0] op_sel_hi:[1,0]
  v_pk_add_f32 v[86:87], v[86:87], s[74:75] op_sel:[0,0] op_sel_hi:[1,0]
  v_cvt_pk_bf16_f32 v220, v60, v61
  v_cvt_pk_bf16_f32 v221, v62, v63
  v_cvt_pk_bf16_f32 v222, v84, v85
  v_cvt_pk_bf16_f32 v223, v86, v87
  buffer_store_dwordx4 v[220:223], v176, s[52:55], s70 offen sc0 sc1
  v_pk_fma_f32 v[224:225], v[64:65], s[72:73], s[72:73] op_sel:[0,1,1] op_sel_hi:[1,1,1] neg_lo:[0,0,1] neg_hi:[0,0,1]
  v_pk_fma_f32 v[226:227], v[66:67], s[72:73], s[72:73] op_sel:[0,1,1] op_sel_hi:[1,1,1] neg_lo:[0,0,1] neg_hi:[0,0,1]
  v_pk_fma_f32 v[228:229], v[88:89], s[72:73], s[72:73] op_sel:[0,1,1] op_sel_hi:[1,1,1] neg_lo:[0,0,1] neg_hi:[0,0,1]
  v_pk_fma_f32 v[230:231], v[90:91], s[72:73], s[72:73] op_sel:[0,1,1] op_sel_hi:[1,1,1] neg_lo:[0,0,1] neg_hi:[0,0,1]
  v_exp_f32 v224, v224 clamp
  v_exp_f32 v225, v225 clamp
  v_exp_f32 v226, v226 clamp
  v_exp_f32 v227, v227 clamp
  v_exp_f32 v228, v228 clamp
  v_exp_f32 v229, v229 clamp
  v_exp_f32 v230, v230 clamp
  v_exp_f32 v231, v231 clamp
  v_max_f32 v64, v64, v224
  v_max_f32 v65, v65, v225
  v_max_f32 v66, v66, v226
  v_max_f32 v67, v67, v227
  v_max_f32 v88, v88, v228
  v_max_f32 v89, v89, v229
  v_max_f32 v90, v90, v230
  v_max_f32 v91, v91, v231
  v_pk_add_f32 v[64:65], v[64:65], s[74:75] op_sel:[0,0] op_sel_hi:[1,0]
  v_pk_add_f32 v[66:67], v[66:67], s[74:75] op_sel:[0,0] op_sel_hi:[1,0]
  v_pk_add_f32 v[88:89], v[88:89], s[74:75] op_sel:[0,0] op_sel_hi:[1,0]
  v_pk_add_f32 v[90:91], v[90:91], s[74:75] op_sel:[0,0] op_sel_hi:[1,0]
  v_cvt_pk_bf16_f32 v232, v64, v65
  v_cvt_pk_bf16_f32 v233, v66, v67
  v_cvt_pk_bf16_f32 v234, v88, v89
  v_cvt_pk_bf16_f32 v235, v90, v91
  buffer_store_dwordx4 v[232:235], v177, s[52:55], s70 offen sc0 sc1
  v_pk_fma_f32 v[236:237], v[68:69], s[72:73], s[72:73] op_sel:[0,1,1] op_sel_hi:[1,1,1] neg_lo:[0,0,1] neg_hi:[0,0,1]
  v_pk_fma_f32 v[238:239], v[70:71], s[72:73], s[72:73] op_sel:[0,1,1] op_sel_hi:[1,1,1] neg_lo:[0,0,1] neg_hi:[0,0,1]
  v_pk_fma_f32 v[240:241], v[92:93], s[72:73], s[72:73] op_sel:[0,1,1] op_sel_hi:[1,1,1] neg_lo:[0,0,1] neg_hi:[0,0,1]
  v_pk_fma_f32 v[242:243], v[94:95], s[72:73], s[72:73] op_sel:[0,1,1] op_sel_hi:[1,1,1] neg_lo:[0,0,1] neg_hi:[0,0,1]
  v_exp_f32 v236, v236 clamp
  v_exp_f32 v237, v237 clamp
  v_exp_f32 v238, v238 clamp
  v_exp_f32 v239, v239 clamp
  v_exp_f32 v240, v240 clamp
  v_exp_f32 v241, v241 clamp
  v_exp_f32 v242, v242 clamp
  v_exp_f32 v243, v243 clamp
  v_max_f32 v68, v68, v236
  v_max_f32 v69, v69, v237
  v_max_f32 v70, v70, v238
  v_max_f32 v71, v71, v239
  v_max_f32 v92, v92, v240
  v_max_f32 v93, v93, v241
  v_max_f32 v94, v94, v242
  v_max_f32 v95, v95, v243
  v_pk_add_f32 v[68:69], v[68:69], s[74:75] op_sel:[0,0] op_sel_hi:[1,0]
  v_pk_add_f32 v[70:71], v[70:71], s[74:75] op_sel:[0,0] op_sel_hi:[1,0]
  v_pk_add_f32 v[92:93], v[92:93], s[74:75] op_sel:[0,0] op_sel_hi:[1,0]
  v_pk_add_f32 v[94:95], v[94:95], s[74:75] op_sel:[0,0] op_sel_hi:[1,0]
  v_cvt_pk_bf16_f32 v244, v68, v69
  v_cvt_pk_bf16_f32 v245, v70, v71
  v_cvt_pk_bf16_f32 v246, v92, v93
  v_cvt_pk_bf16_f32 v247, v94, v95
  buffer_store_dwordx4 v[244:247], v178, s[52:55], s70 offen sc0 sc1
  s_branch L_p2
L1_exit:
  s_endpgm
L_wret:
  s_mov_b64 exec, -1
  s_cmp_eq_u32 s98, 4
  s_cbranch_scc1 L_wr_kv
  s_cmp_eq_u32 s98, 1
  s_cbranch_scc1 L_wr_q
  s_endpgm
.p2align 6
L_p2:
  v_mbcnt_lo_u32_b32 v0, -1, 0
  v_mbcnt_hi_u32_b32 v0, -1, v0
  s_mov_b32 s52, s42
  s_and_b32 s53, s43, 0xffff
  s_mov_b32 s54, 9764864
  s_mov_b32 s55, 0x20000
  s_and_b32 s3, s64, 3
  s_lshr_b32 s4, s64, 2
  v_lshlrev_b32 v3, 4, v0
  v_lshlrev_b32 v15, 3, v0
  v_mov_b32 v38, 1
  v_mov_b64 v[252:253], 0
  s_mul_i32 s67, s3, 20736
  s_add_u32 s67, s67, s96
  s_sub_u32 s9, s96, 64
  v_mov_b32 v39, s9
  s_mov_b32 s49, 0
  s_cmp_eq_u32 s4, 1
  s_cselect_b32 s75, 1, 0
  s_cbranch_scc0 L_nd_57
  s_bfe_u32 s8, s2, 0x10002
  s_lshl_b32 s8, s8, 4
  s_lshr_b32 s7, s2, 7
  s_lshl_b32 s7, s7, 3
  s_add_u32 s7, s7, s8
  s_add_u32 s7, s7, s64
  s_mul_i32 s73, s7, 20736
  s_add_u32 s73, s73, 6291456
  s_cmp_eq_u32 s97, 0
  s_cbranch_scc1 L_own_58
  s_and_b32 s7, s7, 24
  s_mul_i32 s74, s7, 20736
  s_lshl_b32 s8, s3, 10
  s_add_u32 s74, s74, s8
  s_add_u32 s74, s74, 6291456
  s_add_u32 s8, s8, s96
  s_add_u32 m0, s8, 0
  s_add_u32 s77, s74, 0
  buffer_load_dwordx4 v3, s[52:55], s77 offen sc1 lds
  s_add_u32 m0, s8, 4096
  s_add_u32 s77, s74, 4096
  buffer_load_dwordx4 v3, s[52:55], s77 offen sc1 lds
  s_add_u32 m0, s8, 8192
  s_add_u32 s77, s74, 8192
  buffer_load_dwordx4 v3, s[52:55], s77 offen sc1 lds
  s_add_u32 m0, s8, 12288
  s_add_u32 s77, s74, 12288
  buffer_load_dwordx4 v3, s[52:55], s77 offen sc1 lds
  s_add_u32 m0, s8, 16384
  s_add_u32 s77, s74, 16384
  buffer_load_dwordx4 v3, s[52:55], s77 offen sc1 lds
  s_add_u32 m0, s8, 20480
  s_add_u32 s77, s74, 20480
  buffer_load_dwordx4 v3, s[52:55], s77 offen sc1 lds
  s_cmp_lg_u32 s101, 1
  s_cbranch_scc1 L_n8_60
  s_waitcnt vmcnt(6) lgkmcnt(0)
  s_barrier
L_n8_60:
  v_mov_b32 v37, 0xff
  ds_write_b32 v39, v37 offset:12
  s_setprio 0
  v_mov_b32 v37, 0
  buffer_load_dword v10, v37, s[56:59], 0 offen offset:128 sc1
  s_add_u32 m0, s8, 24576
  s_add_u32 s77, s74, 24576
  buffer_load_dwordx4 v3, s[52:55], s77 offen sc1 lds
  s_add_u32 m0, s8, 28672
  s_add_u32 s77, s74, 28672
  buffer_load_dwordx4 v3, s[52:55], s77 offen sc1 lds
  s_add_u32 m0, s8, 32768
  s_add_u32 s77, s74, 32768
  buffer_load_dwordx4 v3, s[52:55], s77 offen sc1 lds
  s_add_u32 m0, s8, 36864
  s_add_u32 s77, s74, 36864
  buffer_load_dwordx4 v3, s[52:55], s77 offen sc1 lds
  s_add_u32 m0, s8, 40960
  s_add_u32 s77, s74, 40960
  buffer_load_dwordx4 v3, s[52:55], s77 offen sc1 lds
  s_add_u32 m0, s8, 45056
  s_add_u32 s77, s74, 45056
  buffer_load_dwordx4 v3, s[52:55], s77 offen sc1 lds
  s_add_u32 m0, s8, 49152
  s_add_u32 s77, s74, 49152
  buffer_load_dwordx4 v3, s[52:55], s77 offen sc1 lds
  s_add_u32 m0, s8, 53248
  s_add_u32 s77, s74, 53248
  buffer_load_dwordx4 v3, s[52:55], s77 offen sc1 lds
  s_add_u32 m0, s8, 57344
  s_add_u32 s77, s74, 57344
  buffer_load_dwordx4 v3, s[52:55], s77 offen sc1 lds
  s_mov_b32 s10, 0
  s_waitcnt vmcnt(9)
L_zp_62:
  v_readfirstlane_b32 s9, v10
  s_cmp_ge_u32 s9, 8
  s_cbranch_scc1 L_ze_63
  s_add_u32 s10, s10, 1
  s_cmp_gt_u32 s10, 8192
  s_cbranch_scc1 L_ze_63

  buffer_load_dword v10, v37, s[56:59], 0 offen offset:128 sc0 sc1
  s_waitcnt vmcnt(0)
  s_branch L_zp_62
L_ze_63:
  s_branch L_g_64
L_own_58:
  s_add_u32 s77, s73, 0
  buffer_load_dwordx4 v[172:175], v3, s[52:55], s77 offen offset:0 sc1
  buffer_load_dwordx4 v[176:179], v3, s[52:55], s77 offen offset:1024 sc1
  buffer_load_dwordx4 v[180:183], v3, s[52:55], s77 offen offset:2048 sc1
  buffer_load_dwordx4 v[184:187], v3, s[52:55], s77 offen offset:3072 sc1
  s_add_u32 s77, s73, 4096
  buffer_load_dwordx4 v[188:191], v3, s[52:55], s77 offen offset:0 sc1
  buffer_load_dwordx4 v[192:195], v3, s[52:55], s77 offen offset:1024 sc1
  buffer_load_dwordx4 v[196:199], v3, s[52:55], s77 offen offset:2048 sc1
  buffer_load_dwordx4 v[200:203], v3, s[52:55], s77 offen offset:3072 sc1
  s_add_u32 s77, s73, 8192
  buffer_load_dwordx4 v[204:207], v3, s[52:55], s77 offen offset:0 sc1
  buffer_load_dwordx4 v[208:211], v3, s[52:55], s77 offen offset:1024 sc1
  buffer_load_dwordx4 v[212:215], v3, s[52:55], s77 offen offset:2048 sc1
  buffer_load_dwordx4 v[216:219], v3, s[52:55], s77 offen offset:3072 sc1
  s_add_u32 s77, s73, 12288
  buffer_load_dwordx4 v[220:223], v3, s[52:55], s77 offen offset:0 sc1
  buffer_load_dwordx4 v[224:227], v3, s[52:55], s77 offen offset:1024 sc1
  buffer_load_dwordx4 v[228:231], v3, s[52:55], s77 offen offset:2048 sc1
  buffer_load_dwordx4 v[232:235], v3, s[52:55], s77 offen offset:3072 sc1
  s_add_u32 s77, s73, 16384
  buffer_load_dwordx4 v[236:239], v3, s[52:55], s77 offen offset:0 sc1
  buffer_load_dwordx4 v[240:243], v3, s[52:55], s77 offen offset:1024 sc1
  buffer_load_dwordx4 v[244:247], v3, s[52:55], s77 offen offset:2048 sc1
  buffer_load_dwordx4 v[248:251], v3, s[52:55], s77 offen offset:3072 sc1
  s_add_u32 s77, s73, 20480
  s_mov_b32 exec_hi, 0
  buffer_load_dwordx2 v[252:253], v15, s[52:55], s77 offen sc1
  s_mov_b64 exec, -1
  s_waitcnt vmcnt(21)
  v_mov_b32 v36, s91
  s_mov_b64 exec, 1
  ds_add_u32 v39, v36
  s_mov_b64 exec, -1
  s_cmp_eq_u32 s98, 0
  s_cbranch_scc1 L_ns_65
  v_mov_b32 v36, 16
  v_lshlrev_b32 v37, 8, v0
  s_mov_b64 exec, 1
  s_cmp_eq_u32 s98, 1
  s_cbranch_scc1 L_s2_66
  ds_add_rtn_u32 v35, v39, v38 offset:4
  s_sub_u32 s10, s98, 1
  s_waitcnt lgkmcnt(0)
  v_readfirstlane_b32 s9, v35
  s_cmp_lg_u32 s9, s10
  s_cbranch_scc1 L_sx_67

  s_cmp_eq_u32 s99, 0
  s_cbranch_scc1 L_s2_66
  s_mov_b64 exec, 0xffff
  buffer_atomic_add v38, v37, s[52:55], s100 offen sc1
  s_branch L_sx_67
L_s2_66:
  buffer_store_dword v36, v37, s[52:55], s100 offen sc0 sc1
L_sx_67:
  s_mov_b64 exec, -1
L_ns_65:
  s_branch L_nd_57
L_g_64:
  s_add_u32 s77, s73, 0
  s_waitcnt vmcnt(6)
  buffer_load_dwordx4 v[172:175], v3, s[52:55], s77 offen offset:0 sc1
  s_waitcnt vmcnt(6)
  buffer_load_dwordx4 v[176:179], v3, s[52:55], s77 offen offset:1024 sc1
  s_waitcnt vmcnt(6)
  buffer_load_dwordx4 v[180:183], v3, s[52:55], s77 offen offset:2048 sc1
  s_waitcnt vmcnt(6)
  buffer_load_dwordx4 v[184:187], v3, s[52:55], s77 offen offset:3072 sc1
  s_add_u32 s77, s73, 4096
  s_waitcnt vmcnt(6)
  buffer_load_dwordx4 v[188:191], v3, s[52:55], s77 offen offset:0 sc1
  s_waitcnt vmcnt(6)
  buffer_load_dwordx4 v[192:195], v3, s[52:55], s77 offen offset:1024 sc1
  s_waitcnt vmcnt(6)
  buffer_load_dwordx4 v[196:199], v3, s[52:55], s77 offen offset:2048 sc1
  s_waitcnt vmcnt(6)
  buffer_load_dwordx4 v[200:203], v3, s[52:55], s77 offen offset:3072 sc1
  s_add_u32 s77, s73, 8192
  s_waitcnt vmcnt(6)
  buffer_load_dwordx4 v[204:207], v3, s[52:55], s77 offen offset:0 sc1
  s_waitcnt vmcnt(6)
  buffer_load_dwordx4 v[208:211], v3, s[52:55], s77 offen offset:1024 sc1
  s_waitcnt vmcnt(6)
  buffer_load_dwordx4 v[212:215], v3, s[52:55], s77 offen offset:2048 sc1
  s_waitcnt vmcnt(6)
  buffer_load_dwordx4 v[216:219], v3, s[52:55], s77 offen offset:3072 sc1
  s_add_u32 s77, s73, 12288
  s_waitcnt vmcnt(6)
  buffer_load_dwordx4 v[220:223], v3, s[52:55], s77 offen offset:0 sc1
  s_waitcnt vmcnt(6)
  buffer_load_dwordx4 v[224:227], v3, s[52:55], s77 offen offset:1024 sc1
  s_waitcnt vmcnt(6)
  buffer_load_dwordx4 v[228:231], v3, s[52:55], s77 offen offset:2048 sc1
  s_waitcnt vmcnt(6)
  buffer_load_dwordx4 v[232:235], v3, s[52:55], s77 offen offset:3072 sc1
  s_add_u32 s77, s73, 16384
  s_waitcnt vmcnt(6)
  buffer_load_dwordx4 v[236:239], v3, s[52:55], s77 offen offset:0 sc1
  s_waitcnt vmcnt(6)
  buffer_load_dwordx4 v[240:243], v3, s[52:55], s77 offen offset:1024 sc1
  s_waitcnt vmcnt(6)
  buffer_load_dwordx4 v[244:247], v3, s[52:55], s77 offen offset:2048 sc1
  s_waitcnt vmcnt(6)
  buffer_load_dwordx4 v[248:251], v3, s[52:55], s77 offen offset:3072 sc1
  s_add_u32 s77, s73, 20480
  s_waitcnt vmcnt(6)
  s_mov_b32 exec_hi, 0
  buffer_load_dwordx2 v[252:253], v15, s[52:55], s77 offen sc1
  s_mov_b64 exec, -1
  s_mov_b32 s10, 0
L_lw_69:
  ds_read_b32 v35, v39 offset:0
L_l1_71:
  s_add_u32 s10, s10, 1
  s_waitcnt lgkmcnt(0)
  v_readfirstlane_b32 s9, v35
  s_cmp_gt_u32 s10, 8192
  s_cbranch_scc1 L_le_70
  s_and_b32 s9, s9, 0xff
  s_cmp_lt_u32 s9, 4
  s_cbranch_scc1 L_lw_69
L_le_70:
  s_add_u32 m0, s8, 61440
  s_add_u32 s77, s74, 61440
  buffer_load_dwordx4 v3, s[52:55], s77 offen sc1 lds
  s_add_u32 m0, s8, 65536
  s_add_u32 s77, s74, 65536
  buffer_load_dwordx4 v3, s[52:55], s77 offen sc1 lds
  s_add_u32 m0, s8, 69632
  s_add_u32 s77, s74, 69632
  buffer_load_dwordx4 v3, s[52:55], s77 offen sc1 lds
  s_add_u32 m0, s8, 73728
  s_add_u32 s77, s74, 73728
  buffer_load_dwordx4 v3, s[52:55], s77 offen sc1 lds
  s_add_u32 m0, s8, 77824
  s_add_u32 s77, s74, 77824
  buffer_load_dwordx4 v3, s[52:55], s77 offen sc1 lds
  s_cmp_lg_u32 s3, 0
  s_cbranch_scc1 L_d_61
  s_add_u32 m0, s8, 81920
  s_add_u32 s77, s74, 81920
  buffer_load_dwordx4 v3, s[52:55], s77 offen sc1 lds
L_d_61:
  s_branch L_es_72
L_nd_57:
  s_cmp_eq_u32 s97, 0
  s_cbranch_scc1 L_es_72
  s_mov_b32 s10, 0
L_lw_73:
  ds_read_b32 v35, v39 offset:12
L_l1_75:
  s_add_u32 s10, s10, 1
  s_waitcnt lgkmcnt(0)
  v_readfirstlane_b32 s9, v35
  s_cmp_gt_u32 s10, 8192
  s_cbranch_scc1 L_le_74
  s_cmp_lt_u32 s9, 1
  s_cbranch_scc1 L_lw_73
L_le_74:
  s_waitcnt vmcnt(0)
  s_cmp_eq_u32 s98, 0
  s_cbranch_scc1 L_ns_76
  v_mov_b32 v36, 16
  v_lshlrev_b32 v37, 8, v0
  s_mov_b64 exec, 1
  s_cmp_eq_u32 s98, 1
  s_cbranch_scc1 L_s2_77
  ds_add_rtn_u32 v35, v39, v38 offset:4
  s_sub_u32 s10, s98, 1
  s_waitcnt lgkmcnt(0)
  v_readfirstlane_b32 s9, v35
  s_cmp_lg_u32 s9, s10
  s_cbranch_scc1 L_sx_78

  s_cmp_eq_u32 s99, 0
  s_cbranch_scc1 L_s2_77
  s_mov_b64 exec, 0xffff
  buffer_atomic_add v38, v37, s[52:55], s100 offen sc1
  s_branch L_sx_78
L_s2_77:
  buffer_store_dword v36, v37, s[52:55], s100 offen sc0 sc1
L_sx_78:
  s_mov_b64 exec, -1
L_ns_76:
  s_setprio 0
L_es_72:
  v_lshrrev_b32 v2, 4, v0
  s_and_b32 s7, s2, 3
  s_lshl_b32 s7, s7, 4
  s_bfe_u32 s5, s2, 0x40003
  s_add_u32 s5, s5, s7
  v_and_b32 v1, 15, v0
  v_and_b32 v35, 3, v0
  v_add_u32 v36, 8, v35
  v_min_u32 v36, v36, v1
  v_mul_u32_u24 v4, 192, v2
  v_lshl_add_u32 v4, v36, 4, v4
  v_lshrrev_b32 v36, 1, v36
  v_lshlrev_b32 v36, 4, v36
  v_add_u32 v36, 512, v36
  v_cmp_gt_u32 vcc, 32, v0
  v_and_b32 v6, 511, v3
  v_lshlrev_b32 v7, 2, v1
  v_cndmask_b32 v5, v36, v3, vcc
  s_mul_i32 s11, s64, 6144
  s_add_u32 s11, s11, 2359296
  s_add_u32 s12, s11, 4096
  s_mul_i32 s7, s5, 36864
  s_mul_i32 s8, s64, 4608
  s_add_u32 s13, s7, s8
  s_add_u32 s14, s13, 4096
  s_lshl_b32 s7, s5, 1
  s_add_u32 s7, s7, s4
  s_lshl_b32 s15, s7, 6
  s_lshl_b32 s8, s64, 13
  s_add_u32 s15, s15, s8
  s_add_u32 s15, s15, 2424832
  s_xor_b32 s60, s15, 64
  s_mul_i32 s7, s64, 16
  s_and_b32 s8, s2, 15
  s_add_u32 s7, s7, s8
  s_lshl_b32 s7, s7, 8
  s_add_u32 s7, s7, 4849664
  v_mov_b32 v8, s7
  s_lshr_b32 s7, s5, 1
  s_mul_i32 s7, s7, 6
  s_add_u32 s7, s7, 19072
  s_mul_i32 s8, s64, 3
  s_add_u32 s9, s8, 2
  s_lshr_b32 s8, s8, 2
  s_lshr_b32 s9, s9, 2
  s_add_u32 s8, s8, s7
  s_add_u32 s9, s9, s7
  s_lshl_b32 s8, s8, 8
  s_lshl_b32 s9, s9, 8
  v_writelane_b32 v8, s8, 1
  v_writelane_b32 v8, s9, 2
  s_cmp_lg_u32 s97, 0
  s_cbranch_scc1 L_q_80
  v_mov_b32 v10, 0
  s_mov_b64 exec, 7
  v_mov_b32 v10, 0
  buffer_atomic_add v10, v8, s[52:55], 0 offen sc0 sc1
  s_mov_b64 exec, -1
L_q_80:
  s_mov_b32 s84, 0x11111111
  s_mov_b32 s85, 0x11111111
  s_lshl_b64 s[86:87], s[84:85], 1
  s_lshl_b64 s[88:89], s[84:85], 2
  s_lshl_b64 s[24:25], s[84:85], 3
  s_mov_b64 s[26:27], 0xffff
  s_lshl_b64 s[28:29], s[26:27], 16
  s_mov_b32 s30, 0x0
  s_mov_b32 s31, 0x44441111
  s_lshl_b64 s[32:33], s[30:31], 1
  v_mov_b32 v48, 0
  v_mov_b32 v54, 0
  v_mov_b32 v60, 0
  v_mov_b32 v66, 0
  v_mov_b32 v72, 0
  v_mov_b32 v77, 0
  v_mov_b32 v78, 0
  v_mov_b32 v83, 0
  v_mov_b32 v84, 0
  v_mov_b32 v89, 0
  v_mov_b32 v90, 0
  v_mov_b32 v95, 0
  v_mov_b32 v85, 0
  v_mov_b32 v88, 0
  v_mov_b32 v91, 0
  v_mov_b32 v94, 0
  v_mov_b32 v96, 0
  v_mov_b32 v121, 0
  v_mov_b64 v[166:167], 0
  v_mov_b64 v[168:169], 0
  v_mov_b64 v[170:171], 0
  v_mov_b64 v[44:45], 0
  v_mov_b64 v[46:47], 0
  s_mov_b32 exec_lo, 0
  v_mov_b32 v44, 0x358637bd
  v_mov_b32 v45, 0x358637bd
  v_mov_b32 v46, 0x358637bd
  v_mov_b32 v47, 0x358637bd
  s_mov_b64 exec, -1
  s_bfe_u32 s8, s2, 0x10002
  s_mul_i32 s8, s8, 288
  s_lshr_b32 s7, s2, 7
  s_mul_i32 s6, s7, 160
  s_add_u32 s6, s6, s8
  s_add_u32 s70, s8, 128
  s_add_u32 s76, s96, 82944
  s_cmp_eq_u32 s75, 1
  s_cselect_b32 s8, 15328, 0
  s_cselect_b32 s7, s76, 0
  s_xor_b32 s8, s8, 8672
  v_lshl_add_u32 v33, s4, 2, v39
  v_mov_b32 v34, 1
  s_xor_b32 s77, s3, 1
  s_mul_i32 s77, s77, s8
  s_add_u32 s77, s77, s7
  v_add_u32 v18, s77, v3
  s_xor_b32 s77, s3, 2
  s_mul_i32 s77, s77, s8
  s_add_u32 s77, s77, s7
  v_add_u32 v19, s77, v3
  s_xor_b32 s77, s3, 3
  s_mul_i32 s77, s77, s8
  s_add_u32 s77, s77, s7
  v_add_u32 v20, s77, v3
  v_mul_u32_u24 v21, s8, v2
  v_lshl_add_u32 v21, v1, 4, v21
  v_add_u32 v21, s7, v21
  s_mul_i32 s9, s3, s8
  s_add_u32 s9, s9, s7
  v_add_u32 v16, s9, v3
  v_lshlrev_b32 v22, 3, v2
  v_lshl_add_u32 v22, v1, 4, v22
  v_add_u32 v22, s9, v22
  s_lshr_b32 s7, s6, 3
  s_lshl_b32 s8, s3, 2
  s_add_u32 s7, s7, s8
  v_add_u32 v9, s7, v0
  s_lshr_b32 s7, s70, 3
  s_sub_u32 s7, s7, 4
  s_mov_b64 exec, 0xf0
  v_add_u32 v9, s7, v0
  s_mov_b64 exec, -1
  s_and_b32 s7, s2, 0
  s_lshl_b32 s7, s7, 8
  s_add_u32 s7, s7, 4931584
  v_lshl_add_u32 v9, v9, 8, s7
  s_mov_b32 s76, 0
  s_cmp_eq_u32 s75, 1
  s_cbranch_scc1 L_w_81
  s_cmp_eq_u32 s97, 0
  s_cbranch_scc1 L_w1_82
  s_branch L_c1x
L_w1_82:
  s_waitcnt vmcnt(1)
  s_cmp_eq_u32 s98, 0
  s_cbranch_scc1 L_ns_84
  v_mov_b32 v36, 16
  v_lshlrev_b32 v37, 8, v0
  s_mov_b64 exec, 1
  s_cmp_eq_u32 s98, 1
  s_cbranch_scc1 L_s2_85
  ds_add_rtn_u32 v35, v39, v38 offset:4
  s_sub_u32 s10, s98, 1
  s_waitcnt lgkmcnt(0)
  v_readfirstlane_b32 s9, v35
  s_cmp_lg_u32 s9, s10
  s_cbranch_scc1 L_sy_87

  s_cmp_eq_u32 s99, 0
  s_cbranch_scc1 L_s2_85
  s_mov_b64 exec, 0xffff
  buffer_atomic_add v38, v37, s[52:55], s100 offen sc1
  s_branch L_sx_86
L_sy_87:
  s_waitcnt vmcnt(0)
  s_branch L_sx_86
L_s2_85:
  buffer_store_dword v36, v37, s[52:55], s100 offen sc0 sc1
L_sx_86:
  s_mov_b64 exec, -1
L_ns_84:
  s_cmp_lg_u32 s97, 0
  s_cbranch_scc1 L_w_81
  s_waitcnt vmcnt(1)
L_sig2:
  v_cmp_gt_u32 vcc, 16, v10
  s_nop 0
  s_and_b32 s9, vcc_lo, 7
  s_cbranch_scc1 L_rp
  s_mov_b32 s49, 1
  buffer_load_dwordx4 v[130:133], v6, s[52:55], s14 offen sc1
  buffer_load_dwordx4 v[98:101], v3, s[52:55], s13 offen offset:0 sc1
  buffer_load_dwordx4 v[104:107], v3, s[52:55], s13 offen offset:1024 sc1
  buffer_load_dwordx4 v[110:113], v3, s[52:55], s13 offen offset:2048 sc1
  buffer_load_dwordx4 v[116:119], v3, s[52:55], s13 offen offset:3072 sc1
  buffer_load_dwordx4 v[122:125], v4, s[52:55], s12 offen offset:0 sc1
  buffer_load_dwordx4 v[126:129], v5, s[52:55], s12 offen offset:768 sc1
  buffer_load_dword v41, v7, s[52:55], s60 offen sc1
  buffer_load_dword v40, v7, s[52:55], s15 offen sc1
  buffer_load_dwordx4 v[50:53], v3, s[52:55], s11 offen offset:0 sc1
  buffer_load_dwordx4 v[56:59], v3, s[52:55], s11 offen offset:1024 sc1
  buffer_load_dwordx4 v[62:65], v3, s[52:55], s11 offen offset:2048 sc1
  buffer_load_dwordx4 v[68:71], v3, s[52:55], s11 offen offset:3072 sc1
  s_branch L_w_81
L_rp:
  s_mov_b64 exec, 7
  v_mov_b32 v10, 0
  buffer_atomic_add v10, v8, s[52:55], 0 offen sc0 sc1
  s_mov_b64 exec, -1
L_w_81:
  s_setprio 0
  s_cmp_eq_u32 s75, 1
  s_cbranch_scc0 L_c1_88
  s_cmp_eq_u32 s97, 0
  s_cbranch_scc1 L_c3_90
  s_waitcnt vmcnt(0)
  v_mov_b32 v36, s91
  s_mov_b64 exec, 1
  ds_add_u32 v39, v36
  s_mov_b64 exec, -1
  s_mov_b32 s10, 0
L_cw_92:
  ds_read_b32 v35, v39
  s_add_u32 s10, s10, 1
  s_cmp_gt_u32 s10, 8192
  s_cbranch_scc1 L_ce_93
  s_waitcnt lgkmcnt(0)
  v_readfirstlane_b32 s9, v35
  s_cmp_eq_u32 s9, 0x404
  s_cbranch_scc1 L_ce_93
  s_sleep 1
  s_branch L_cw_92
L_ce_93:
  s_mov_b64 exec, 7
  v_mov_b32 v10, 0
  buffer_atomic_add v10, v8, s[52:55], 0 offen sc0 sc1
  s_mov_b64 exec, -1
  s_branch L_c2_89
L_c3_90:
  s_mov_b32 s10, 0
L_cw_94:
  ds_read_b32 v35, v39
  s_add_u32 s10, s10, 1
  s_cmp_gt_u32 s10, 8192
  s_cbranch_scc1 L_ce_95
  s_waitcnt lgkmcnt(0)
  v_readfirstlane_b32 s9, v35
  s_cmp_eq_u32 s9, 0x404
  s_cbranch_scc1 L_ce_95
  s_sleep 1
  s_branch L_cw_94
L_ce_95:
  s_branch L_c2_89
L_c1_88:
L_c1x:
  s_mov_b32 s10, 0
L_cw_96:
  ds_read_b32 v35, v39
  s_add_u32 s10, s10, 1
  s_cmp_gt_u32 s10, 8192
  s_cbranch_scc1 L_ce_97
  s_waitcnt lgkmcnt(0)
  v_readfirstlane_b32 s9, v35
  s_cmp_eq_u32 s9, 0x404
  s_cbranch_scc1 L_ce_97
  s_sleep 1
  s_branch L_cw_96
L_ce_97:
  s_cmp_eq_u32 s97, 0
  s_cbranch_scc1 L_c4_91
  s_mov_b64 exec, 7
  v_mov_b32 v10, 0
  buffer_atomic_add v10, v8, s[52:55], 0 offen sc0 sc1
  s_mov_b64 exec, -1
L_c4_91:
  v_add_u32 v12, s67, v3
  v_add_u32 v15, s67, v15
  ds_read_b128 v[172:175], v12 offset:0
  ds_read_b128 v[176:179], v12 offset:1024
  ds_read_b128 v[180:183], v12 offset:2048
  ds_read_b128 v[184:187], v12 offset:3072
  ds_read_b128 v[188:191], v12 offset:4096
  ds_read_b128 v[192:195], v12 offset:5120
  ds_read_b128 v[196:199], v12 offset:6144
  ds_read_b128 v[200:203], v12 offset:7168
  ds_read_b128 v[204:207], v12 offset:8192
  ds_read_b128 v[208:211], v12 offset:9216
  ds_read_b128 v[212:215], v12 offset:10240
  ds_read_b128 v[216:219], v12 offset:11264
  ds_read_b128 v[220:223], v12 offset:12288
  ds_read_b128 v[224:227], v12 offset:13312
  ds_read_b128 v[228:231], v12 offset:14336
  ds_read_b128 v[232:235], v12 offset:15360
  ds_read_b128 v[236:239], v12 offset:16384
  ds_read_b128 v[240:243], v12 offset:17408
  ds_read_b128 v[244:247], v12 offset:18432
  ds_read_b128 v[248:251], v12 offset:19456
  s_mov_b32 exec_hi, 0
  ds_read_b64 v[252:253], v15 offset:20480
  s_mov_b64 exec, 1
  ds_add_u32 v39, v38 offset:36
  s_mov_b64 exec, -1
  s_setprio 2
  s_cmp_eq_u32 s49, 1
  s_cbranch_scc1 L_late
L_c2_89:
  s_setprio 0
  s_mov_b32 s10, 0
  s_mov_b64 exec, 0x7
L_pp_98:
  s_waitcnt vmcnt(0)
  v_cmp_gt_u32 vcc, 16, v10
  s_nop 0
  s_and_b32 s9, vcc_lo, 0x6
  s_cbranch_scc0 L_pe_99
  v_mov_b32 v10, 0
  buffer_atomic_add v10, v8, s[52:55], 0 offen sc0 sc1
  s_add_u32 s10, s10, 1
  s_cmp_lt_u32 s10, 8192
  s_cbranch_scc1 L_pp_98
L_pe_99:
  s_mov_b64 exec, -1
  buffer_load_dwordx4 v[130:133], v6, s[52:55], s14 offen sc1
  buffer_load_dwordx4 v[98:101], v3, s[52:55], s13 offen offset:0 sc1
  buffer_load_dwordx4 v[104:107], v3, s[52:55], s13 offen offset:1024 sc1
  buffer_load_dwordx4 v[110:113], v3, s[52:55], s13 offen offset:2048 sc1
  buffer_load_dwordx4 v[116:119], v3, s[52:55], s13 offen offset:3072 sc1
  s_bitcmp0_b32 vcc_lo, 0
  s_cbranch_scc1 L_kv_101
  s_mov_b32 s10, 0
  s_mov_b64 exec, 0x1
  v_mov_b32 v140, 0
  buffer_atomic_add v140, v8, s[52:55], 0 offen sc0 sc1
L_pp_102:
  s_waitcnt vmcnt(0)
  v_cmp_gt_u32 vcc, 16, v140
  s_nop 0
  s_and_b32 s9, vcc_lo, 0x1
  s_cbranch_scc0 L_pe_103
  v_mov_b32 v140, 0
  buffer_atomic_add v140, v8, s[52:55], 0 offen sc0 sc1
  s_add_u32 s10, s10, 1
  s_cmp_lt_u32 s10, 8192
  s_cbranch_scc1 L_pp_102
L_pe_103:
  s_mov_b64 exec, -1
L_kv_101:
  s_setprio 2
  buffer_load_dwordx4 v[122:125], v4, s[52:55], s12 offen offset:0 sc1
  buffer_load_dwordx4 v[126:129], v5, s[52:55], s12 offen offset:768 sc1
  buffer_load_dword v41, v7, s[52:55], s60 offen sc1
  buffer_load_dword v40, v7, s[52:55], s15 offen sc1
  buffer_load_dwordx4 v[50:53], v3, s[52:55], s11 offen offset:0 sc1
  buffer_load_dwordx4 v[56:59], v3, s[52:55], s11 offen offset:1024 sc1
  buffer_load_dwordx4 v[62:65], v3, s[52:55], s11 offen offset:2048 sc1
  buffer_load_dwordx4 v[68:71], v3, s[52:55], s11 offen offset:3072 sc1
L_late:
  s_mov_b32 s44, s38
  s_and_b32 s45, s39, 0xffff
  s_mov_b32 s46, 2359296
  s_mov_b32 s47, 0x20000
  s_movk_i32 s77, 0xf0
  s_lshl_b32 s7, s4, 11
  s_xor_b32 s8, s7, 2048
  s_add_u32 s7, s7, s67
  s_add_u32 s8, s8, s67
  v_add_u32 v27, s7, v3
  v_add_u32 v28, s8, v3
  v_and_b32 v35, 3, v0
  v_lshlrev_b32 v35, 3, v35
  v_lshl_add_u32 v35, v2, 5, v35
  v_lshrrev_b32 v36, 2, v1
  v_lshl_add_u32 v29, v36, 15, v35
  v_mul_u32_u24 v36, 1152, v1
  v_lshl_add_u32 v31, v2, 4, v36
  s_lshr_b32 s71, s2, 7
  s_bfe_u32 s7, s2, 0x10002
  s_lshl_b32 s7, s7, 1
  s_add_u32 s7, s7, s71
  s_xor_b32 s7, s7, 1
  s_lshl_b32 s7, s7, 3
  s_add_u32 s7, s7, s64
  s_mul_i32 s74, s7, 20736
  s_add_u32 s74, s74, 6309888
  v_lshlrev_b32 v17, 3, v0
  v_and_b32 v35, 7, v0
  v_bfe_u32 v36, v0, 3, 1
  v_lshlrev_b32 v30, 14, v35
  v_lshl_add_u32 v30, v2, 3, v30
  v_lshl_add_u32 v30, v36, 1, v30
  v_mul_u32_u24 v32, 1152, v36
  v_lshl_add_u32 v32, v35, 3, v32
  s_lshl_b32 s7, s64, 1
  v_add_lshl_u32 v25, v36, s7, 2
  s_lshl_b32 s8, s71, 2
  v_xor_b32 v35, s8, v35
  v_lshlrev_b32 v36, 5, v35
  v_lshl_add_u32 v36, v25, 2, v36
  v_lshlrev_b32 v35, 8, v35
  v_lshl_add_u32 v23, v2, 5, v36
  v_and_or_b32 v36, v36, s77, v35
  v_and_or_b32 v35, v23, s77, v35
  v_mul_u32_u24 v23, 8672, v2
  v_add_u32 v23, v23, v35
  v_mul_u32_u24 v24, 6656, v2
  s_add_u32 s8, s96, 82944
  v_add3_u32 v24, v24, v36, s8
  s_lshl_b32 s8, s5, 1
  s_add_u32 s8, s8, s71
  s_lshl_b32 s9, s8, 4
  s_add_u32 s9, s9, s7
  s_mul_i32 s66, s9, 576
  s_add_u32 s66, s66, s70
  s_lshl_b32 s66, s66, 1
  s_lshl_b32 s63, s70, 12
  s_lshl_b32 s8, s8, 7
  s_add_u32 s63, s63, s8
  s_lshr_b32 s8, s64, 1
  s_lshl_b32 s8, s8, 5
  s_add_u32 s63, s63, s8
  s_and_b32 s8, s64, 1
  s_lshl_b32 s8, s8, 2
  s_add_u32 s63, s63, s8
  s_add_u32 s63, s63, 2490368
  s_lshl_b32 s7, s5, 1
  s_add_u32 s7, s7, s4
  s_lshl_b32 s9, s3, 5
  s_add_u32 s9, s9, s6
  s_mul_i32 s8, s7, 9216
  s_add_u32 s65, s8, s9
  s_lshl_b32 s65, s65, 1
  s_lshl_b32 s10, s7, 7
  s_add_u32 s10, s10, 2490368
  s_lshl_b32 s9, s9, 12
  s_add_u32 s61, s10, s9
  s_add_u32 s62, s61, 16384
  s_mov_b32 s34, 0x300003
  s_mov_b32 s35, 0x30000300
  s_lshl_b64 s[36:37], s[34:35], 2
  s_mov_b32 s22, 0xaaaaaaaa
  s_mov_b32 s23, 0xaaaaaaaa
L_build:
  s_waitcnt lgkmcnt(0)
  s_waitcnt vmcnt(12)
  v_mov_b32 v97, v130
  v_mov_b32 v102, v132
  v_mov_b32 v103, v131
  v_mov_b32 v108, v133
  v_mov_b32 v109, v130
  v_mov_b32 v114, v132
  v_mov_b32 v115, v131
  v_mov_b32 v120, v133
  s_waitcnt vmcnt(7)
  v_cvt_pk_bf16_f32 v122, v122, v123
  v_cvt_pk_bf16_f32 v123, v124, v125
  v_cndmask_b32 v74, 0, v122, s[84:85]
  v_cndmask_b32 v75, 0, v123, s[84:85]
  v_cndmask_b32 v80, 0, v122, s[86:87]
  v_cndmask_b32 v81, 0, v123, s[86:87]
  v_cndmask_b32 v86, 0, v122, s[88:89]
  v_cndmask_b32 v87, 0, v123, s[88:89]
  v_cndmask_b32 v92, 0, v122, s[24:25]
  v_cndmask_b32 v93, 0, v123, s[24:25]
  s_waitcnt vmcnt(6)
  v_cvt_pk_bf16_f32 v126, v126, v127
  v_cvt_pk_bf16_f32 v127, v128, v129
  v_cndmask_b32 v76, 0, v126, s[30:31]
  v_cndmask_b32 v73, 0, v126, s[30:31]
  v_cndmask_b32 v82, 0, v127, s[32:33]
  v_cndmask_b32 v79, 0, v127, s[32:33]
  v_mfma_f32_16x16x32_bf16 v[122:125], v[74:77], v[100:103], v[44:47]
  v_cndmask_b32 v49, 0, v126, s[26:27]
  v_cndmask_b32 v55, 0, v127, s[26:27]
  v_cndmask_b32 v61, 0, v126, s[28:29]
  v_mfma_f32_16x16x32_bf16 v[122:125], v[80:83], v[106:109], v[122:125]
  v_cndmask_b32 v67, 0, v127, s[28:29]
  s_waitcnt vmcnt(5)
  v_mul_f32 v41, 0x3fb8aa3b, v41
  s_waitcnt vmcnt(4)
  v_mul_f32 v40, 0x3fb8aa3b, v40
  v_mfma_f32_16x16x32_bf16 v[122:125], v[86:89], v[112:115], v[122:125]
  v_exp_f32 v41, -v41
  v_exp_f32 v40, -v40
  v_add_f32 v41, 1.0, v41
  v_mfma_f32_16x16x32_bf16 v[122:125], v[92:95], v[118:121], v[122:125]
  v_add_f32 v40, 1.0, v40
  v_mfma_f32_16x16x32_bf16 v[126:129], v[72:75], v[96:99], v[44:47]
  s_waitcnt vmcnt(3)
  v_cvt_pk_bf16_f32 v50, v50, v51
  v_cvt_pk_bf16_f32 v51, v52, v53
  v_mfma_f32_16x16x32_bf16 v[126:129], v[78:81], v[102:105], v[126:129]
  v_mov_b32 v52, v49
  v_mov_b32 v53, 0
  v_mfma_f32_16x16x32_bf16 v[126:129], v[84:87], v[108:111], v[126:129]
  s_waitcnt vmcnt(2)
  v_cvt_pk_bf16_f32 v56, v56, v57
  v_cvt_pk_bf16_f32 v57, v58, v59
  v_mfma_f32_16x16x32_bf16 v[126:129], v[90:93], v[114:117], v[126:129]
  v_mov_b32 v58, v55
  v_mov_b32 v59, 0
  v_mfma_f32_16x16x32_bf16 v[150:153], v[50:53], v[100:103], 0
  v_mov_b64 v[80:81], 0
  buffer_load_dwordx4 v[72:75], v3, s[52:55], s74 offen sc1
  buffer_load_dwordx4 v[76:79], v3, s[52:55], s74 offen offset:1024 sc1
  s_mov_b32 exec_hi, 0
  buffer_load_dwordx2 v[80:81], v17, s[52:55], s74 offen offset:2048 sc1
  s_mov_b64 exec, -1
  s_waitcnt vmcnt(4)
  v_cvt_pk_bf16_f32 v62, v62, v63
  v_cvt_pk_bf16_f32 v63, v64, v65
  v_mov_b32 v64, v61
  v_mov_b32 v65, 0
  v_mfma_f32_16x16x32_bf16 v[154:157], v[56:59], v[106:109], 0
  s_waitcnt vmcnt(3)
  v_cvt_pk_bf16_f32 v68, v68, v69
  v_cvt_pk_bf16_f32 v69, v70, v71
  v_mov_b32 v70, v67
  v_mov_b32 v71, 0
  v_mfma_f32_16x16x32_bf16 v[158:161], v[62:65], v[112:115], 0
  v_mul_f32 v12, v41, v122
  v_mul_f32 v13, v41, v123
  v_mfma_f32_16x16x32_bf16 v[162:165], v[68:71], v[118:121], 0
  v_mul_f32 v14, v41, v124
  v_mul_f32 v15, v41, v125
  v_mfma_f32_16x16x32_bf16 v[134:137], v[48:51], v[96:99], 0
  v_mul_f32 v130, v41, v122
  v_mul_f32 v131, v41, v123
  v_mfma_f32_16x16x32_bf16 v[138:141], v[54:57], v[102:105], 0
  v_mul_f32 v132, v41, v124
  v_mul_f32 v133, v41, v125
  v_mfma_f32_16x16x32_bf16 v[142:145], v[60:63], v[108:111], 0
  v_mul_f32 v4, v40, v126
  v_mul_f32 v5, v40, v127
  v_mfma_f32_16x16x32_bf16 v[146:149], v[66:69], v[114:117], 0
  v_mul_f32 v6, v40, v128
  v_mul_f32 v7, v40, v129
  v_mul_f32 v96, v40, v126
  v_mul_f32 v97, v40, v127
  v_mul_f32 v98, v40, v128
  v_mul_f32 v99, v40, v129
  v_permlane32_swap_b32 v130, v12
  v_permlane32_swap_b32 v131, v13
  v_permlane32_swap_b32 v132, v14
  v_permlane32_swap_b32 v133, v15
  v_permlane32_swap_b32 v96, v4
  v_permlane32_swap_b32 v97, v5
  v_permlane32_swap_b32 v98, v6
  v_permlane32_swap_b32 v99, v7
  v_rcp_f32 v12, v12
  v_rcp_f32 v13, v13
  v_rcp_f32 v14, v14
  v_rcp_f32 v15, v15
  v_rcp_f32 v4, v4
  v_rcp_f32 v5, v5
  v_rcp_f32 v6, v6
  v_rcp_f32 v7, v7
  v_mul_f32 v122, v122, v12
  v_mul_f32 v123, v123, v13
  v_mul_f32 v124, v124, v14
  v_mul_f32 v125, v125, v15
  s_mov_b32 exec_hi, 0
  v_cvt_pk_bf16_f32 v168, v122, v123
  v_cvt_pk_bf16_f32 v169, v124, v125
  ds_write_b64 v22, v[168:169] offset:4352
  s_mov_b64 exec, -1
  v_mul_f32 v150, v150, v12
  v_mul_f32 v151, v151, v12
  v_mul_f32 v152, v152, v12
  v_mul_f32 v153, v153, v12
  v_cvt_pk_bf16_f32 v150, v150, v151
  v_cvt_pk_bf16_f32 v151, v152, v153
  v_mul_f32 v154, v154, v13
  v_mul_f32 v155, v155, v13
  v_mul_f32 v156, v156, v13
  v_mul_f32 v157, v157, v13
  v_cvt_pk_bf16_f32 v152, v154, v155
  v_cvt_pk_bf16_f32 v153, v156, v157
  ds_write_b128 v16, v[150:153] offset:2048
  v_mul_f32 v158, v158, v14
  v_mul_f32 v159, v159, v14
  v_mul_f32 v160, v160, v14
  v_mul_f32 v161, v161, v14
  v_cvt_pk_bf16_f32 v158, v158, v159
  v_cvt_pk_bf16_f32 v159, v160, v161
  v_mul_f32 v162, v162, v15
  v_mul_f32 v163, v163, v15
  v_mul_f32 v164, v164, v15
  v_mul_f32 v165, v165, v15
  v_cvt_pk_bf16_f32 v160, v162, v163
  v_cvt_pk_bf16_f32 v161, v164, v165
  ds_write_b128 v16, v[158:161] offset:3072
  v_mul_f32 v126, v126, v4
  v_mul_f32 v127, v127, v5
  v_mul_f32 v128, v128, v6
  v_mul_f32 v129, v129, v7
  s_mov_b32 exec_hi, 0
  v_cvt_pk_bf16_f32 v166, v126, v127
  v_cvt_pk_bf16_f32 v167, v128, v129
  ds_write_b64 v22, v[166:167] offset:4096
  s_mov_b64 exec, -1
  v_mul_f32 v134, v134, v4
  v_mul_f32 v135, v135, v4
  v_mul_f32 v136, v136, v4
  v_mul_f32 v137, v137, v4
  v_cvt_pk_bf16_f32 v134, v134, v135
  v_cvt_pk_bf16_f32 v135, v136, v137
  v_mul_f32 v138, v138, v5
  v_mul_f32 v139, v139, v5
  v_mul_f32 v140, v140, v5
  v_mul_f32 v141, v141, v5
  v_cvt_pk_bf16_f32 v136, v138, v139
  v_cvt_pk_bf16_f32 v137, v140, v141
  ds_write_b128 v16, v[134:137] offset:0
  v_mul_f32 v142, v142, v6
  v_mul_f32 v143, v143, v6
  v_mul_f32 v144, v144, v6
  v_mul_f32 v145, v145, v6
  v_cvt_pk_bf16_f32 v142, v142, v143
  v_cvt_pk_bf16_f32 v143, v144, v145
  v_mul_f32 v146, v146, v7
  v_mul_f32 v147, v147, v7
  v_mul_f32 v148, v148, v7
  v_mul_f32 v149, v149, v7
  v_cvt_pk_bf16_f32 v144, v146, v147
  v_cvt_pk_bf16_f32 v145, v148, v149
  ds_write_b128 v16, v[142:145] offset:1024
  s_mov_b64 exec, 1
  ds_add_u32 v33, v34 offset:24
  s_mov_b64 exec, -1
  s_setprio 0
  s_mov_b64 exec, 0xff
  buffer_load_dword v11, v9, s[52:55], 0 offen sc0 sc1
  s_mov_b64 exec, -1
  s_cmp_lg_u32 s4, s71
  s_cbranch_scc1 L_o1_105
  v_mfma_f32_16x16x16_bf16 v[64:67], v[252:253], v[166:167], 0
  v_rcp_f32 v37, v40
  v_mfma_f32_16x16x32_bf16 v[56:59], v[172:175], v[150:153], 0
  v_sub_f32 v36, 1.0, v37
  v_mfma_f32_16x16x32_bf16 v[60:63], v[176:179], v[150:153], 0
  v_cvt_pk_bf16_f32 v37, v36, 0
  v_mfma_f32_16x16x32_bf16 v[56:59], v[180:183], v[158:161], v[56:59]
  v_lshlrev_b32 v38, 16, v37
  v_mfma_f32_16x16x32_bf16 v[60:63], v[184:187], v[158:161], v[60:63]
  v_cndmask_b32 v37, v37, v38, s[22:23]
  s_waitcnt vmcnt(1)
  v_mfma_f32_16x16x16_bf16 v[68:71], v[80:81], v[166:167], 0
  v_cndmask_b32 v42, 0, v37, s[34:35]
  v_mfma_f32_16x16x32_bf16 v[64:67], v[244:247], v[134:137], v[64:67]
  v_cndmask_b32 v43, 0, v37, s[36:37]
  v_mfma_f32_16x16x32_bf16 v[64:67], v[248:251], v[142:145], v[64:67]
  ds_bpermute_b32 v26, v25, v36
  s_nop 2
  v_mfma_f32_16x16x32_bf16 v[68:71], v[72:75], v[134:137], v[68:71]
  v_mfma_f32_16x16x32_bf16 v[68:71], v[76:79], v[142:145], v[68:71]
  s_branch L_o2_106
L_o1_105:
  v_mfma_f32_16x16x16_bf16 v[64:67], v[252:253], v[168:169], 0
  v_rcp_f32 v37, v40
  v_mfma_f32_16x16x32_bf16 v[56:59], v[172:175], v[150:153], 0
  v_sub_f32 v36, 1.0, v37
  v_mfma_f32_16x16x32_bf16 v[60:63], v[176:179], v[150:153], 0
  v_cvt_pk_bf16_f32 v37, v36, 0
  v_mfma_f32_16x16x32_bf16 v[56:59], v[180:183], v[158:161], v[56:59]
  v_lshlrev_b32 v38, 16, v37
  v_mfma_f32_16x16x32_bf16 v[60:63], v[184:187], v[158:161], v[60:63]
  v_cndmask_b32 v37, v37, v38, s[22:23]
  s_waitcnt vmcnt(1)
  v_mfma_f32_16x16x16_bf16 v[68:71], v[80:81], v[168:169], 0
  v_cndmask_b32 v42, 0, v37, s[34:35]
  v_mfma_f32_16x16x32_bf16 v[64:67], v[244:247], v[150:153], v[64:67]
  v_cndmask_b32 v43, 0, v37, s[36:37]
  v_mfma_f32_16x16x32_bf16 v[64:67], v[248:251], v[158:161], v[64:67]
  v_rcp_f32 v26, v41
  s_nop 2
  v_mfma_f32_16x16x32_bf16 v[68:71], v[72:75], v[150:153], v[68:71]
  v_sub_f32 v26, 1.0, v26
  v_mfma_f32_16x16x32_bf16 v[68:71], v[76:79], v[158:161], v[68:71]
  ds_bpermute_b32 v26, v25, v26
L_o2_106:
  s_mov_b32 s10, 0
L_lw_107:
  ds_read_b32 v35, v33 offset:24
L_l1_109:
  s_add_u32 s10, s10, 1
  s_waitcnt lgkmcnt(0)
  v_readfirstlane_b32 s9, v35
  s_cmp_gt_u32 s10, 8192
  s_cbranch_scc1 L_le_108
  s_cmp_lt_u32 s9, 4
  s_cbranch_scc1 L_lw_107
L_le_108:
  ds_read_b32 v35, v39 offset:36
  ds_read_b128 v[72:75], v18 offset:2048
  ds_read_b128 v[76:79], v18 offset:3072
  ds_read_b128 v[80:83], v19 offset:2048
  ds_read_b128 v[84:87], v19 offset:3072
  ds_read_b128 v[88:91], v20 offset:2048
  ds_read_b128 v[92:95], v20 offset:3072
  ds_read_b128 v[96:99], v21 offset:4352
  ds_read_b128 v[100:103], v18 offset:0
  ds_read_b128 v[104:107], v18 offset:1024
  ds_read_b128 v[108:111], v19 offset:0
  ds_read_b128 v[112:115], v19 offset:1024
  ds_read_b128 v[116:119], v20 offset:0
  ds_read_b128 v[120:123], v20 offset:1024
  ds_read_b128 v[124:127], v21 offset:4096
  s_mov_b64 exec, 0xff
  buffer_load_dword v10, v9, s[52:55], 0 offen sc0 sc1
  s_mov_b64 exec, -1
  s_lshl_b32 s7, s3, 1
  s_cmp_eq_u32 s75, 1
  s_cselect_b32 s7, 0, s7
  v_mfma_f32_16x16x32_bf16 v[48:51], v[172:175], v[134:137], 0
  v_lshl_add_u32 v36, v2, 1, v1
  v_add_u32 v36, s7, v36
  v_mfma_f32_16x16x32_bf16 v[52:55], v[176:179], v[134:137], 0
  v_and_b32 v36, 15, v36
  v_sub_u32 v37, v36, v1
  v_mfma_f32_16x16x32_bf16 v[48:51], v[180:183], v[142:145], v[48:51]
  v_xor_b32 v36, 8, v36
  v_lshl_add_u32 v37, v37, 4, v16
  v_mfma_f32_16x16x32_bf16 v[52:55], v[184:187], v[142:145], v[52:55]
  v_sub_u32 v36, v36, v1
  v_lshl_add_u32 v36, v36, 4, v16
  s_waitcnt lgkmcnt(13)
  v_mfma_f32_16x16x32_bf16 v[56:59], v[188:191], v[72:75], v[56:59]
  v_mfma_f32_16x16x32_bf16 v[60:63], v[192:195], v[72:75], v[60:63]
  s_waitcnt lgkmcnt(12)
  v_mfma_f32_16x16x32_bf16 v[56:59], v[196:199], v[76:79], v[56:59]
  v_mfma_f32_16x16x32_bf16 v[60:63], v[200:203], v[76:79], v[60:63]
  s_waitcnt lgkmcnt(11)
  v_mfma_f32_16x16x32_bf16 v[56:59], v[204:207], v[80:83], v[56:59]
  v_mfma_f32_16x16x32_bf16 v[60:63], v[208:211], v[80:83], v[60:63]
  s_waitcnt lgkmcnt(10)
  v_mfma_f32_16x16x32_bf16 v[56:59], v[212:215], v[84:87], v[56:59]
  v_mfma_f32_16x16x32_bf16 v[60:63], v[216:219], v[84:87], v[60:63]
  ds_write_b128 v36, v[68:71] offset:5632
  ds_write_b128 v37, v[64:67] offset:4608
  s_waitcnt lgkmcnt(11)
  v_mfma_f32_16x16x32_bf16 v[56:59], v[220:223], v[88:91], v[56:59]
  v_mfma_f32_16x16x32_bf16 v[60:63], v[224:227], v[88:91], v[60:63]
  s_waitcnt lgkmcnt(10)
  v_mfma_f32_16x16x32_bf16 v[56:59], v[228:231], v[92:95], v[56:59]
  v_mfma_f32_16x16x32_bf16 v[60:63], v[232:235], v[92:95], v[60:63]
  s_waitcnt lgkmcnt(9)
  v_mfma_f32_16x16x32_bf16 v[56:59], v[236:239], v[96:99], v[56:59]
  v_mfma_f32_16x16x32_bf16 v[60:63], v[240:243], v[96:99], v[60:63]
  v_readfirstlane_b32 s9, v35
  s_waitcnt lgkmcnt(8)
  v_mfma_f32_16x16x32_bf16 v[48:51], v[188:191], v[100:103], v[48:51]
  v_mfma_f32_16x16x32_bf16 v[52:55], v[192:195], v[100:103], v[52:55]
  s_cmp_ge_u32 s9, 4
  s_cbranch_scc1 L_x_110
  s_mov_b32 s10, 0
L_lw_111:
  ds_read_b32 v35, v39 offset:36
L_l1_113:
  s_add_u32 s10, s10, 1
  s_waitcnt lgkmcnt(0)
  v_readfirstlane_b32 s9, v35
  s_cmp_gt_u32 s10, 8192
  s_cbranch_scc1 L_le_112
  s_cmp_lt_u32 s9, 4
  s_cbranch_scc1 L_lw_111
L_le_112:
L_x_110:
  s_nop 2
  ds_write_b128 v27, v[56:59] offset:0
  ds_write_b128 v27, v[60:63] offset:1024
  s_mov_b64 exec, 1
  ds_add_u32 v39, v34 offset:32
  s_mov_b64 exec, -1
  s_mov_b64 exec, 0xff
  s_waitcnt vmcnt(1)
  v_cmp_ne_u32 vcc, 16, v11
  s_mov_b64 exec, -1
  s_waitcnt lgkmcnt(10)
  v_mfma_f32_16x16x32_bf16 v[48:51], v[196:199], v[104:107], v[48:51]
  v_mfma_f32_16x16x32_bf16 v[52:55], v[200:203], v[104:107], v[52:55]
  s_cbranch_vccz L_dbt_115
  s_mov_b64 exec, 0xff
  s_waitcnt vmcnt(0)
  v_cmp_ne_u32 vcc, 16, v10
  buffer_load_dword v11, v9, s[52:55], 0 offen sc0 sc1
  s_mov_b64 exec, -1
  s_cbranch_vccnz L_nbt_114
L_dbt_115:
  s_mov_b32 s76, 1
  buffer_load_dwordx2 v[44:45], v29, s[52:55], s61 offen sc1
  buffer_load_dwordx2 v[46:47], v29, s[52:55], s62 offen sc1
  buffer_load_short_d16_hi v170, v30, s[52:55], s63 offen sc1
L_nbt_114:
  s_waitcnt lgkmcnt(9)
  v_mfma_f32_16x16x32_bf16 v[48:51], v[204:207], v[108:111], v[48:51]
  v_mfma_f32_16x16x32_bf16 v[52:55], v[208:211], v[108:111], v[52:55]
  s_waitcnt lgkmcnt(8)
  v_mfma_f32_16x16x32_bf16 v[48:51], v[212:215], v[112:115], v[48:51]
  v_mfma_f32_16x16x32_bf16 v[52:55], v[216:219], v[112:115], v[52:55]
  s_waitcnt lgkmcnt(7)
  v_mfma_f32_16x16x32_bf16 v[48:51], v[220:223], v[116:119], v[48:51]
  v_mfma_f32_16x16x32_bf16 v[52:55], v[224:227], v[116:119], v[52:55]
  s_waitcnt lgkmcnt(6)
  v_mfma_f32_16x16x32_bf16 v[48:51], v[228:231], v[120:123], v[48:51]
  v_mfma_f32_16x16x32_bf16 v[52:55], v[232:235], v[120:123], v[52:55]
  s_waitcnt lgkmcnt(5)
  v_mfma_f32_16x16x32_bf16 v[48:51], v[236:239], v[124:127], v[48:51]
  v_mfma_f32_16x16x32_bf16 v[52:55], v[240:243], v[124:127], v[52:55]
  s_cmp_eq_u32 s76, 1
  s_cbranch_scc1 L_bt_116
  s_mov_b32 s10, 0
  s_mov_b64 exec, 0xff
  s_branch L_f1_119
L_fp_117:
  buffer_load_dword v11, v9, s[52:55], 0 offen sc0 sc1
L_f1_119:
  s_add_u32 s10, s10, 1
  s_waitcnt vmcnt(0)
  v_cmp_gt_u32 vcc, 16, v11
  s_cmp_gt_u32 s10, 8192
  s_cbranch_scc1 L_fe_118
  s_and_b32 s9, vcc_lo, 0xff
  s_cbranch_scc1 L_fp_117
L_fe_118:
  s_mov_b64 exec, -1
  buffer_load_dwordx2 v[44:45], v29, s[52:55], s61 offen sc1
  buffer_load_dwordx2 v[46:47], v29, s[52:55], s62 offen sc1
  buffer_load_short_d16_hi v170, v30, s[52:55], s63 offen sc1
L_bt_116:
  s_mov_b32 s10, 0
L_lw_120:
  ds_read_b32 v35, v39 offset:32
L_l1_122:
  s_add_u32 s10, s10, 1
  s_waitcnt lgkmcnt(0)
  v_readfirstlane_b32 s9, v35
  s_cmp_gt_u32 s10, 8192
  s_cbranch_scc1 L_le_121
  s_cmp_lt_u32 s9, 8
  s_cbranch_scc1 L_lw_120
L_le_121:
  ds_read_b128 v[72:75], v23 offset:4608
  ds_read_b128 v[76:79], v24 offset:4608
  ds_read_b128 v[80:83], v28 offset:0
  ds_read_b128 v[84:87], v28 offset:1024
  s_waitcnt lgkmcnt(2)
  v_add_f32 v72, v72, v76
  v_add_f32 v73, v73, v77
  v_add_f32 v74, v74, v78
  v_add_f32 v75, v75, v79
  s_nop 0
  v_permlane32_swap_b32 v72, v74
  v_permlane32_swap_b32 v73, v75
  s_nop 0
  v_add_f32 v72, v72, v74
  v_add_f32 v73, v73, v75
  s_nop 1
  v_permlane16_swap_b32 v72, v73
  s_nop 0
  v_add_f32 v72, v72, v73
  s_waitcnt vmcnt(0)
  s_waitcnt lgkmcnt(1)
  v_mfma_f32_16x16x16_bf16 v[80:83], v[44:45], v[42:43], v[80:83]
  s_waitcnt lgkmcnt(0)
  v_mfma_f32_16x16x16_bf16 v[84:87], v[46:47], v[42:43], v[84:87]
  v_fma_f32 v73, v26, v170, v72
  v_fmac_f32 v72, v26, v170
  s_nop 1
  v_permlane16_swap_b32 v72, v73
  s_nop 0
  v_cvt_pk_bf16_f32 v75, v72, v73
  v_cvt_pk_bf16_f32 v74, v72, v73
  s_nop 1
  v_permlane32_swap_b32 v74, v75
  s_mov_b64 exec, 0xffff
  buffer_store_dwordx2 v[74:75], v32, s[44:47], s66 offen sc0 sc1
  s_mov_b64 exec, -1
  v_pk_add_f32 v[48:49], v[48:49], v[80:81]
  v_pk_add_f32 v[50:51], v[50:51], v[82:83]
  v_cvt_pk_bf16_f32 v134, v48, v49
  v_cvt_pk_bf16_f32 v135, v50, v51
  v_pk_add_f32 v[52:53], v[52:53], v[84:85]
  v_pk_add_f32 v[54:55], v[54:55], v[86:87]
  v_cvt_pk_bf16_f32 v136, v52, v53
  v_cvt_pk_bf16_f32 v137, v54, v55
  buffer_store_dwordx4 v[134:137], v31, s[44:47], s65 offen sc0 sc1
  s_endpgm
.p2align 6
L_seqtab:
  .long 0, 0
  .long 0, 0
  .long 0, 0
  .long 0, 0
  .long 0, 0
  .long 0, 0
  .long 0, 0
  .long 0, 0
  .long 0, 0
  .long 0, 0
  .long 0, 0
  .long 0, 0
  .long 0, 0
  .long 0, 0
  .long 0, 0
  .long 0, 0
  .long 0, 0
  .long 0, 0
  .long 0, 0
  .long 0, 0
  .long 0, 0
  .long 0, 0
  .long 0, 0
  .long 0, 0
  .long 0, 0
  .long 0, 0
  .long 0, 0
  .long 0, 0
  .long 0, 0
  .long 0, 0
  .long 0, 0
  .long 0, 0
  .long 0, 0
  .long 0, 0
  .long 0, 0
  .long 0, 0
  .long 0, 0
  .long 0, 0
  .long 0, 0
  .long 0, 0
  .long 0, 0
  .long 0, 0
  .long 0, 0
  .long 0, 0
  .long 0, 0
  .long 0, 0
  .long 0, 0
  .long 0, 0
  .long 0, 0
  .long 0, 0
  .long 0, 0
  .long 0, 0
  .long 0, 0
  .long 0, 0
  .long 0, 0
  .long 0, 0
  .long 0, 0
  .long 0, 0
  .long 0, 0
  .long 0, 0
  .long 0, 0
  .long 0, 0
  .long 0, 0
  .long 0, 0
  .long 0, 0
  .long 0, 0
  .long 0, 0
  .long 0, 0
  .long 0, 0
  .long 0, 0
  .long 0, 0
  .long 0, 0
  .long 0x0, 0x87654321
  .long 0x4, 0x32108765
  .long 0x0, 0x87654321
  .long 0x4, 0x32108765
  .long 0x7, 0x10832654
  .long 0x3, 0x65487210
  .long 0x7, 0x10832654
  .long 0x3, 0x65487210
  .long 0x1, 0x48765032
  .long 0x5, 0x83210476
  .long 0x1, 0x48765032
  .long 0x5, 0x83210476
  .long 0x4, 0x32108765
  .long 0x0, 0x87654321
  .long 0x4, 0x32108765
  .long 0x0, 0x87654321
  .long 0x2, 0x54876103
  .long 0x6, 0x8321547
  .long 0x2, 0x54876103
  .long 0x6, 0x8321547
  .long 0x6, 0x8321547
  .long 0x2, 0x54876103
  .long 0x6, 0x8321547
  .long 0x2, 0x54876103
  .long 0x3, 0x65487210
  .long 0x7, 0x10832654
  .long 0x3, 0x65487210
  .long 0x7, 0x10832654
  .long 0x7, 0x10832654
  .long 0x3, 0x65487210
  .long 0x7, 0x10832654
  .long 0x3, 0x65487210
  .long 0x1, 0x48765032
  .long 0x5, 0x83210476
  .long 0x1, 0x48765032
  .long 0x5, 0x83210476
  .long 0x4, 0x32108765
  .long 0x0, 0x87654321
  .long 0x4, 0x32108765
  .long 0x0, 0x87654321
  .long 0x2, 0x54876103
  .long 0x6, 0x8321547
  .long 0x2, 0x54876103
  .long 0x6, 0x8321547
  .long 0x5, 0x83210476
  .long 0x1, 0x48765032
  .long 0x5, 0x83210476
  .long 0x1, 0x48765032
  .long 0x0, 0x87654321
  .long 0x4, 0x32108765
  .long 0x0, 0x87654321
  .long 0x4, 0x32108765
  .long 0x4, 0x32108765
  .long 0x0, 0x87654321
  .long 0x4, 0x32108765
  .long 0x0, 0x87654321
  .long 0x1, 0x48765032
  .long 0x5, 0x83210476
  .long 0x1, 0x48765032
  .long 0x5, 0x83210476
  .long 0x5, 0x83210476
  .long 0x1, 0x48765032
  .long 0x5, 0x83210476
  .long 0x1, 0x48765032
  .long 0x2, 0x54876103
  .long 0x6, 0x8321547
  .long 0x2, 0x54876103
  .long 0x6, 0x8321547
  .long 0x6, 0x8321547
  .long 0x2, 0x54876103
  .long 0x6, 0x8321547
  .long 0x2, 0x54876103
  .long 0x3, 0x65487210
  .long 0x7, 0x10832654
  .long 0x3, 0x65487210
  .long 0x7, 0x10832654
  .long 0x7, 0x10832654
  .long 0x3, 0x65487210
  .long 0x7, 0x10832654
  .long 0x3, 0x65487210
  .long 0x1, 0x48765032
  .long 0x5, 0x83210476
  .long 0x1, 0x48765032
  .long 0x5, 0x83210476
  .long 0x5, 0x83210476
  .long 0x1, 0x48765032
  .long 0x5, 0x83210476
  .long 0x1, 0x48765032
  .long 0x2, 0x54876103
  .long 0x6, 0x8321547
  .long 0x2, 0x54876103
  .long 0x6, 0x8321547
  .long 0x6, 0x8321547
  .long 0x2, 0x54876103
  .long 0x6, 0x8321547
  .long 0x2, 0x54876103
  .long 0x3, 0x65487210
  .long 0x7, 0x10832654
  .long 0x3, 0x65487210
  .long 0x7, 0x10832654
  .long 0x7, 0x10832654
  .long 0x3, 0x65487210
  .long 0x7, 0x10832654
  .long 0x3, 0x65487210
  .long 0x0, 0x87654321
  .long 0x4, 0x32108765
  .long 0x0, 0x87654321
  .long 0x4, 0x32108765
  .long 0x4, 0x32108765
  .long 0x0, 0x87654321
  .long 0x4, 0x32108765
  .long 0x0, 0x87654321
  .long 0x2, 0x54876103
  .long 0x6, 0x8321547
  .long 0x2, 0x54876103
  .long 0x6, 0x8321547
  .long 0x6, 0x8321547
  .long 0x2, 0x54876103
  .long 0x6, 0x8321547
  .long 0x2, 0x54876103
  .long 0x3, 0x65487210
  .long 0x7, 0x10832654
  .long 0x3, 0x65487210
  .long 0x7, 0x10832654
  .long 0x7, 0x10832654
  .long 0x3, 0x65487210
  .long 0x7, 0x10832654
  .long 0x3, 0x65487210
  .long 0x0, 0x87654321
  .long 0x4, 0x32108765
  .long 0x0, 0x87654321
  .long 0x4, 0x32108765
  .long 0x4, 0x32108765
  .long 0x0, 0x87654321
  .long 0x4, 0x32108765
  .long 0x0, 0x87654321
  .long 0x1, 0x48765032
  .long 0x5, 0x83210476
  .long 0x1, 0x48765032
  .long 0x5, 0x83210476
  .long 0x5, 0x83210476
  .long 0x1, 0x48765032
  .long 0x5, 0x83210476
  .long 0x1, 0x48765032
  .long 0x3, 0x65487210
  .long 0x7, 0x10832654
  .long 0x3, 0x65487210
  .long 0x7, 0x10832654
  .long 0x7, 0x10832654
  .long 0x3, 0x65487210
  .long 0x7, 0x10832654
  .long 0x3, 0x65487210
  .long 0x0, 0x87654321
  .long 0x4, 0x32108765
  .long 0x0, 0x87654321
  .long 0x4, 0x32108765
  .long 0x4, 0x32108765
  .long 0x0, 0x87654321
  .long 0x4, 0x32108765
  .long 0x0, 0x87654321
  .long 0x1, 0x48765032
  .long 0x5, 0x83210476
  .long 0x1, 0x48765032
  .long 0x5, 0x83210476
  .long 0x5, 0x83210476
  .long 0x1, 0x48765032
  .long 0x5, 0x83210476
  .long 0x1, 0x48765032
  .long 0x2, 0x54876103
  .long 0x6, 0x8321547
  .long 0x2, 0x54876103
  .long 0x6, 0x8321547
  .long 0x6, 0x8321547
  .long 0x2, 0x54876103
  .long 0x6, 0x8321547
  .long 0x2, 0x54876103
  .long 0, 0
  .long 0, 0
  .long 0, 0
  .long 0, 0
  .long 0, 0
  .long 0, 0
  .long 0, 0
  .long 0, 0
.p2align 8
L_wtab:
  .long 0x00000000, 0x00000000, 0x00000000, 0x00000000, 0x00000000, 0x00000000, 0x00000000, 0x00000000
  .long 0x00000000, 0x00000000, 0x00000000, 0x00000000, 0x00000000, 0x00000000, 0x00000000, 0x00000000
  .long 0x00000000, 0x00000000, 0x00000000, 0x00000000, 0x00000000, 0x00000000, 0x00000000, 0x00000000
  .long 0x00000000, 0x00000000, 0x00000000, 0x00000000, 0x00000000, 0x00000000, 0x00000000, 0x00000000
  .long 0x00000000, 0x00000000, 0x00000000, 0x00000000, 0x00000000, 0x00000000, 0x00000000, 0x00000000
  .long 0x00000000, 0x00000000, 0x00000000, 0x00000000, 0x00000000, 0x00000000, 0x00000000, 0x00000000
  .long 0x00000000, 0x00000000, 0x00000000, 0x00000000, 0x00000000, 0x00000000, 0x00000000, 0x00000000
  .long 0x00000000, 0x00000000, 0x00000000, 0x00000000, 0x00000000, 0x00000000, 0x00000000, 0x00000000
  .long 0x00000000, 0x3f800000, 0x3f803f80, 0x00000000, 0x00000000, 0x00000000, 0x3f803f80, 0x00003f80
  .long 0x00000000, 0x00000000, 0x3f800000, 0x3f803f80, 0x00000000, 0x00000000, 0x00000000, 0x3f803f80
  .long 0x00000000, 0x00000000, 0x00000000, 0x3f800000, 0x00000000, 0x00000000, 0x00000000, 0x00000000
  .long 0x00000000, 0x00000000, 0x00000000, 0x00000000, 0x00000000, 0x00000000, 0x00000000, 0x00000000
  .long 0x00000000, 0x00000000, 0x00000000, 0x00000000, 0x00000000, 0x00000000, 0x00000000, 0x00000000
  .long 0x00000000, 0x00000000, 0x00000000, 0x00000000, 0x00000000, 0x00000000, 0x00000000, 0x00000000
  .long 0x00000000, 0x00000000, 0x00000000, 0x00000000, 0x00000000, 0x00000000, 0x00000000, 0x00000000
  .long 0x00000000, 0x00000000, 0x00000000, 0x00000000, 0x00000000, 0x00000000, 0x00000000, 0x00000000
  .long 0x00000000, 0x00000000, 0x00000000, 0x00000000, 0x00000000, 0x00000000, 0x00000000, 0x00000000
  .long 0x00000000, 0x00000000, 0x00000000, 0x00000000, 0x00003f80, 0x00000000, 0x00000000, 0x00000000
  .long 0x3f803f80, 0x00000000, 0x00000000, 0x00000000, 0x3f803f80, 0x00003f80, 0x00000000, 0x00000000
  .long 0x3f800000, 0x3f803f80, 0x00000000, 0x00000000, 0x00000000, 0x3f803f80, 0x00003f80, 0x00000000
  .long 0x00000000, 0x3f800000, 0x3f803f80, 0x00000000, 0x00000000, 0x00000000, 0x3f803f80, 0x00003f80
  .long 0x00000000, 0x00000000, 0x3f800000, 0x3f803f80, 0x00000000, 0x00000000, 0x00000000, 0x3f803f80
  .long 0x00000000, 0x00000000, 0x00000000, 0x3f800000, 0x00000000, 0x00000000, 0x00000000, 0x00000000
  .long 0x00000000, 0x00000000, 0x00000000, 0x00000000, 0x00000000, 0x00000000, 0x00000000, 0x00000000
  .long 0x00000000, 0x00000000, 0x00000000, 0x00000000, 0x00000000, 0x00000000, 0x00000000, 0x00000000
  .long 0x00000000, 0x00000000, 0x00000000, 0x00000000, 0x00000000, 0x00000000, 0x00000000, 0x00000000
  .long 0x00000000, 0x00000000, 0x00000000, 0x00000000, 0x00000000, 0x00000000, 0x00000000, 0x00000000
  .long 0x00000000, 0x00000000, 0x00000000, 0x00000000, 0x00000000, 0x00000000, 0x00000000, 0x00000000
  .long 0x00000000, 0x00000000, 0x00000000, 0x00000000, 0x00000000, 0x00000000, 0x00000000, 0x00000000
  .long 0x00000000, 0x00000000, 0x00000000, 0x00000000, 0x00003f80, 0x00000000, 0x00000000, 0x00000000
  .long 0x3f803f80, 0x00000000, 0x00000000, 0x00000000, 0x3f803f80, 0x00003f80, 0x00000000, 0x00000000
  .long 0x3f800000, 0x3f803f80, 0x00000000, 0x00000000, 0x00000000, 0x3f803f80, 0x00003f80, 0x00000000
  .long 0x00000000, 0x3f800000, 0x3f803f80, 0x00000000, 0x00000000, 0x00000000, 0x3f803f80, 0x00003f80
  .long 0x00000000, 0x00000000, 0x3f800000, 0x3f803f80, 0x00000000, 0x00000000, 0x00000000, 0x3f803f80
  .long 0x00000000, 0x00000000, 0x00000000, 0x3f800000, 0x00000000, 0x00000000, 0x00000000, 0x00000000
  .long 0x00000000, 0x00000000, 0x00000000, 0x00000000, 0x00000000, 0x00000000, 0x00000000, 0x00000000
  .long 0x00000000, 0x00000000, 0x00000000, 0x00000000, 0x00000000, 0x00000000, 0x00000000, 0x00000000
  .long 0x00000000, 0x00000000, 0x00000000, 0x00000000, 0x00000000, 0x00000000, 0x00000000, 0x00000000
  .long 0x00000000, 0x00000000, 0x00000000, 0x00000000, 0x00000000, 0x00000000, 0x00000000, 0x00000000
  .long 0x00000000, 0x00000000, 0x00000000, 0x00000000, 0x00000000, 0x00000000, 0x00000000, 0x00000000
  .long 0x00000000, 0x00000000, 0x00000000, 0x00000000, 0x00000000, 0x00000000, 0x00000000, 0x00000000
  .long 0x00000000, 0x00000000, 0x00000000, 0x00000000, 0x00003f80, 0x00000000, 0x00000000, 0x00000000
  .long 0x3f803f80, 0x00000000, 0x00000000, 0x00000000, 0x3f803f80, 0x00003f80, 0x00000000, 0x00000000
  .long 0x3f800000, 0x3f803f80, 0x00000000, 0x00000000, 0x00000000, 0x3f803f80, 0x00003f80, 0x00000000
  .long 0x00000000, 0x3f800000, 0x3f803f80, 0x00000000, 0x00000000, 0x00000000, 0x3f803f80, 0x00003f80
  .long 0x00000000, 0x00000000, 0x3f800000, 0x3f803f80, 0x00000000, 0x00000000, 0x00000000, 0x3f803f80
  .long 0x00000000, 0x00000000, 0x00000000, 0x3f800000, 0x00000000, 0x00000000, 0x00000000, 0x00000000
  .long 0x00000000, 0x00000000, 0x00000000, 0x00000000, 0x00000000, 0x00000000, 0x00000000, 0x00000000
  .long 0x00000000, 0x00000000, 0x00000000, 0x00000000, 0x00000000, 0x00000000, 0x00000000, 0x00000000
  .long 0x00000000, 0x00000000, 0x00000000, 0x00000000, 0x00000000, 0x00000000, 0x00000000, 0x00000000
  .long 0x00000000, 0x00000000, 0x00000000, 0x00000000, 0x00000000, 0x00000000, 0x00000000, 0x00000000
  .long 0x00000000, 0x00000000, 0x00000000, 0x00000000, 0x00000000, 0x00000000, 0x00000000, 0x00000000
  .long 0x00000000, 0x00000000, 0x00000000, 0x00000000, 0x00000000, 0x00000000, 0x00000000, 0x00000000
  .long 0x00000000, 0x00000000, 0x00000000, 0x00000000, 0x00003f80, 0x00000000, 0x00000000, 0x00000000
  .long 0x3f803f80, 0x00000000, 0x00000000, 0x00000000, 0x3f803f80, 0x00003f80, 0x00000000, 0x00000000
  .long 0x3f800000, 0x3f803f80, 0x00000000, 0x00000000, 0x00000000, 0x3f803f80, 0x00003f80, 0x00000000
  .long 0x00000000, 0x00000000, 0x00000000, 0x00000000, 0x00000000, 0x00000000, 0x00000000, 0x00000000
  .long 0x00000000, 0x00000000, 0x00000000, 0x00000000, 0x00000000, 0x00000000, 0x00000000, 0x00000000
  .long 0x00000000, 0x00000000, 0x00000000, 0x00000000, 0x00000000, 0x00000000, 0x00000000, 0x00000000
  .long 0x00000000, 0x00000000, 0x00000000, 0x00000000, 0x00000000, 0x00000000, 0x00000000, 0x00000000
  .long 0x00000000, 0x00000000, 0x00000000, 0x00000000, 0x00000000, 0x00000000, 0x00000000, 0x00000000
  .long 0x00000000, 0x00000000, 0x00000000, 0x00000000, 0x00000000, 0x00000000, 0x00000000, 0x00000000
  .long 0x00000000, 0x00000000, 0x00000000, 0x00000000, 0x00000000, 0x00000000, 0x00000000, 0x00000000
  .long 0x00000000, 0x00000000, 0x00000000, 0x00000000, 0x00000000, 0x00000000, 0x00000000, 0x00000000
  .long 0x00000000, 0x00000000, 0x00000000, 0x3f803f80, 0x00000000, 0x00000000, 0x00000000, 0x3f800000
  .long 0x00000000, 0x00000000, 0x00000000, 0x00000000, 0x00000000, 0x00000000, 0x00000000, 0x00000000
  .long 0x00000000, 0x00000000, 0x00000000, 0x00000000, 0x00000000, 0x00000000, 0x00000000, 0x00000000
  .long 0x00000000, 0x00000000, 0x00000000, 0x00000000, 0x00000000, 0x00000000, 0x00000000, 0x00000000
  .long 0x00000000, 0x00000000, 0x00000000, 0x00000000, 0x00000000, 0x00000000, 0x00000000, 0x00000000
  .long 0x00000000, 0x00000000, 0x00000000, 0x00000000, 0x00000000, 0x00000000, 0x00000000, 0x00000000
  .long 0x00000000, 0x00000000, 0x00000000, 0x00000000, 0x00000000, 0x00000000, 0x00000000, 0x00000000
  .long 0x00000000, 0x00000000, 0x00000000, 0x00000000, 0x00000000, 0x00000000, 0x00000000, 0x00000000
  .long 0x3f803f80, 0x00003f80, 0x00000000, 0x00000000, 0x3f803f80, 0x3f803f80, 0x00000000, 0x00000000
  .long 0x3f803f80, 0x3f803f80, 0x00003f80, 0x00000000, 0x3f800000, 0x3f803f80, 0x3f803f80, 0x00000000
  .long 0x00000000, 0x3f803f80, 0x3f803f80, 0x00003f80, 0x00000000, 0x3f800000, 0x3f803f80, 0x3f803f80
  .long 0x00000000, 0x00000000, 0x3f803f80, 0x3f803f80, 0x00000000, 0x00000000, 0x3f800000, 0x3f803f80
  .long 0x00000000, 0x00000000, 0x00000000, 0x3f803f80, 0x00000000, 0x00000000, 0x00000000, 0x3f800000
  .long 0x00000000, 0x00000000, 0x00000000, 0x00000000, 0x00000000, 0x00000000, 0x00000000, 0x00000000
  .long 0x00000000, 0x00000000, 0x00000000, 0x00000000, 0x00000000, 0x00000000, 0x00000000, 0x00000000
  .long 0x00000000, 0x00000000, 0x00000000, 0x00000000, 0x00000000, 0x00000000, 0x00000000, 0x00000000
  .long 0x00000000, 0x00000000, 0x00000000, 0x00000000, 0x00000000, 0x00000000, 0x00000000, 0x00000000
  .long 0x00000000, 0x00000000, 0x00000000, 0x00000000, 0x00000000, 0x00000000, 0x00000000, 0x00000000
  .long 0x00000000, 0x00000000, 0x00000000, 0x00000000, 0x00000000, 0x00000000, 0x00000000, 0x00000000
  .long 0x00003f80, 0x00000000, 0x00000000, 0x00000000, 0x3f803f80, 0x00000000, 0x00000000, 0x00000000
  .long 0x3f803f80, 0x00003f80, 0x00000000, 0x00000000, 0x3f803f80, 0x3f803f80, 0x00000000, 0x00000000
  .long 0x3f803f80, 0x3f803f80, 0x00003f80, 0x00000000, 0x3f800000, 0x3f803f80, 0x3f803f80, 0x00000000
  .long 0x00000000, 0x3f803f80, 0x3f803f80, 0x00003f80, 0x00000000, 0x3f800000, 0x3f803f80, 0x3f803f80
  .long 0x00000000, 0x00000000, 0x3f803f80, 0x3f803f80, 0x00000000, 0x00000000, 0x3f800000, 0x3f803f80
  .long 0x00000000, 0x00000000, 0x00000000, 0x00000000, 0x00000000, 0x00000000, 0x00000000, 0x00000000
  .long 0x00000000, 0x00000000, 0x00000000, 0x00000000, 0x00000000, 0x00000000, 0x00000000, 0x00000000
  .long 0x00000000, 0x00000000, 0x00000000, 0x00000000, 0x00000000, 0x00000000, 0x00000000, 0x00000000
  .long 0x00000000, 0x00000000, 0x00000000, 0x00000000, 0x00000000, 0x00000000, 0x00000000, 0x00000000
  .long 0x00000000, 0x00000000, 0x00000000, 0x00000000, 0x00000000, 0x00000000, 0x00000000, 0x00000000
  .long 0x00000000, 0x00000000, 0x00000000, 0x00000000, 0x00000000, 0x00000000, 0x00000000, 0x00000000
  .long 0x00000000, 0x00000000, 0x00000000, 0x00000000, 0x00000000, 0x00000000, 0x00000000, 0x00000000
  .long 0x00003f80, 0x00000000, 0x00000000, 0x00000000, 0x3f803f80, 0x00000000, 0x00000000, 0x00000000
  .long 0x00000000, 0x00000000, 0x00000000, 0x3f803f80, 0x00000000, 0x00000000, 0x00000000, 0x3f800000
  .long 0x00000000, 0x00000000, 0x00000000, 0x00000000, 0x00000000, 0x00000000, 0x00000000, 0x00000000
  .long 0x00000000, 0x00000000, 0x00000000, 0x00000000, 0x00000000, 0x00000000, 0x00000000, 0x00000000
  .long 0x00000000, 0x00000000, 0x00000000, 0x00000000, 0x00000000, 0x00000000, 0x00000000, 0x00000000
  .long 0x00000000, 0x00000000, 0x00000000, 0x00000000, 0x00000000, 0x00000000, 0x00000000, 0x00000000
  .long 0x00000000, 0x00000000, 0x00000000, 0x00000000, 0x00000000, 0x00000000, 0x00000000, 0x00000000
  .long 0x00000000, 0x00000000, 0x00000000, 0x00000000, 0x00000000, 0x00000000, 0x00000000, 0x00000000
  .long 0x00000000, 0x00000000, 0x00000000, 0x00000000, 0x00000000, 0x00000000, 0x00000000, 0x00000000
  .long 0x3f803f80, 0x00003f80, 0x00000000, 0x00000000, 0x3f803f80, 0x3f803f80, 0x00000000, 0x00000000
  .long 0x3f803f80, 0x3f803f80, 0x00003f80, 0x00000000, 0x3f800000, 0x3f803f80, 0x3f803f80, 0x00000000
  .long 0x00000000, 0x3f803f80, 0x3f803f80, 0x00003f80, 0x00000000, 0x3f800000, 0x3f803f80, 0x3f803f80
  .long 0x00000000, 0x00000000, 0x3f803f80, 0x3f803f80, 0x00000000, 0x00000000, 0x3f800000, 0x3f803f80
  .long 0x00000000, 0x00000000, 0x00000000, 0x3f803f80, 0x00000000, 0x00000000, 0x00000000, 0x3f800000
  .long 0x00000000, 0x00000000, 0x00000000, 0x00000000, 0x00000000, 0x00000000, 0x00000000, 0x00000000
  .long 0x00000000, 0x00000000, 0x00000000, 0x00000000, 0x00000000, 0x00000000, 0x00000000, 0x00000000
  .long 0x00000000, 0x00000000, 0x00000000, 0x00000000, 0x00000000, 0x00000000, 0x00000000, 0x00000000
  .long 0x00000000, 0x00000000, 0x00000000, 0x00000000, 0x00000000, 0x00000000, 0x00000000, 0x00000000
  .long 0x00000000, 0x00000000, 0x00000000, 0x00000000, 0x00000000, 0x00000000, 0x00000000, 0x00000000
  .long 0x00000000, 0x00000000, 0x00000000, 0x00000000, 0x00000000, 0x00000000, 0x00000000, 0x00000000
  .long 0x00003f80, 0x00000000, 0x00000000, 0x00000000, 0x3f803f80, 0x00000000, 0x00000000, 0x00000000
  .long 0x3f803f80, 0x00003f80, 0x00000000, 0x00000000, 0x3f803f80, 0x3f803f80, 0x00000000, 0x00000000
  .long 0x3f803f80, 0x3f803f80, 0x00003f80, 0x00000000, 0x3f800000, 0x3f803f80, 0x3f803f80, 0x00000000
  .long 0x00000000, 0x3f803f80, 0x3f803f80, 0x00003f80, 0x00000000, 0x3f800000, 0x3f803f80, 0x3f803f80
  .long 0x00000000, 0x00000000, 0x3f803f80, 0x3f803f80, 0x00000000, 0x00000000, 0x3f800000, 0x3f803f80
  .long 0x00000000, 0x00000000, 0x00000000, 0x00000000, 0x00000000, 0x00000000, 0x00000000, 0x00000000
  .long 0x00000000, 0x00000000, 0x00000000, 0x00000000, 0x00000000, 0x00000000, 0x00000000, 0x00000000
  .long 0x00000000, 0x00000000, 0x00000000, 0x00000000, 0x00000000, 0x00000000, 0x00000000, 0x00000000
  .long 0x00000000, 0x00000000, 0x00000000, 0x00000000, 0x00000000, 0x00000000, 0x00000000, 0x00000000
  .long 0x00000000, 0x00000000, 0x00000000, 0x00000000, 0x00000000, 0x00000000, 0x00000000, 0x00000000
  .long 0x00000000, 0x00000000, 0x00000000, 0x00000000, 0x00000000, 0x00000000, 0x00000000, 0x00000000
  .long 0x00000000, 0x00000000, 0x00000000, 0x00000000, 0x00000000, 0x00000000, 0x00000000, 0x00000000
  .long 0x00003f80, 0x00000000, 0x00000000, 0x00000000, 0x3f803f80, 0x00000000, 0x00000000, 0x00000000
  .long 0x00000000, 0x00000000, 0x3f800000, 0x3f803f80, 0x00000000, 0x00000000, 0x00000000, 0x3f803f80
  .long 0x00000000, 0x00000000, 0x00000000, 0x3f800000, 0x00000000, 0x00000000, 0x00000000, 0x00000000
  .long 0x00000000, 0x00000000, 0x00000000, 0x00000000, 0x00000000, 0x00000000, 0x00000000, 0x00000000
  .long 0x00000000, 0x00000000, 0x00000000, 0x00000000, 0x00000000, 0x00000000, 0x00000000, 0x00000000
  .long 0x00000000, 0x00000000, 0x00000000, 0x00000000, 0x00000000, 0x00000000, 0x00000000, 0x00000000
  .long 0x00000000, 0x00000000, 0x00000000, 0x00000000, 0x00000000, 0x00000000, 0x00000000, 0x00000000
  .long 0x00000000, 0x00000000, 0x00000000, 0x00000000, 0x00000000, 0x00000000, 0x00000000, 0x00000000
  .long 0x00000000, 0x00000000, 0x00000000, 0x00000000, 0x00000000, 0x00000000, 0x00000000, 0x00000000
  .long 0x3f803f80, 0x3f803f80, 0x00000000, 0x00000000, 0x3f803f80, 0x3f803f80, 0x00003f80, 0x00000000
  .long 0x3f803f80, 0x3f803f80, 0x3f803f80, 0x00000000, 0x3f803f80, 0x3f803f80, 0x3f803f80, 0x00003f80
  .long 0x3f800000, 0x3f803f80, 0x3f803f80, 0x3f803f80, 0x00000000, 0x3f803f80, 0x3f803f80, 0x3f803f80
  .long 0x00000000, 0x3f800000, 0x3f803f80, 0x3f803f80, 0x00000000, 0x00000000, 0x3f803f80, 0x3f803f80
  .long 0x00000000, 0x00000000, 0x3f800000, 0x3f803f80, 0x00000000, 0x00000000, 0x00000000, 0x3f803f80
  .long 0x00000000, 0x00000000, 0x00000000, 0x3f800000, 0x00000000, 0x00000000, 0x00000000, 0x00000000
  .long 0x00000000, 0x00000000, 0x00000000, 0x00000000, 0x00000000, 0x00000000, 0x00000000, 0x00000000
  .long 0x00000000, 0x00000000, 0x00000000, 0x00000000, 0x00000000, 0x00000000, 0x00000000, 0x00000000
  .long 0x00000000, 0x00000000, 0x00000000, 0x00000000, 0x00000000, 0x00000000, 0x00000000, 0x00000000
  .long 0x00000000, 0x00000000, 0x00000000, 0x00000000, 0x00000000, 0x00000000, 0x00000000, 0x00000000
  .long 0x00000000, 0x00000000, 0x00000000, 0x00000000, 0x00003f80, 0x00000000, 0x00000000, 0x00000000
  .long 0x3f803f80, 0x00000000, 0x00000000, 0x00000000, 0x3f803f80, 0x00003f80, 0x00000000, 0x00000000
  .long 0x3f803f80, 0x3f803f80, 0x00000000, 0x00000000, 0x3f803f80, 0x3f803f80, 0x00003f80, 0x00000000
  .long 0x3f803f80, 0x3f803f80, 0x3f803f80, 0x00000000, 0x3f803f80, 0x3f803f80, 0x3f803f80, 0x00003f80
  .long 0x3f800000, 0x3f803f80, 0x3f803f80, 0x3f803f80, 0x00000000, 0x3f803f80, 0x3f803f80, 0x3f803f80
  .long 0x00000000, 0x3f800000, 0x3f803f80, 0x3f803f80, 0x00000000, 0x00000000, 0x3f803f80, 0x3f803f80
  .long 0x00000000, 0x00000000, 0x00000000, 0x00000000, 0x00000000, 0x00000000, 0x00000000, 0x00000000
  .long 0x00000000, 0x00000000, 0x00000000, 0x00000000, 0x00000000, 0x00000000, 0x00000000, 0x00000000
  .long 0x00000000, 0x00000000, 0x00000000, 0x00000000, 0x00000000, 0x00000000, 0x00000000, 0x00000000
  .long 0x00000000, 0x00000000, 0x00000000, 0x00000000, 0x00000000, 0x00000000, 0x00000000, 0x00000000
  .long 0x00000000, 0x00000000, 0x00000000, 0x00000000, 0x00000000, 0x00000000, 0x00000000, 0x00000000
  .long 0x00000000, 0x00000000, 0x00000000, 0x00000000, 0x00000000, 0x00000000, 0x00000000, 0x00000000
  .long 0x00000000, 0x00000000, 0x00000000, 0x00000000, 0x00003f80, 0x00000000, 0x00000000, 0x00000000
  .long 0x3f803f80, 0x00000000, 0x00000000, 0x00000000, 0x3f803f80, 0x00003f80, 0x00000000, 0x00000000
  .long 0x00000000, 0x00000000, 0x3f803f80, 0x3f803f80, 0x00000000, 0x00000000, 0x3f800000, 0x3f803f80
  .long 0x00000000, 0x00000000, 0x00000000, 0x3f803f80, 0x00000000, 0x00000000, 0x00000000, 0x3f800000
  .long 0x00000000, 0x00000000, 0x00000000, 0x00000000, 0x00000000, 0x00000000, 0x00000000, 0x00000000
  .long 0x00000000, 0x00000000, 0x00000000, 0x00000000, 0x00000000, 0x00000000, 0x00000000, 0x00000000
  .long 0x00000000, 0x00000000, 0x00000000, 0x00000000, 0x00000000, 0x00000000, 0x00000000, 0x00000000
  .long 0x00000000, 0x00000000, 0x00000000, 0x00000000, 0x00000000, 0x00000000, 0x00000000, 0x00000000
  .long 0x00000000, 0x00000000, 0x00000000, 0x00000000, 0x00000000, 0x00000000, 0x00000000, 0x00000000
  .long 0x00000000, 0x00000000, 0x00000000, 0x00000000, 0x00000000, 0x00000000, 0x00000000, 0x00000000
  .long 0x3f803f80, 0x3f803f80, 0x00003f80, 0x00000000, 0x3f803f80, 0x3f803f80, 0x3f803f80, 0x00000000
  .long 0x3f803f80, 0x3f803f80, 0x3f803f80, 0x00003f80, 0x3f803f80, 0x3f803f80, 0x3f803f80, 0x3f803f80
  .long 0x3f803f80, 0x3f803f80, 0x3f803f80, 0x3f803f80, 0x3f800000, 0x3f803f80, 0x3f803f80, 0x3f803f80
  .long 0x00000000, 0x3f803f80, 0x3f803f80, 0x3f803f80, 0x00000000, 0x3f800000, 0x3f803f80, 0x3f803f80
  .long 0x00000000, 0x00000000, 0x3f803f80, 0x3f803f80, 0x00000000, 0x00000000, 0x3f800000, 0x3f803f80
  .long 0x00000000, 0x00000000, 0x00000000, 0x3f803f80, 0x00000000, 0x00000000, 0x00000000, 0x3f800000
  .long 0x00000000, 0x00000000, 0x00000000, 0x00000000, 0x00000000, 0x00000000, 0x00000000, 0x00000000
  .long 0x00000000, 0x00000000, 0x00000000, 0x00000000, 0x00000000, 0x00000000, 0x00000000, 0x00000000
  .long 0x00000000, 0x00000000, 0x00000000, 0x00000000, 0x00000000, 0x00000000, 0x00000000, 0x00000000
  .long 0x00000000, 0x00000000, 0x00000000, 0x00000000, 0x00000000, 0x00000000, 0x00000000, 0x00000000
  .long 0x00003f80, 0x00000000, 0x00000000, 0x00000000, 0x3f803f80, 0x00000000, 0x00000000, 0x00000000
  .long 0x3f803f80, 0x00003f80, 0x00000000, 0x00000000, 0x3f803f80, 0x3f803f80, 0x00000000, 0x00000000
  .long 0x3f803f80, 0x3f803f80, 0x00003f80, 0x00000000, 0x3f803f80, 0x3f803f80, 0x3f803f80, 0x00000000
  .long 0x3f803f80, 0x3f803f80, 0x3f803f80, 0x00003f80, 0x3f803f80, 0x3f803f80, 0x3f803f80, 0x3f803f80
  .long 0x3f803f80, 0x3f803f80, 0x3f803f80, 0x3f803f80, 0x3f800000, 0x3f803f80, 0x3f803f80, 0x3f803f80
  .long 0x00000000, 0x3f803f80, 0x3f803f80, 0x3f803f80, 0x00000000, 0x3f800000, 0x3f803f80, 0x3f803f80
  .long 0x00000000, 0x00000000, 0x00000000, 0x00000000, 0x00000000, 0x00000000, 0x00000000, 0x00000000
  .long 0x00000000, 0x00000000, 0x00000000, 0x00000000, 0x00000000, 0x00000000, 0x00000000, 0x00000000
  .long 0x00000000, 0x00000000, 0x00000000, 0x00000000, 0x00000000, 0x00000000, 0x00000000, 0x00000000
  .long 0x00000000, 0x00000000, 0x00000000, 0x00000000, 0x00000000, 0x00000000, 0x00000000, 0x00000000
  .long 0x00000000, 0x00000000, 0x00000000, 0x00000000, 0x00000000, 0x00000000, 0x00000000, 0x00000000
  .long 0x00000000, 0x00000000, 0x00000000, 0x00000000, 0x00000000, 0x00000000, 0x00000000, 0x00000000
  .long 0x00003f80, 0x00000000, 0x00000000, 0x00000000, 0x3f803f80, 0x00000000, 0x00000000, 0x00000000
  .long 0x3f803f80, 0x00003f80, 0x00000000, 0x00000000, 0x3f803f80, 0x3f803f80, 0x00000000, 0x00000000
L_code_end:
.section .rodata,"a"
.p2align 6
.amdhsa_kernel gated_mix__linear_attn_block__ssm_conv_s4d__prompt_kernel
  .amdhsa_next_free_vgpr 256
  .amdhsa_next_free_sgpr 102
  .amdhsa_accum_offset 256
  .amdhsa_group_segment_fixed_size 0
  .amdhsa_kernarg_size 112
  .amdhsa_user_sgpr_count 2
  .amdhsa_user_sgpr_kernarg_segment_ptr 1
  .amdhsa_system_sgpr_workgroup_id_x 1
.end_amdhsa_kernel
```
